```python
import torch

def _softmax(x, axis=-1):
    return torch.softmax(x, dim=axis)
def _gelu(x):
    return torch.nn.functional.gelu(x, approximate="tanh")
def _silu(x):
    return torch.nn.functional.silu(x)
def _sigmoid(x):
    return torch.sigmoid(x)
def _layernorm(x, axis=-1, eps=1e-5):
    m = x.mean(dim=axis, keepdim=True)
    v = x.var(dim=axis, keepdim=True, unbiased=False)
    return (x - m) / torch.sqrt(v + eps)
def _scatter_add(tgt, idx, src, axis=0):
    return tgt.clone().index_add_(axis, idx, src)
def _segment_sum(src, seg, n):
    out = torch.zeros((n,) + src.shape[1:], dtype=src.dtype)
    return out.index_add_(0, seg, src)
def _pad(x, pw):
    flat = tuple(v for pair in reversed(pw) for v in pair)
    return torch.nn.functional.pad(x, flat)

kernel_name = 'parallel_sum__ssm_conv_s5__glu_gated_geglu__prompt'

def setup_inputs():

    _w = (lambda a: (lambda t: t.to(torch.bfloat16) if t.is_floating_point() else t)(torch.as_tensor(a)))
    def _A_setup():
        B, S, D = 1, 2048, 1024
        P = D
        Lambda_re = -0.5 * (lambda _x: torch.exp(torch.as_tensor(_x)))((lambda *s: torch.randn(*s, dtype=torch.bfloat16) * 0.2)(P))
        Lambda_im = (lambda *s: torch.randn(*s, dtype=torch.bfloat16) * 0.8)(P) * 1.0
        B_re = (lambda *s: torch.randn(*s, dtype=torch.bfloat16) * 0.2)(P, D) * (D ** -0.5)
        B_im = (lambda *s: torch.randn(*s, dtype=torch.bfloat16) * 0.2)(P, D) * (D ** -0.5)
        C_re = (lambda *s: torch.randn(*s, dtype=torch.bfloat16) * 0.2)(D, P) * (P ** -0.5)
        C_im = (lambda *s: torch.randn(*s, dtype=torch.bfloat16) * 0.2)(D, P) * (P ** -0.5)
        log_dt = (lambda *s: torch.randn(*s, dtype=torch.bfloat16) * 0.2)(P) * 0.3 - 2.0
        Dskip = (lambda *s: torch.randn(*s, dtype=torch.bfloat16) * 0.05)(D)
        return {
            "x": _w((lambda *s: torch.randn(*s, dtype=torch.bfloat16) * 0.05)(B, S, D)),
            "Lambda_re": _w(Lambda_re),
            "Lambda_im": _w(Lambda_im),
            "B_re": _w(B_re),
            "B_im": _w(B_im),
            "C_re": _w(C_re),
            "C_im": _w(C_im),
            "log_dt": _w(log_dt),
            "Dskip": _w(Dskip),
        }
    _A_in = _A_setup()

    def _B_setup():
        B, S, Dm, Df = 1, 2048, 1024, 3584
        return {
            "x": _w((lambda *s: torch.randn(*s, dtype=torch.bfloat16) * 0.05)(B, S, Dm)),
            "w_gate": _w((lambda *s: torch.randn(*s, dtype=torch.bfloat16) * 0.4)(Dm, Df) * (Dm ** -0.5)),
            "w_up": _w((lambda *s: torch.randn(*s, dtype=torch.bfloat16) * 0.4)(Dm, Df) * (Dm ** -0.5)),
            "w_down": _w((lambda *s: torch.randn(*s, dtype=torch.bfloat16) * 0.4)(Df, Dm) * (Df ** -0.5)),
        }
    _B_in = _B_setup()

    return {
        "A_x": _A_in["x"],
        "A_Lambda_re": _A_in["Lambda_re"],
        "A_Lambda_im": _A_in["Lambda_im"],
        "A_B_re": _A_in["B_re"],
        "A_B_im": _A_in["B_im"],
        "A_C_re": _A_in["C_re"],
        "A_C_im": _A_in["C_im"],
        "A_log_dt": _A_in["log_dt"],
        "A_Dskip": _A_in["Dskip"],
        "B_x": _B_in["x"],
        "B_w_gate": _B_in["w_gate"],
        "B_w_up": _B_in["w_up"],
        "B_w_down": _B_in["w_down"],
    }

def reference(A_x, A_Lambda_re, A_Lambda_im, A_B_re, A_B_im, A_C_re, A_C_im, A_log_dt, A_Dskip, B_x, B_w_gate, B_w_up, B_w_down):
    def _A_ref(x, Lambda_re, Lambda_im, B_re, B_im, C_re, C_im, log_dt, Dskip):
        Bsz, L, H = x.shape
        Lam = Lambda_re + 1j * Lambda_im
        Bmat = B_re + 1j * B_im
        Cmat = C_re + 1j * C_im
        dt = torch.exp(log_dt)
        Lam_bar = torch.exp(dt * Lam)
        B_bar = ((Lam_bar - 1.0) / Lam)[:, None] * Bmat
        Bu = torch.einsum("bld,pd->blp", x + 0j, B_bar)
        h = torch.zeros_like(Bu[:, 0, :])
        hs = []
        for t in range(L):
            h = Lam_bar[None, :] * h + Bu[:, t, :]
            hs.append(h)
        hseq = torch.stack(hs, 1)
        y = 2.0 * torch.einsum("blp,dp->bld", hseq, Cmat).real + x * Dskip[None, None, :]
        return y

    def _B_ref(x, w_gate, w_up, w_down):
        g = torch.einsum("bsd,df->bsf", x, w_gate)
        u = torch.einsum("bsd,df->bsf", x, w_up)
        h = _gelu(g) * u
        return torch.einsum("bsf,fd->bsd", h, w_down)

    x = A_x
    xn = _layernorm(x, axis=-1)
    return x + _A_ref(xn, A_Lambda_re, A_Lambda_im, A_B_re, A_B_im, A_C_re, A_C_im, A_log_dt, A_Dskip) + _B_ref(xn, B_w_gate, B_w_up, B_w_down)
```

```asm
; @launch grid=(256,1,1) block=(256,1,1) lds=163840
.amdgcn_target "amdgcn-amd-amdhsa--gfx950"
.text
.globl parallel_sum__ssm_conv_s5__glu_gated_geglu__prompt_kernel
.p2align 8
.type parallel_sum__ssm_conv_s5__glu_gated_geglu__prompt_kernel,@function
parallel_sum__ssm_conv_s5__glu_gated_geglu__prompt_kernel:
    s_cmp_ge_u32 s2, 256
    s_cbranch_scc1 f_end
    s_load_dwordx2 s[24:25], s[0:1], 0
    s_load_dwordx4 s[20:23], s[0:1], 112
    s_load_dwordx4 s[4:7], s[0:1], 80
    s_load_dwordx4 s[8:11], s[0:1], 24
    s_load_dwordx4 s[48:51], s[0:1], 8
    s_load_dwordx4 s[28:31], s[0:1], 56
    s_memrealtime s[60:61]
    v_lshrrev_b32 v228, 6, v0
    v_and_b32 v1, 63, v0
    v_readfirstlane_b32 s26, v228
    s_and_b32 s66, s2, 7
    s_lshl_b32 s66, s66, 5
    s_lshr_b32 s67, s2, 3
    s_add_u32 s66, s66, s67
    s_lshl_b32 s59, s66, 2
    s_add_u32 s59, s59, s26
    s_and_b32 s66, s59, 127
    s_lshl_b32 s66, s66, 1
    v_and_b32 v228, 1, v1
    v_add_u32 v228, s66, v228
    s_getpc_b64 s[72:73]
L_pc1:
    s_add_u32 s72, s72, parallel_sum__ssm_conv_s5__glu_gated_geglu__prompt_kernel-L_pc1
    s_addc_u32 s73, s73, (parallel_sum__ssm_conv_s5__glu_gated_geglu__prompt_kernel-L_pc1)>>32
    v_lshlrev_b32 v229, 7, v228
    v_min_u32 v229, code_end-parallel_sum__ssm_conv_s5__glu_gated_geglu__prompt_kernel-4, v229
    v_mov_b32 v235, s73
    v_add_co_u32 v234, vcc, s72, v229
    s_nop 1
    v_addc_co_u32 v235, vcc, 0, v235, vcc
    global_load_dword v240, v[234:235], off
    s_lshr_b32 s56, s2, 5
    s_bfe_u32 s57, s2, 0x20001
    s_bfe_u32 s27, s2, 0x20003
    s_and_b32 s66, s2, 1
    s_lshl_b32 s66, s66, 2
    s_add_u32 s27, s27, s66
    s_lshl_b32 s58, s57, 3
    s_add_u32 s58, s58, s56
    s_lshl_b32 s69, s27, 2
    s_add_u32 s70, s69, s57
    s_add_u32 s69, s69, s26
    s_lshl_b32 s62, s70, 1
    s_and_b32 s66, s56, 1
    s_add_u32 s62, s62, s66
    s_lshl_b32 s62, s62, 1
    s_lshr_b32 s66, s26, 1
    s_add_u32 s62, s62, s66
    s_lshl_b32 s62, s62, 4
    s_and_b32 s66, s56, 6
    s_add_u32 s62, s62, s66
    s_and_b32 s65, s26, 1
    s_add_u32 s62, s62, s65
    s_lshl_b32 s66, s62, 11
    s_add_u32 s67, s66, 0x4000
    v_lshlrev_b32 v2, 4, v1
    v_and_b32 v3, 0xf0, v2
    v_bfrev_b32 v241, 1
    s_mov_b32 s42, 4194304
    s_mov_b32 s43, 0x00020000
    s_waitcnt lgkmcnt(0)
    s_mov_b64 s[40:41], s[24:25]
    buffer_load_dwordx4 v[68:71], v2, s[40:43], s66 offen
    buffer_load_dwordx4 v[72:75], v2, s[40:43], s66 offen offset:1024
    buffer_load_dwordx4 v[76:79], v2, s[40:43], s67 offen
    buffer_load_dwordx4 v[80:83], v2, s[40:43], s67 offen offset:1024
    s_load_dwordx4 s[12:15], s[0:1], 40
    s_load_dwordx4 s[16:19], s[0:1], 96
    s_mov_b32 s44, s20
    s_mov_b32 s45, s21
    s_mov_b32 s46, 0x100
    s_mov_b32 s47, 0x00020000
    s_or_b32 s66, s60, 15
    v_mov_b32 v228, s66
    s_cmp_eq_u32 s59, 0
    s_cselect_b32 s46, 256, 0
    v_lshlrev_b32 v229, 6, v1
    buffer_store_dword v228, v229, s[44:47], 0 offen sc0 sc1
    s_mov_b32 s46, 256
    s_lshl_b32 s20, s57, 3
    s_add_u32 s20, s20, s27
    s_lshl_b32 s20, s20, 3
    s_add_u32 s20, s20, s56
    s_lshl_b32 s20, s20, 2
    s_add_u32 s20, s20, s26
    s_lshl_b32 s20, s20, 8
    s_add_u32 s52, s22, 0x1c60000
    s_addc_u32 s53, s23, 0
    s_mov_b32 s54, 0x80000
    s_mov_b32 s55, 0x00020000
    s_mov_b64 exec, 1
    buffer_load_dword v240, v3, s[52:55], s20 offen sc1
    s_mov_b64 exec, -1
    s_cmp_ge_u32 s26, 2
    s_cselect_b32 s32, s6, s4
    s_cselect_b32 s33, s7, s5
    s_cselect_b32 s36, s10, s8
    s_cselect_b32 s37, s11, s9
    s_mov_b32 s34, 7340032
    s_mov_b32 s35, 0x00020000
    s_mov_b32 s38, 2097152
    s_mov_b32 s39, 0x00020000
    s_bfe_u32 s63, s59, 0x60002
    s_lshl_b32 s63, s63, 1
    s_add_u32 s63, s63, s65
    s_mul_i32 s66, s63, 7168
    s_mul_i32 s67, s57, 1792
    s_add_u32 s66, s66, s67
    v_cmp_gt_u32 vcc, 14, v1
    v_lshlrev_b32 v228, 7, v1
    s_add_u32 s67, s66, 917504
    v_cndmask_b32 v236, v241, v228, vcc
    buffer_load_dword v240, v236, s[32:35], s66 offen
    buffer_load_dword v240, v236, s[32:35], s67 offen
    s_lshl_b32 s67, s57, 7
    s_add_u32 s67, s67, s63
    s_lshl_b32 s67, s67, 12
    v_lshrrev_b32 v228, 1, v1
    v_lshlrev_b32 v228, 11, v228
    v_and_b32 v229, 1, v1
    v_lshl_add_u32 v228, v229, 7, v228
    v_cmp_gt_u32 vcc, 4, v1
    v_add_u32 v228, s67, v228
    s_nop 0
    v_cndmask_b32 v237, v241, v228, vcc
    buffer_load_dword v240, v237, s[36:39], 0 offen
    buffer_load_dword v240, v237, s[36:39], 0 offen offset:256
    v_add_u32 v228, 0, v1
    v_mul_u32_u24 v229, 4682, v228
    v_lshrrev_b32 v229, 16, v229
    v_mul_u32_u24 v230, 6944, v229
    v_lshl_add_u32 v230, v228, 4, v230
    v_bfe_u32 v228, v229, 2, 1
    v_bfe_u32 v229, v229, 3, 1
    v_sub_u32 v228, v228, v229
    v_mul_i32_i24 v228, 28672, v228
    v_add_u32 v242, v230, v228
    v_add_u32 v228, 64, v1
    v_mul_u32_u24 v229, 4682, v228
    v_lshrrev_b32 v229, 16, v229
    v_mul_u32_u24 v230, 6944, v229
    v_lshl_add_u32 v230, v228, 4, v230
    v_bfe_u32 v228, v229, 2, 1
    v_bfe_u32 v229, v229, 3, 1
    v_sub_u32 v228, v228, v229
    v_mul_i32_i24 v228, 28672, v228
    v_subrev_u32 v230, 1024, v230
    v_add_u32 v243, v230, v228
    v_add_u32 v228, 128, v1
    v_mul_u32_u24 v229, 4682, v228
    v_lshrrev_b32 v229, 16, v229
    v_mul_u32_u24 v230, 6944, v229
    v_lshl_add_u32 v230, v228, 4, v230
    v_bfe_u32 v228, v229, 2, 1
    v_bfe_u32 v229, v229, 3, 1
    v_sub_u32 v228, v228, v229
    v_mul_i32_i24 v228, 28672, v228
    v_subrev_u32 v230, 2048, v230
    v_add_u32 v244, v230, v228
    v_add_u32 v228, 192, v1
    v_mul_u32_u24 v229, 4682, v228
    v_lshrrev_b32 v229, 16, v229
    v_mul_u32_u24 v230, 6944, v229
    v_lshl_add_u32 v230, v228, 4, v230
    v_bfe_u32 v228, v229, 2, 1
    v_bfe_u32 v229, v229, 3, 1
    v_sub_u32 v228, v228, v229
    v_mul_i32_i24 v228, 28672, v228
    v_subrev_u32 v230, 3072, v230
    v_add_u32 v245, v230, v228
    v_add_u32 v228, 256, v1
    v_mul_u32_u24 v229, 4682, v228
    v_lshrrev_b32 v229, 16, v229
    v_mul_u32_u24 v230, 6944, v229
    v_lshl_add_u32 v230, v228, 4, v230
    v_bfe_u32 v228, v229, 2, 1
    v_bfe_u32 v229, v229, 3, 1
    v_sub_u32 v228, v228, v229
    v_mul_i32_i24 v228, 28672, v228
    v_add_u32 v246, v230, v228
    v_add_u32 v228, 320, v1
    v_mul_u32_u24 v229, 4682, v228
    v_lshrrev_b32 v229, 16, v229
    v_mul_u32_u24 v230, 6944, v229
    v_lshl_add_u32 v230, v228, 4, v230
    v_bfe_u32 v228, v229, 2, 1
    v_bfe_u32 v229, v229, 3, 1
    v_sub_u32 v228, v228, v229
    v_mul_i32_i24 v228, 28672, v228
    v_subrev_u32 v230, 1024, v230
    v_add_u32 v247, v230, v228
    v_add_u32 v228, 384, v1
    v_mul_u32_u24 v229, 4682, v228
    v_lshrrev_b32 v229, 16, v229
    v_mul_u32_u24 v230, 6944, v229
    v_lshl_add_u32 v230, v228, 4, v230
    v_bfe_u32 v228, v229, 2, 1
    v_bfe_u32 v229, v229, 3, 1
    v_sub_u32 v228, v228, v229
    v_mul_i32_i24 v228, 28672, v228
    v_subrev_u32 v230, 2048, v230
    v_add_u32 v248, v230, v228
    v_lshrrev_b32 v228, 3, v1
    v_lshrrev_b32 v229, 1, v228
    v_xor_b32 v229, v229, v1
    v_and_b32 v229, 7, v229
    v_lshlrev_b32 v229, 4, v229
    v_lshl_add_u32 v249, v228, 11, v229
    v_xor_b32 v229, 64, v249
    v_add_u32 v250, 15360, v229
    v_lshrrev_b32 v228, 3, v3
    s_lshl_b32 s66, s58, 6
    s_mov_b32 s52, s48
    s_mov_b32 s53, s49
    s_mov_b32 s54, 0x800
    s_mov_b32 s55, 0x00020000
    buffer_load_ushort v92, v228, s[52:55], s66 offen
    buffer_load_ushort v93, v228, s[52:55], s66 offen offset:32
    s_mov_b32 s52, s50
    s_mov_b32 s53, s51
    s_mov_b32 s54, 0x800
    s_mov_b32 s55, 0x00020000
    buffer_load_ushort v94, v228, s[52:55], s66 offen
    buffer_load_ushort v95, v228, s[52:55], s66 offen offset:32
    s_mov_b32 s52, s28
    s_mov_b32 s53, s29
    s_mov_b32 s54, 0x800
    s_mov_b32 s55, 0x00020000
    buffer_load_ushort v96, v228, s[52:55], s66 offen
    buffer_load_ushort v97, v228, s[52:55], s66 offen offset:32
    s_lshl_b32 s66, s56, 2
    s_add_u32 s66, s66, s57
    s_lshl_b32 s66, s66, 6
    v_and_b32 v228, 7, v1
    v_lshlrev_b32 v228, 3, v228
    s_mov_b32 s52, s30
    s_mov_b32 s53, s31
    s_mov_b32 s54, 0x800
    s_mov_b32 s55, 0x00020000
    buffer_load_dwordx2 a[216:217], v228, s[52:55], s66 offen
    v_mov_b32 v100, -1
    v_mov_b32 v101, -1
    v_mov_b32 v102, -1
    v_mov_b32 v103, -1
    s_add_u32 s52, s22, 0x1c20000
    s_addc_u32 s53, s23, 0
    s_mov_b32 s54, 0x40000
    s_mov_b32 s55, 0x00020000
    s_lshl_b32 s66, s58, 5
    s_add_u32 s66, s66, s69
    s_lshl_b32 s66, s66, 8
    s_mov_b64 exec, 0xffff
    buffer_store_dwordx4 v[100:103], v3, s[52:55], s66 offen sc0 sc1
    s_mov_b64 exec, -1
    s_lshl_b32 s71, s26, 1
    v_xor_b32 v87, s71, v1
    v_and_b32 v87, 7, v87
    v_lshlrev_b32 v87, 4, v87
    v_lshl_add_u32 v87, v1, 7, v87
    v_add_u32 v84, 147456, v87
    v_xor_b32 v85, 16, v84
    v_lshrrev_b32 v87, 3, v0
    v_xor_b32 v88, v87, v0
    v_and_b32 v88, 7, v88
    v_lshlrev_b32 v231, 4, v88
    v_and_b32 v88, 3, v87
    v_lshl_add_u32 v231, v88, 8, v231
    v_lshrrev_b32 v88, 2, v87
    v_lshl_add_u32 v231, v88, 12, v231
    v_lshlrev_b32 v86, 4, v0
    v_add_u32 v86, 147456, v86
    s_mul_i32 s70, s70, 135168
    s_lshr_b32 s71, s56, 1
    s_lshl_b32 s71, s71, 10
    s_add_u32 s70, s70, s71
    s_and_b32 s71, s56, 1
    s_lshl_b32 s71, s71, 7
    s_add_u32 s70, s70, s71
    s_lshl_b32 s62, s62, 3
    s_mov_b32 s40, s22
    s_mov_b32 s41, s23
    s_mov_b32 s42, 0x420000
    s_mov_b32 s43, 0x00020000
    s_add_u32 s52, s22, 0x1c00000
    s_addc_u32 s53, s23, 0
    s_mov_b32 s54, 0x4000
    s_mov_b32 s55, 0x00020000
    s_mov_b32 s66, 0xffff0000
    s_mov_b32 s67, 0x3a800000
    s_lshl_b32 s71, s26, 6
    v_mov_b32 v104, 0
    s_waitcnt vmcnt(14)
    v_lshlrev_b32 v106, 16, v68
    v_and_b32 v107, s66, v68
    v_lshlrev_b32 v108, 16, v69
    v_and_b32 v109, s66, v69
    v_lshlrev_b32 v110, 16, v70
    v_and_b32 v111, s66, v70
    v_lshlrev_b32 v112, 16, v71
    v_and_b32 v113, s66, v71
    v_lshlrev_b32 v114, 16, v72
    v_and_b32 v115, s66, v72
    v_lshlrev_b32 v116, 16, v73
    v_and_b32 v117, s66, v73
    v_lshlrev_b32 v118, 16, v74
    v_and_b32 v119, s66, v74
    v_lshlrev_b32 v120, 16, v75
    v_and_b32_e64 v121, s66, v75
    v_pk_add_f32 v[140:141], v[106:107], v[108:109]
    v_pk_add_f32 v[140:141], v[140:141], v[110:111]
    v_pk_add_f32 v[140:141], v[140:141], v[112:113]
    v_pk_add_f32 v[140:141], v[140:141], v[114:115]
    v_pk_add_f32 v[140:141], v[140:141], v[116:117]
    v_pk_add_f32 v[140:141], v[140:141], v[118:119]
    v_pk_add_f32 v[140:141], v[140:141], v[120:121]
    v_lshlrev_b32 v122, 16, v76
    v_and_b32 v123, s66, v76
    v_lshlrev_b32 v124, 16, v77
    v_and_b32 v125, s66, v77
    v_lshlrev_b32 v126, 16, v78
    v_and_b32 v127, s66, v78
    v_lshlrev_b32 v128, 16, v79
    v_and_b32 v129, s66, v79
    v_lshlrev_b32 v130, 16, v80
    v_and_b32 v131, s66, v80
    v_lshlrev_b32 v132, 16, v81
    v_and_b32 v133, s66, v81
    v_lshlrev_b32 v134, 16, v82
    v_and_b32 v135, s66, v82
    v_lshlrev_b32 v136, 16, v83
    v_and_b32 v137, s66, v83
    v_pk_add_f32 v[142:143], v[122:123], v[124:125]
    v_pk_add_f32 v[142:143], v[142:143], v[126:127]
    v_pk_add_f32 v[142:143], v[142:143], v[128:129]
    v_pk_add_f32 v[142:143], v[142:143], v[130:131]
    v_pk_add_f32 v[142:143], v[142:143], v[132:133]
    v_pk_add_f32 v[142:143], v[142:143], v[134:135]
    v_pk_add_f32 v[142:143], v[142:143], v[136:137]
    v_add_f32 v138, v140, v141
    v_add_f32_e64 v139, v142, v143
    s_nop 0
    v_add_f32_dpp v138, v138, v138 quad_perm:[1,0,3,2] row_mask:0xf bank_mask:0xf
    v_add_f32_dpp v139, v139, v139 quad_perm:[1,0,3,2] row_mask:0xf bank_mask:0xf
    s_nop 0
    v_add_f32_dpp v138, v138, v138 quad_perm:[2,3,0,1] row_mask:0xf bank_mask:0xf
    v_add_f32_dpp v139, v139, v139 quad_perm:[2,3,0,1] row_mask:0xf bank_mask:0xf
    s_nop 0
    v_add_f32_dpp v138, v138, v138 row_half_mirror row_mask:0xf bank_mask:0xf
    v_add_f32_dpp v139, v139, v139 row_half_mirror row_mask:0xf bank_mask:0xf
    s_nop 0
    v_add_f32_dpp v138, v138, v138 row_mirror row_mask:0xf bank_mask:0xf
    v_add_f32_dpp v139, v139, v139 row_mirror row_mask:0xf bank_mask:0xf
    v_mov_b32 v87, v138
    v_mov_b32 v88, v139
    s_nop 0
    v_permlane16_swap_b32 v87, v138
    v_permlane16_swap_b32 v88, v139
    v_add_f32 v138, v138, v87
    v_add_f32 v139, v139, v88
    v_mov_b32 v87, v138
    v_mov_b32 v88, v139
    s_nop 0
    v_permlane32_swap_b32 v87, v138
    v_permlane32_swap_b32 v88, v139
    v_add_f32 v138, v138, v87
    v_add_f32 v139, v139, v88
    v_mul_f32 v144, s67, v138
    v_mul_f32_e64 v146, s67, v139
    buffer_load_dword v105, v104, s[44:47], s71 offen sc0 sc1
    v_pk_add_f32 v[148:149], v[106:107], v[144:145] op_sel_hi:[1,0] neg_lo:[0,1] neg_hi:[0,1]
    v_pk_add_f32 v[150:151], v[122:123], v[146:147] op_sel_hi:[1,0] neg_lo:[0,1] neg_hi:[0,1]
    v_pk_mul_f32 v[140:141], v[148:149], v[148:149]
    v_pk_mul_f32 v[142:143], v[150:151], v[150:151]
    v_pk_add_f32 v[148:149], v[108:109], v[144:145] op_sel_hi:[1,0] neg_lo:[0,1] neg_hi:[0,1]
    v_pk_add_f32 v[150:151], v[124:125], v[146:147] op_sel_hi:[1,0] neg_lo:[0,1] neg_hi:[0,1]
    v_pk_fma_f32 v[140:141], v[148:149], v[148:149], v[140:141]
    v_pk_fma_f32 v[142:143], v[150:151], v[150:151], v[142:143]
    v_pk_add_f32 v[148:149], v[110:111], v[144:145] op_sel_hi:[1,0] neg_lo:[0,1] neg_hi:[0,1]
    v_pk_add_f32 v[150:151], v[126:127], v[146:147] op_sel_hi:[1,0] neg_lo:[0,1] neg_hi:[0,1]
    v_pk_fma_f32 v[140:141], v[148:149], v[148:149], v[140:141]
    v_pk_fma_f32 v[142:143], v[150:151], v[150:151], v[142:143]
    v_pk_add_f32 v[148:149], v[112:113], v[144:145] op_sel_hi:[1,0] neg_lo:[0,1] neg_hi:[0,1]
    v_pk_add_f32 v[150:151], v[128:129], v[146:147] op_sel_hi:[1,0] neg_lo:[0,1] neg_hi:[0,1]
    v_pk_fma_f32 v[140:141], v[148:149], v[148:149], v[140:141]
    v_pk_fma_f32 v[142:143], v[150:151], v[150:151], v[142:143]
    v_pk_add_f32 v[148:149], v[114:115], v[144:145] op_sel_hi:[1,0] neg_lo:[0,1] neg_hi:[0,1]
    v_pk_add_f32 v[150:151], v[130:131], v[146:147] op_sel_hi:[1,0] neg_lo:[0,1] neg_hi:[0,1]
    v_pk_fma_f32 v[140:141], v[148:149], v[148:149], v[140:141]
    v_pk_fma_f32 v[142:143], v[150:151], v[150:151], v[142:143]
    v_pk_add_f32 v[148:149], v[116:117], v[144:145] op_sel_hi:[1,0] neg_lo:[0,1] neg_hi:[0,1]
    v_pk_add_f32 v[150:151], v[132:133], v[146:147] op_sel_hi:[1,0] neg_lo:[0,1] neg_hi:[0,1]
    v_pk_fma_f32 v[140:141], v[148:149], v[148:149], v[140:141]
    v_pk_fma_f32 v[142:143], v[150:151], v[150:151], v[142:143]
    v_pk_add_f32 v[148:149], v[118:119], v[144:145] op_sel_hi:[1,0] neg_lo:[0,1] neg_hi:[0,1]
    v_pk_add_f32 v[150:151], v[134:135], v[146:147] op_sel_hi:[1,0] neg_lo:[0,1] neg_hi:[0,1]
    v_pk_fma_f32 v[140:141], v[148:149], v[148:149], v[140:141]
    v_pk_fma_f32 v[142:143], v[150:151], v[150:151], v[142:143]
    v_pk_add_f32 v[148:149], v[120:121], v[144:145] op_sel_hi:[1,0] neg_lo:[0,1] neg_hi:[0,1]
    v_pk_add_f32 v[150:151], v[136:137], v[146:147] op_sel_hi:[1,0] neg_lo:[0,1] neg_hi:[0,1]
    v_pk_fma_f32 v[140:141], v[148:149], v[148:149], v[140:141]
    v_pk_fma_f32 v[142:143], v[150:151], v[150:151], v[142:143]
    v_add_f32 v138, v140, v141
    v_add_f32_e64 v139, v142, v143
    s_nop 0
    v_add_f32_dpp v138, v138, v138 quad_perm:[1,0,3,2] row_mask:0xf bank_mask:0xf
    v_add_f32_dpp v139, v139, v139 quad_perm:[1,0,3,2] row_mask:0xf bank_mask:0xf
    s_nop 0
    v_add_f32_dpp v138, v138, v138 quad_perm:[2,3,0,1] row_mask:0xf bank_mask:0xf
    v_add_f32_dpp v139, v139, v139 quad_perm:[2,3,0,1] row_mask:0xf bank_mask:0xf
    s_nop 0
    v_add_f32_dpp v138, v138, v138 row_half_mirror row_mask:0xf bank_mask:0xf
    v_add_f32_dpp v139, v139, v139 row_half_mirror row_mask:0xf bank_mask:0xf
    s_nop 0
    v_add_f32_dpp v138, v138, v138 row_mirror row_mask:0xf bank_mask:0xf
    v_add_f32_dpp v139, v139, v139 row_mirror row_mask:0xf bank_mask:0xf
    v_mov_b32 v87, v138
    v_mov_b32 v88, v139
    s_nop 0
    v_permlane16_swap_b32 v87, v138
    v_permlane16_swap_b32 v88, v139
    v_add_f32 v138, v138, v87
    v_add_f32 v139, v139, v88
    v_mov_b32 v87, v138
    v_mov_b32 v88, v139
    s_nop 0
    v_permlane32_swap_b32 v87, v138
    v_permlane32_swap_b32 v88, v139
    v_add_f32 v138, v138, v87
    v_add_f32_e64 v139, v139, v88
    v_cvt_pk_bf16_f32 v144, v144, v144
    v_and_b32 v144, s66, v144
    v_mul_f32 v138, s67, v138
    v_cvt_pk_bf16_f32 v138, v138, v138
    v_and_b32_e64 v138, s66, v138
    v_add_f32 v138, 0x3727c5ac, v138
    v_cvt_pk_bf16_f32 v138, v138, v138
    v_and_b32 v138, s66, v138
    v_sqrt_f32 v138, v138
    v_cvt_pk_bf16_f32 v146, v146, v146
    v_and_b32 v146, s66, v146
    v_mul_f32 v139, s67, v139
    v_cvt_pk_bf16_f32 v139, v139, v139
    v_and_b32_e64 v139, s66, v139
    v_add_f32 v139, 0x3727c5ac, v139
    v_cvt_pk_bf16_f32 v139, v139, v139
    v_and_b32 v139, s66, v139
    v_sqrt_f32 v139, v139
    v_pk_add_f32 v[106:107], v[106:107], v[144:145] op_sel_hi:[1,0] neg_lo:[0,1] neg_hi:[0,1]
    v_pk_add_f32 v[108:109], v[108:109], v[144:145] op_sel_hi:[1,0] neg_lo:[0,1] neg_hi:[0,1]
    v_pk_add_f32 v[110:111], v[110:111], v[144:145] op_sel_hi:[1,0] neg_lo:[0,1] neg_hi:[0,1]
    v_pk_add_f32 v[112:113], v[112:113], v[144:145] op_sel_hi:[1,0] neg_lo:[0,1] neg_hi:[0,1]
    v_cvt_pk_bf16_f32 v138, v138, v138
    v_and_b32 v138, s66, v138
    v_rcp_f32 v145, v138
    v_pk_add_f32 v[122:123], v[122:123], v[146:147] op_sel_hi:[1,0] neg_lo:[0,1] neg_hi:[0,1]
    v_pk_add_f32 v[124:125], v[124:125], v[146:147] op_sel_hi:[1,0] neg_lo:[0,1] neg_hi:[0,1]
    v_pk_add_f32 v[126:127], v[126:127], v[146:147] op_sel_hi:[1,0] neg_lo:[0,1] neg_hi:[0,1]
    v_pk_add_f32 v[128:129], v[128:129], v[146:147] op_sel_hi:[1,0] neg_lo:[0,1] neg_hi:[0,1]
    v_cvt_pk_bf16_f32 v139, v139, v139
    v_and_b32 v139, s66, v139
    v_rcp_f32 v147, v139
    v_pk_mul_f32 v[106:107], v[106:107], v[144:145] op_sel:[0,1] op_sel_hi:[1,1]
    v_pk_mul_f32 v[108:109], v[108:109], v[144:145] op_sel:[0,1] op_sel_hi:[1,1]
    v_pk_mul_f32 v[110:111], v[110:111], v[144:145] op_sel:[0,1] op_sel_hi:[1,1]
    v_pk_mul_f32 v[112:113], v[112:113], v[144:145] op_sel:[0,1] op_sel_hi:[1,1]
    v_cvt_pk_bf16_f32 v68, v106, v107
    v_cvt_pk_bf16_f32 v69, v108, v109
    v_cvt_pk_bf16_f32 v70, v110, v111
    v_cvt_pk_bf16_f32 v71, v112, v113
    ds_write_b128 v84, v[68:71] offset:0
    v_pk_mul_f32 v[122:123], v[122:123], v[146:147] op_sel:[0,1] op_sel_hi:[1,1]
    v_pk_mul_f32 v[124:125], v[124:125], v[146:147] op_sel:[0,1] op_sel_hi:[1,1]
    v_pk_mul_f32 v[126:127], v[126:127], v[146:147] op_sel:[0,1] op_sel_hi:[1,1]
    v_pk_mul_f32 v[128:129], v[128:129], v[146:147] op_sel:[0,1] op_sel_hi:[1,1]
    v_cvt_pk_bf16_f32 v76, v122, v123
    v_cvt_pk_bf16_f32 v77, v124, v125
    v_cvt_pk_bf16_f32 v78, v126, v127
    v_cvt_pk_bf16_f32 v79, v128, v129
    ds_write_b128 v85, v[76:79] offset:0
    v_pk_add_f32 v[114:115], v[114:115], v[144:145] op_sel_hi:[1,0] neg_lo:[0,1] neg_hi:[0,1]
    v_pk_add_f32 v[116:117], v[116:117], v[144:145] op_sel_hi:[1,0] neg_lo:[0,1] neg_hi:[0,1]
    v_pk_add_f32 v[118:119], v[118:119], v[144:145] op_sel_hi:[1,0] neg_lo:[0,1] neg_hi:[0,1]
    v_pk_add_f32 v[120:121], v[120:121], v[144:145] op_sel_hi:[1,0] neg_lo:[0,1] neg_hi:[0,1]
    v_pk_add_f32 v[130:131], v[130:131], v[146:147] op_sel_hi:[1,0] neg_lo:[0,1] neg_hi:[0,1]
    v_pk_add_f32 v[132:133], v[132:133], v[146:147] op_sel_hi:[1,0] neg_lo:[0,1] neg_hi:[0,1]
    v_pk_add_f32 v[134:135], v[134:135], v[146:147] op_sel_hi:[1,0] neg_lo:[0,1] neg_hi:[0,1]
    v_pk_add_f32 v[136:137], v[136:137], v[146:147] op_sel_hi:[1,0] neg_lo:[0,1] neg_hi:[0,1]
    v_pk_mul_f32 v[114:115], v[114:115], v[144:145] op_sel:[0,1] op_sel_hi:[1,1]
    v_pk_mul_f32 v[116:117], v[116:117], v[144:145] op_sel:[0,1] op_sel_hi:[1,1]
    v_pk_mul_f32 v[118:119], v[118:119], v[144:145] op_sel:[0,1] op_sel_hi:[1,1]
    v_pk_mul_f32 v[120:121], v[120:121], v[144:145] op_sel:[0,1] op_sel_hi:[1,1]
    v_cvt_pk_bf16_f32 v72, v114, v115
    v_cvt_pk_bf16_f32 v73, v116, v117
    v_cvt_pk_bf16_f32 v74, v118, v119
    v_cvt_pk_bf16_f32 v75, v120, v121
    ds_write_b128 v84, v[72:75] offset:8192
    v_pk_mul_f32 v[130:131], v[130:131], v[146:147] op_sel:[0,1] op_sel_hi:[1,1]
    v_pk_mul_f32 v[132:133], v[132:133], v[146:147] op_sel:[0,1] op_sel_hi:[1,1]
    v_pk_mul_f32 v[134:135], v[134:135], v[146:147] op_sel:[0,1] op_sel_hi:[1,1]
    v_pk_mul_f32 v[136:137], v[136:137], v[146:147] op_sel:[0,1] op_sel_hi:[1,1]
    v_cvt_pk_bf16_f32 v80, v130, v131
    v_cvt_pk_bf16_f32 v81, v132, v133
    v_cvt_pk_bf16_f32 v82, v134, v135
    v_cvt_pk_bf16_f32 v83, v136, v137
    ds_write_b128 v85, v[80:83] offset:8192
    s_mov_b64 exec, 1
    buffer_store_dwordx2 v[144:145], v104, s[52:55], s62 offen sc0 sc1
    buffer_store_dwordx2 v[146:147], v104, s[52:55], s62 offen offset:64 sc0 sc1
    s_mov_b64 exec, -1
    s_mov_b32 s28, s70
    s_waitcnt lgkmcnt(0)
    s_barrier
    ds_read_b128 a[128:131], v86 offset:0
    ds_read_b128 a[132:135], v86 offset:4096
    ds_read_b128 a[136:139], v86 offset:8192
    ds_read_b128 a[140:143], v86 offset:12288
    s_waitcnt lgkmcnt(3)
    buffer_store_dwordx4 a[128:131], v231, s[40:43], s28 offen sc0 sc1
    s_add_u32 s28, s28, 0x8000
    s_lshl_b32 s67, s65, 5
    s_sub_u32 s67, s63, s67
    s_add_u32 s67, s67, 128
    s_mul_i32 s67, s67, 7168
    s_mul_i32 s21, s56, 224
    s_sub_u32 s67, s67, s21
    v_add_u32 v236, s67, v236
    s_mul_i32 s60, s65, 229376
    s_mul_i32 s67, s58, 224
    s_add_u32 s60, s60, s67
    s_lshl_b32 s66, s65, 4
    s_lshl_b32 s61, s58, 5
    s_add_u32 s61, s61, s66
    s_lshl_b32 s61, s61, 11
    s_mul_i32 s63, s26, 7168
    s_lshl_b32 s64, s26, 11
    s_mov_b32 s68, 73728
    s_add_u32 m0, s63, 0
    s_nop 0
    buffer_load_dwordx4 v242, s[32:35], s60 offen lds
    buffer_load_dwordx4 v243, s[32:35], s60 offen offset:1024 lds
    buffer_load_dwordx4 v244, s[32:35], s60 offen offset:2048 lds
    buffer_load_dwordx4 v245, s[32:35], s60 offen offset:3072 lds
    s_waitcnt vmcnt(7)
    v_cmp_eq_u32 vcc, 0, v105
    s_cbranch_vccnz f_n_slow
f_n_ok:
    v_readfirstlane_b32 s3, v105
    s_add_u32 s52, s22, 0x1c60000
    s_addc_u32 s53, s23, 0
    s_mov_b32 s54, 0x80000
    s_mov_b32 s55, 0x00020000
    s_and_b32 s3, s3, 0xfffffff0
    s_waitcnt vmcnt(4)
    v_or_b32_e64 v66, s3, 0
    s_mov_b64 exec, 1
    buffer_store_dword v66, v3, s[52:55], s20 offen sc0 sc1
    s_mov_b64 exec, -1
    v_lshrrev_b32 v228, 4, v1
    v_lshrrev_b32 v229, 2, v1
    v_and_b32 v229, 7, v229
    s_add_u32 m0, s63, 4096
    s_nop 0
    buffer_load_dwordx4 v246, s[32:35], s60 offen lds
    v_lshrrev_b32 v230, 5, v1
    v_lshl_add_u32 v229, v230, 4, v229
    v_mul_u32_u24 v229, 224, v229
    v_and_b32_e64 v230, 3, v1
    v_lshl_add_u32 v229, v230, 3, v229
    v_mov_b32_e64 v251, v229
    v_add_u32 v252, 73728, v229
    v_and_b32_e64 v229, 15, v1
    buffer_load_dwordx4 v247, s[32:35], s60 offen offset:1024 lds
    v_lshrrev_b32 v230, 1, v229
    v_xor_b32 v230, v230, v228
    v_lshlrev_b32_e64 v230, 4, v230
    v_lshl_add_u32 v230, v229, 7, v230
    v_add_u32 v253, 57344, v230
    v_xor_b32_e64 v254, 64, v253
    v_add_u32 v232, 73728, v253
    v_add_u32 v233, 73728, v254
    buffer_load_dwordx4 v248, s[32:35], s60 offen offset:2048 lds
    s_add_u32 s60, s60, 458752
    s_mov_b32 s70, 512
    s_mul_i32 s62, s69, 135168
    s_mul_i32 s66, s59, 7168
    v_cmp_gt_u32 vcc, 12, v1
    v_lshl_add_u32 v228, v1, 7, s66
    s_lshr_b32 s66, s59, 1
    v_cndmask_b32 v238, v241, v228, vcc
    s_lshl_b32 s66, s66, 12
    s_add_u32 m0, s64, 57344
    s_nop 0
    buffer_load_dwordx4 v249, s[36:39], s61 offen lds
    v_cmp_gt_u32 vcc, 32, v1
    v_lshl_add_u32 v228, v1, 7, s66
    s_and_b32 s66, s59, 127
    v_cndmask_b32 v239, v241, v228, vcc
    s_lshl_b32 s67, s26, 3
    s_add_u32 s67, s67, s27
    s_lshl_b32 s67, s67, 5
    v_and_or_b32 v255, v1, 31, s67
    buffer_load_dwordx4 v250, s[36:39], s61 offen offset:1024 lds
    s_add_u32 s61, s61, 128
    v_lshlrev_b32 v255, 8, v255
    v_lshlrev_b32 v92, 16, v92
    v_lshlrev_b32 v93, 16, v93
    v_lshlrev_b32 v94, 16, v94
    v_lshlrev_b32 v95, 16, v95
    v_lshlrev_b32 v96, 16, v96
    v_lshlrev_b32_e64 v97, 16, v97
    v_mul_f32 v96, 0x3fb8aa3b, v96
    s_add_u32 m0, s63, 28672
    s_nop 0
    buffer_load_dwordx4 v242, s[32:35], s60 offen lds
    v_mul_f32 v97, 0x3fb8aa3b, v97
    v_exp_f32 v96, v96
    v_exp_f32 v97, v97
    v_mul_f32 v160, v92, v92
    v_mul_f32_e64 v161, v93, v93
    v_cvt_pk_bf16_f32 v96, v96, v96
    v_cvt_pk_bf16_f32 v97, v97, v97
    v_and_b32 v96, 0xffff0000, v96
    buffer_load_dwordx4 v243, s[32:35], s60 offen offset:1024 lds
    v_and_b32 v97, 0xffff0000, v97
    v_mul_f32 v152, v96, v92
    v_mul_f32 v153, v97, v93
    v_mul_f32 v154, v96, v94
    v_mul_f32 v155, v97, v95
    v_mul_f32 v152, 0x3fb8aa3b, v152
    v_mul_f32 v153, 0x3fb8aa3b, v153
    v_exp_f32_e64 v152, v152
    buffer_load_dwordx4 v244, s[32:35], s60 offen offset:2048 lds
    v_exp_f32 v153, v153
    v_mul_f32 v154, 0x3e22f983, v154
    v_mul_f32 v155, 0x3e22f983, v155
    v_rndne_f32 v162, v154
    v_rndne_f32 v163, v155
    v_sub_f32 v154, v154, v162
    v_sub_f32 v155, v155, v163
    v_cos_f32 v156, v154
    buffer_load_dwordx4 v245, s[32:35], s60 offen offset:3072 lds
    v_cos_f32 v157, v155
    v_sin_f32 v158, v154
    v_sin_f32 v159, v155
    v_fmac_f32 v160, v94, v94
    v_fmac_f32 v161, v95, v95
    v_mul_f32 v156, v156, v152
    v_mul_f32 v157, v157, v153
    v_mul_f32 v158, v158, v152
    s_add_u32 m0, s63, 32768
    s_nop 0
    buffer_load_dwordx4 v246, s[32:35], s60 offen lds
    v_mul_f32 v159, v159, v153
    v_rcp_f32 v160, v160
    v_rcp_f32 v161, v161
    v_add_f32 v162, -1.0, v156
    v_add_f32 v163, -1.0, v157
    v_add_f32 v160, v160, v160
    v_add_f32 v161, v161, v161
    v_mul_f32_e64 v152, v162, v92
    buffer_load_dwordx4 v247, s[32:35], s60 offen offset:1024 lds
    v_mul_f32 v153, v163, v93
    v_fmac_f32 v152, v158, v94
    v_fmac_f32 v153, v159, v95
    v_mul_f32 v154, v158, v92
    v_mul_f32_e64 v155, v159, v93
    v_fma_f32 v154, -v162, v94, v154
    v_fma_f32 v155, -v163, v95, v155
    v_mul_f32_e64 v152, v152, v160
    buffer_load_dwordx4 v248, s[32:35], s60 offen offset:2048 lds
    s_add_u32 s60, s60, 458752
    s_add_u32 s63, s63, s68
    v_mul_f32 v153, v153, v161
    v_mul_f32 v154, v154, v160
    v_mul_f32 v155, v155, v161
    v_accvgpr_write_b32 a224, v156
    v_accvgpr_write_b32 a225, v157
    v_accvgpr_write_b32 a226, v158
    v_accvgpr_write_b32 a227, v159
    v_accvgpr_write_b32 a228, v152
    s_add_u32 m0, s64, 65536
    s_nop 0
    s_nop 0
    buffer_load_dwordx4 v249, s[36:39], s61 offen lds
    v_accvgpr_write_b32 a229, v153
    v_accvgpr_write_b32 a230, v154
    v_accvgpr_write_b32 a231, v155
    v_pk_mul_f32 v[164:165], v[156:157], v[156:157]
    v_pk_mul_f32 v[166:167], v[156:157], v[158:159]
    v_pk_fma_f32 v[164:165], v[158:159], v[158:159], v[164:165] neg_lo:[1,0,0] neg_hi:[1,0,0]
    v_pk_add_f32 v[166:167], v[166:167], v[166:167]
    v_pk_mul_f32 v[168:169], v[164:165], v[164:165]
    buffer_load_dwordx4 v250, s[36:39], s61 offen offset:1024 lds
    s_add_u32 s61, s61, 128
    s_add_u32 s64, s64, s68
    s_sub_u32 s68, 0, s68
    v_pk_mul_f32 v[170:171], v[164:165], v[166:167]
    v_pk_fma_f32 v[168:169], v[166:167], v[166:167], v[168:169] neg_lo:[1,0,0] neg_hi:[1,0,0]
    v_pk_add_f32 v[170:171], v[170:171], v[170:171]
    v_pk_mul_f32 v[164:165], v[168:169], v[168:169]
    v_pk_mul_f32 v[166:167], v[168:169], v[170:171]
    v_pk_fma_f32 v[164:165], v[170:171], v[170:171], v[164:165] neg_lo:[1,0,0] neg_hi:[1,0,0]
    v_pk_add_f32 v[166:167], v[166:167], v[166:167]
    v_accvgpr_write_b32 a232, v164
    v_accvgpr_write_b32 a233, v165
    v_accvgpr_write_b32 a234, v166
    v_accvgpr_write_b32 a235, v167
    v_pk_mul_f32 v[168:169], v[164:165], v[164:165]
    v_pk_mul_f32 v[170:171], v[164:165], v[166:167]
    v_pk_fma_f32 v[168:169], v[166:167], v[166:167], v[168:169] neg_lo:[1,0,0] neg_hi:[1,0,0]
    v_pk_add_f32 v[170:171], v[170:171], v[170:171]
    v_accvgpr_write_b32 a236, v168
    v_accvgpr_write_b32 a237, v169
    v_accvgpr_write_b32 a238, v170
    v_accvgpr_write_b32 a239, v171
    v_pk_mul_f32 v[164:165], v[168:169], v[168:169]
    v_pk_mul_f32 v[166:167], v[168:169], v[170:171]
    v_pk_fma_f32 v[164:165], v[170:171], v[170:171], v[164:165] neg_lo:[1,0,0] neg_hi:[1,0,0]
    v_pk_add_f32 v[166:167], v[166:167], v[166:167]
    v_pk_mul_f32 v[168:169], v[164:165], v[164:165]
    v_pk_mul_f32 v[170:171], v[164:165], v[166:167]
    v_pk_fma_f32 v[168:169], v[166:167], v[166:167], v[168:169] neg_lo:[1,0,0] neg_hi:[1,0,0]
    v_pk_add_f32 v[170:171], v[170:171], v[170:171]
    v_accvgpr_write_b32 a240, v168
    v_accvgpr_write_b32 a241, v169
    v_accvgpr_write_b32 a242, v170
    v_accvgpr_write_b32 a243, v171
    v_pk_mul_f32 v[164:165], v[168:169], v[168:169]
    v_pk_mul_f32 v[166:167], v[168:169], v[170:171]
    v_pk_fma_f32 v[164:165], v[170:171], v[170:171], v[164:165] neg_lo:[1,0,0] neg_hi:[1,0,0]
    v_pk_add_f32 v[166:167], v[166:167], v[166:167]
    v_pk_mul_f32 v[168:169], v[164:165], v[164:165]
    v_pk_mul_f32 v[170:171], v[164:165], v[166:167]
    v_pk_fma_f32 v[168:169], v[166:167], v[166:167], v[168:169] neg_lo:[1,0,0] neg_hi:[1,0,0]
    v_pk_add_f32 v[170:171], v[170:171], v[170:171]
    v_pk_mul_f32 v[164:165], v[168:169], v[168:169]
    v_pk_mul_f32 v[166:167], v[168:169], v[170:171]
    v_pk_fma_f32 v[164:165], v[170:171], v[170:171], v[164:165] neg_lo:[1,0,0] neg_hi:[1,0,0]
    v_pk_add_f32 v[166:167], v[166:167], v[166:167]
    v_accvgpr_write_b32 a244, v164
    v_accvgpr_write_b32 a245, v165
    v_accvgpr_write_b32 a246, v166
    v_accvgpr_write_b32 a247, v167
    buffer_load_dword v67, v255, s[52:55], 0 offen sc0 sc1
    s_lshl_b32 s66, s66, 2
    v_and_b32 v228, 3, v1
    v_add_u32 v228, s66, v228
    s_getpc_b64 s[72:73]
L_pc2:
    s_add_u32 s72, s72, fa_tail-L_pc2
    s_addc_u32 s73, s73, (fa_tail-L_pc2)>>32
    v_lshlrev_b32 v229, 7, v228
    v_min_u32 v229, code_end-fa_tail-4, v229
    v_mov_b32 v235, s73
    v_add_co_u32 v234, vcc, s72, v229
    s_nop 1
    v_addc_co_u32 v235, vcc, 0, v235, vcc
    s_bitcmp1_b32 s26, 0
    s_cselect_b32 s44, s14, s12
    s_cselect_b32 s45, s15, s13
    s_mov_b32 s46, 2097152
    s_mov_b32 s48, s16
    s_mov_b32 s49, s17
    s_mov_b32 s50, 0x700000
    s_mov_b32 s51, 0x00020000
    s_add_u32 s21, s3, 0
    s_waitcnt vmcnt(0)
    v_subrev_u32 v67, s21, v67
    v_cmp_lt_u32 vcc, 15, v67
    s_cbranch_vccnz f_fl_slow
f_fl_ok:
    s_add_u32 s66, s62, 4096
    buffer_load_dwordx4 a[0:3], v2, s[40:43], s62 offen sc1
    buffer_load_dwordx4 a[16:19], v2, s[40:43], s66 offen sc1
    buffer_load_dwordx4 a[4:7], v2, s[40:43], s62 offen offset:1024 sc1
    buffer_load_dwordx4 a[20:23], v2, s[40:43], s66 offen offset:1024 sc1
    buffer_load_dwordx4 a[8:11], v2, s[40:43], s62 offen offset:2048 sc1
    buffer_load_dwordx4 a[24:27], v2, s[40:43], s66 offen offset:2048 sc1
    buffer_load_dwordx4 a[12:15], v2, s[40:43], s62 offen offset:3072 sc1
    buffer_load_dwordx4 a[28:31], v2, s[40:43], s66 offen offset:3072 sc1
    s_add_u32 s62, s62, 8192
    s_waitcnt vmcnt(9) lgkmcnt(0)
    s_barrier
    ds_read_b64_tr_b16 a[160:161], v251 offset:0
    ds_read_b64_tr_b16 a[162:163], v251 offset:1792
    ds_read_b64_tr_b16 a[164:165], v251 offset:7168
    ds_read_b64_tr_b16 a[166:167], v251 offset:8960
    ds_read_b64_tr_b16 a[168:169], v251 offset:14336
    ds_read_b64_tr_b16 a[170:171], v251 offset:16128
    ds_read_b64_tr_b16 a[172:173], v251 offset:21504
    ds_read_b64_tr_b16 a[174:175], v251 offset:23296
    s_waitcnt vmcnt(4)
    s_waitcnt lgkmcnt(4)
    v_mfma_f32_16x16x32_bf16 v[68:71], a[160:163], a[0:3], 0
    ds_read_b64_tr_b16 a[176:177], v251 offset:32
    v_mfma_f32_16x16x32_bf16 v[68:71], a[164:167], a[16:19], v[68:71]
    buffer_load_dwordx4 a[32:35], v2, s[40:43], s62 offen sc1
    v_mfma_f32_16x16x32_bf16 v[72:75], a[164:167], a[20:23], 0
    ds_read_b64_tr_b16 a[178:179], v251 offset:1824
    v_mfma_f32_16x16x32_bf16 v[72:75], a[160:163], a[4:7], v[72:75]
    s_waitcnt vmcnt(1)
    v_mfma_f32_16x16x32_bf16 v[76:79], a[160:163], a[8:11], 0
    ds_read_b64_tr_b16 a[180:181], v251 offset:7200
    v_mfma_f32_16x16x32_bf16 v[76:79], a[164:167], a[24:27], v[76:79]
    buffer_load_dwordx4 a[36:39], v2, s[40:43], s62 offen offset:1024 sc1
    v_mfma_f32_16x16x32_bf16 v[80:83], a[164:167], a[28:31], 0
    ds_read_b64_tr_b16 a[182:183], v251 offset:8992
    v_mfma_f32_16x16x32_bf16 v[80:83], a[160:163], a[12:15], v[80:83]
    s_waitcnt lgkmcnt(4)
    v_mfma_f32_16x16x32_bf16 v[96:99], a[168:171], a[12:15], 0
    ds_read_b64_tr_b16 a[160:161], v251 offset:14368
    v_mfma_f32_16x16x32_bf16 v[96:99], a[172:175], a[28:31], v[96:99]
    buffer_load_dwordx4 a[40:43], v2, s[40:43], s62 offen offset:2048 sc1
    v_mfma_f32_16x16x32_bf16 v[92:95], a[172:175], a[24:27], 0
    ds_read_b64_tr_b16 a[162:163], v251 offset:16160
    v_mfma_f32_16x16x32_bf16 v[92:95], a[168:171], a[8:11], v[92:95]
    v_mfma_f32_16x16x32_bf16 v[88:91], a[168:171], a[4:7], 0
    ds_read_b64_tr_b16 a[164:165], v251 offset:21536
    v_mfma_f32_16x16x32_bf16 v[88:91], a[172:175], a[20:23], v[88:91]
    buffer_load_dwordx4 a[44:47], v2, s[40:43], s62 offen offset:3072 sc1
    v_mfma_f32_16x16x32_bf16 v[84:87], a[172:175], a[16:19], 0
    ds_read_b64_tr_b16 a[166:167], v251 offset:23328
    v_mfma_f32_16x16x32_bf16 v[84:87], a[168:171], a[0:3], v[84:87]
    s_add_u32 s62, s62, 4096
    s_waitcnt lgkmcnt(4)
    v_mfma_f32_16x16x32_bf16 v[100:103], a[176:179], a[0:3], 0
    ds_read_b64_tr_b16 a[168:169], v251 offset:64
    v_mfma_f32_16x16x32_bf16 v[100:103], a[180:183], a[16:19], v[100:103]
    v_mfma_f32_16x16x32_bf16 v[104:107], a[180:183], a[20:23], 0
    ds_read_b64_tr_b16 a[170:171], v251 offset:1856
    v_mfma_f32_16x16x32_bf16 v[104:107], a[176:179], a[4:7], v[104:107]
    v_mfma_f32_16x16x32_bf16 v[108:111], a[176:179], a[8:11], 0
    ds_read_b64_tr_b16 a[172:173], v251 offset:7232
    v_mfma_f32_16x16x32_bf16 v[108:111], a[180:183], a[24:27], v[108:111]
    buffer_load_dwordx4 a[48:51], v2, s[40:43], s62 offen sc1
    v_mfma_f32_16x16x32_bf16 v[112:115], a[180:183], a[28:31], 0
    ds_read_b64_tr_b16 a[174:175], v251 offset:9024
    v_mfma_f32_16x16x32_bf16 v[112:115], a[176:179], a[12:15], v[112:115]
    s_waitcnt lgkmcnt(4)
    v_mfma_f32_16x16x32_bf16 v[128:131], a[160:163], a[12:15], 0
    ds_read_b64_tr_b16 a[176:177], v251 offset:14400
    v_mfma_f32_16x16x32_bf16 v[128:131], a[164:167], a[28:31], v[128:131]
    buffer_load_dwordx4 a[52:55], v2, s[40:43], s62 offen offset:1024 sc1
    v_mfma_f32_16x16x32_bf16 v[124:127], a[164:167], a[24:27], 0
    ds_read_b64_tr_b16 a[178:179], v251 offset:16192
    v_mfma_f32_16x16x32_bf16 v[124:127], a[160:163], a[8:11], v[124:127]
    v_mfma_f32_16x16x32_bf16 v[120:123], a[160:163], a[4:7], 0
    ds_read_b64_tr_b16 a[180:181], v251 offset:21568
    v_mfma_f32_16x16x32_bf16 v[120:123], a[164:167], a[20:23], v[120:123]
    buffer_load_dwordx4 a[56:59], v2, s[40:43], s62 offen offset:2048 sc1
    v_mfma_f32_16x16x32_bf16 v[116:119], a[164:167], a[16:19], 0
    ds_read_b64_tr_b16 a[182:183], v251 offset:23360
    v_mfma_f32_16x16x32_bf16 v[116:119], a[160:163], a[0:3], v[116:119]
    s_waitcnt lgkmcnt(4)
    v_mfma_f32_16x16x32_bf16 a[64:67], a[168:171], a[0:3], 0
    ds_read_b64_tr_b16 a[160:161], v251 offset:96
    v_mfma_f32_16x16x32_bf16 a[64:67], a[172:175], a[16:19], a[64:67]
    buffer_load_dwordx4 a[60:63], v2, s[40:43], s62 offen offset:3072 sc1
    v_mfma_f32_16x16x32_bf16 a[68:71], a[172:175], a[20:23], 0
    ds_read_b64_tr_b16 a[162:163], v251 offset:1888
    v_mfma_f32_16x16x32_bf16 a[68:71], a[168:171], a[4:7], a[68:71]
    s_add_u32 s62, s62, 4096
    v_mfma_f32_16x16x32_bf16 a[72:75], a[168:171], a[8:11], 0
    ds_read_b64_tr_b16 a[164:165], v251 offset:7264
    v_mfma_f32_16x16x32_bf16 a[72:75], a[172:175], a[24:27], a[72:75]
    v_mfma_f32_16x16x32_bf16 a[76:79], a[172:175], a[28:31], 0
    ds_read_b64_tr_b16 a[166:167], v251 offset:9056
    v_mfma_f32_16x16x32_bf16 a[76:79], a[168:171], a[12:15], a[76:79]
    s_waitcnt lgkmcnt(4)
    v_mfma_f32_16x16x32_bf16 a[92:95], a[176:179], a[12:15], 0
    ds_read_b64_tr_b16 a[168:169], v251 offset:14432
    v_mfma_f32_16x16x32_bf16 a[92:95], a[180:183], a[28:31], a[92:95]
    buffer_store_dwordx4 a[132:135], v231, s[40:43], s28 offen sc0 sc1
    v_mfma_f32_16x16x32_bf16 a[88:91], a[180:183], a[24:27], 0
    ds_read_b64_tr_b16 a[170:171], v251 offset:16224
    v_mfma_f32_16x16x32_bf16 a[88:91], a[176:179], a[8:11], a[88:91]
    s_add_u32 s28, s28, 0x8000
    v_mfma_f32_16x16x32_bf16 a[84:87], a[176:179], a[4:7], 0
    ds_read_b64_tr_b16 a[172:173], v251 offset:21600
    v_mfma_f32_16x16x32_bf16 a[84:87], a[180:183], a[20:23], a[84:87]
    buffer_store_dwordx4 a[136:139], v231, s[40:43], s28 offen sc0 sc1
    v_mfma_f32_16x16x32_bf16 a[80:83], a[180:183], a[16:19], 0
    ds_read_b64_tr_b16 a[174:175], v251 offset:23392
    v_mfma_f32_16x16x32_bf16 a[80:83], a[176:179], a[0:3], a[80:83]
    s_add_u32 s28, s28, 0x8000
    s_waitcnt lgkmcnt(4)
    v_mfma_f32_16x16x32_bf16 a[96:99], a[160:163], a[0:3], 0
    ds_read_b64_tr_b16 a[176:177], v251 offset:128
    v_mfma_f32_16x16x32_bf16 a[96:99], a[164:167], a[16:19], a[96:99]
    buffer_store_dwordx4 a[140:143], v231, s[40:43], s28 offen sc0 sc1
    v_mfma_f32_16x16x32_bf16 a[100:103], a[164:167], a[20:23], 0
    ds_read_b64_tr_b16 a[178:179], v251 offset:1920
    v_mfma_f32_16x16x32_bf16 a[100:103], a[160:163], a[4:7], a[100:103]
    v_mfma_f32_16x16x32_bf16 a[104:107], a[160:163], a[8:11], 0
    ds_read_b64_tr_b16 a[180:181], v251 offset:7296
    v_mfma_f32_16x16x32_bf16 a[104:107], a[164:167], a[24:27], a[104:107]
    buffer_load_dword v240, v236, s[32:35], s60 offen
    v_mfma_f32_16x16x32_bf16 a[108:111], a[164:167], a[28:31], 0
    ds_read_b64_tr_b16 a[182:183], v251 offset:9088
    v_mfma_f32_16x16x32_bf16 a[108:111], a[160:163], a[12:15], a[108:111]
    s_waitcnt lgkmcnt(4)
    v_mfma_f32_16x16x32_bf16 a[124:127], a[168:171], a[12:15], 0
    ds_read_b64_tr_b16 a[160:161], v251 offset:14464
    v_mfma_f32_16x16x32_bf16 a[124:127], a[172:175], a[28:31], a[124:127]
    buffer_load_dword v240, v237, s[36:39], s70 offen
    v_mfma_f32_16x16x32_bf16 a[120:123], a[172:175], a[24:27], 0
    ds_read_b64_tr_b16 a[162:163], v251 offset:16256
    v_mfma_f32_16x16x32_bf16 a[120:123], a[168:171], a[8:11], a[120:123]
    s_add_u32 s70, s70, 256
    v_mfma_f32_16x16x32_bf16 a[116:119], a[168:171], a[4:7], 0
    ds_read_b64_tr_b16 a[164:165], v251 offset:21632
    v_mfma_f32_16x16x32_bf16 a[116:119], a[172:175], a[20:23], a[116:119]
    v_mfma_f32_16x16x32_bf16 a[112:115], a[172:175], a[16:19], 0
    ds_read_b64_tr_b16 a[166:167], v251 offset:23424
    v_mfma_f32_16x16x32_bf16 a[112:115], a[168:171], a[0:3], a[112:115]
    s_waitcnt lgkmcnt(4)
    v_mfma_f32_16x16x32_bf16 v[132:135], a[176:179], a[0:3], 0
    ds_read_b64_tr_b16 a[168:169], v251 offset:160
    v_mfma_f32_16x16x32_bf16 v[132:135], a[180:183], a[16:19], v[132:135]
    v_mfma_f32_16x16x32_bf16 v[136:139], a[180:183], a[20:23], 0
    ds_read_b64_tr_b16 a[170:171], v251 offset:1952
    v_mfma_f32_16x16x32_bf16 v[136:139], a[176:179], a[4:7], v[136:139]
    v_mfma_f32_16x16x32_bf16 v[140:143], a[176:179], a[8:11], 0
    ds_read_b64_tr_b16 a[172:173], v251 offset:7328
    v_mfma_f32_16x16x32_bf16 v[140:143], a[180:183], a[24:27], v[140:143]
    v_mfma_f32_16x16x32_bf16 v[144:147], a[180:183], a[28:31], 0
    ds_read_b64_tr_b16 a[174:175], v251 offset:9120
    v_mfma_f32_16x16x32_bf16 v[144:147], a[176:179], a[12:15], v[144:147]
    s_waitcnt lgkmcnt(4)
    v_mfma_f32_16x16x32_bf16 v[160:163], a[160:163], a[12:15], 0
    ds_read_b64_tr_b16 a[176:177], v251 offset:14496
    v_mfma_f32_16x16x32_bf16 v[160:163], a[164:167], a[28:31], v[160:163]
    v_mfma_f32_16x16x32_bf16 v[156:159], a[164:167], a[24:27], 0
    ds_read_b64_tr_b16 a[178:179], v251 offset:16288
    v_mfma_f32_16x16x32_bf16 v[156:159], a[160:163], a[8:11], v[156:159]
    v_mfma_f32_16x16x32_bf16 v[152:155], a[160:163], a[4:7], 0
    ds_read_b64_tr_b16 a[180:181], v251 offset:21664
    v_mfma_f32_16x16x32_bf16 v[152:155], a[164:167], a[20:23], v[152:155]
    v_mfma_f32_16x16x32_bf16 v[148:151], a[164:167], a[16:19], 0
    ds_read_b64_tr_b16 a[182:183], v251 offset:23456
    v_mfma_f32_16x16x32_bf16 v[148:151], a[160:163], a[0:3], v[148:151]
    s_waitcnt lgkmcnt(4)
    v_mfma_f32_16x16x32_bf16 v[164:167], a[168:171], a[0:3], 0
    ds_read_b64_tr_b16 a[160:161], v251 offset:192
    v_mfma_f32_16x16x32_bf16 v[164:167], a[172:175], a[16:19], v[164:167]
    v_mfma_f32_16x16x32_bf16 v[168:171], a[172:175], a[20:23], 0
    ds_read_b64_tr_b16 a[162:163], v251 offset:1984
    v_mfma_f32_16x16x32_bf16 v[168:171], a[168:171], a[4:7], v[168:171]
    v_mfma_f32_16x16x32_bf16 v[172:175], a[168:171], a[8:11], 0
    ds_read_b64_tr_b16 a[164:165], v251 offset:7360
    v_mfma_f32_16x16x32_bf16 v[172:175], a[172:175], a[24:27], v[172:175]
    v_mfma_f32_16x16x32_bf16 v[176:179], a[172:175], a[28:31], 0
    ds_read_b64_tr_b16 a[166:167], v251 offset:9152
    v_mfma_f32_16x16x32_bf16 v[176:179], a[168:171], a[12:15], v[176:179]
    s_waitcnt lgkmcnt(4)
    v_mfma_f32_16x16x32_bf16 v[192:195], a[176:179], a[12:15], 0
    ds_read_b64_tr_b16 a[168:169], v251 offset:14528
    v_mfma_f32_16x16x32_bf16 v[192:195], a[180:183], a[28:31], v[192:195]
    v_mfma_f32_16x16x32_bf16 v[188:191], a[180:183], a[24:27], 0
    ds_read_b64_tr_b16 a[170:171], v251 offset:16320
    v_mfma_f32_16x16x32_bf16 v[188:191], a[176:179], a[8:11], v[188:191]
    v_mfma_f32_16x16x32_bf16 v[184:187], a[176:179], a[4:7], 0
    ds_read_b64_tr_b16 a[172:173], v251 offset:21696
    v_mfma_f32_16x16x32_bf16 v[184:187], a[180:183], a[20:23], v[184:187]
    v_mfma_f32_16x16x32_bf16 v[180:183], a[180:183], a[16:19], 0
    ds_read_b64_tr_b16 a[174:175], v251 offset:23488
    v_mfma_f32_16x16x32_bf16 v[180:183], a[176:179], a[0:3], v[180:183]
    s_waitcnt lgkmcnt(4)
    v_mfma_f32_16x16x32_bf16 v[196:199], a[160:163], a[0:3], 0
    ds_read_b128 a[176:179], v253 offset:0
    v_mfma_f32_16x16x32_bf16 v[196:199], a[164:167], a[16:19], v[196:199]
    v_mfma_f32_16x16x32_bf16 v[200:203], a[164:167], a[20:23], 0
    v_mfma_f32_16x16x32_bf16 v[200:203], a[160:163], a[4:7], v[200:203]
    v_mfma_f32_16x16x32_bf16 v[204:207], a[160:163], a[8:11], 0
    ds_read_b128 a[180:183], v254 offset:0
    s_add_u32 m0, s63, 0
    v_mfma_f32_16x16x32_bf16 v[204:207], a[164:167], a[24:27], v[204:207]
    buffer_load_dwordx4 v242, s[32:35], s60 offen lds
    v_mfma_f32_16x16x32_bf16 v[208:211], a[164:167], a[28:31], 0
    v_mfma_f32_16x16x32_bf16 v[208:211], a[160:163], a[12:15], v[208:211]
    s_waitcnt lgkmcnt(2)
    v_mfma_f32_16x16x32_bf16 v[224:227], a[168:171], a[12:15], 0
    ds_read_b128 a[160:163], v253 offset:4096
    v_mfma_f32_16x16x32_bf16 v[224:227], a[172:175], a[28:31], v[224:227]
    buffer_load_dwordx4 v243, s[32:35], s60 offen offset:1024 lds
    v_mfma_f32_16x16x32_bf16 v[220:223], a[172:175], a[24:27], 0
    v_mfma_f32_16x16x32_bf16 v[220:223], a[168:171], a[8:11], v[220:223]
    v_mfma_f32_16x16x32_bf16 v[216:219], a[168:171], a[4:7], 0
    ds_read_b128 a[164:167], v254 offset:4096
    v_mfma_f32_16x16x32_bf16 v[216:219], a[172:175], a[20:23], v[216:219]
    buffer_load_dwordx4 v244, s[32:35], s60 offen offset:2048 lds
    v_mfma_f32_16x16x32_bf16 v[212:215], a[172:175], a[16:19], 0
    v_mfma_f32_16x16x32_bf16 v[212:215], a[168:171], a[0:3], v[212:215]
    s_waitcnt lgkmcnt(2)
    v_mfma_f32_16x16x32_bf16 v[4:7], a[0:3], a[176:179], 0
    ds_read_b128 a[168:171], v253 offset:2048
    v_mfma_f32_16x16x32_bf16 v[4:7], a[16:19], a[180:183], v[4:7]
    buffer_load_dwordx4 v245, s[32:35], s60 offen offset:3072 lds
    v_mfma_f32_16x16x32_bf16 v[8:11], a[20:23], a[180:183], 0
    v_mfma_f32_16x16x32_bf16 v[8:11], a[4:7], a[176:179], v[8:11]
    v_mfma_f32_16x16x32_bf16 v[12:15], a[8:11], a[176:179], 0
    ds_read_b128 a[172:175], v254 offset:2048
    s_add_u32 m0, s63, 4096
    v_mfma_f32_16x16x32_bf16 v[12:15], a[24:27], a[180:183], v[12:15]
    buffer_load_dwordx4 v246, s[32:35], s60 offen lds
    v_mfma_f32_16x16x32_bf16 v[16:19], a[28:31], a[180:183], 0
    v_mfma_f32_16x16x32_bf16 v[16:19], a[12:15], a[176:179], v[16:19]
    s_waitcnt lgkmcnt(2)
    v_mfma_f32_16x16x32_bf16 v[48:51], a[12:15], a[160:163], 0
    ds_read_b128 a[176:179], v253 offset:6144
    v_mfma_f32_16x16x32_bf16 v[48:51], a[28:31], a[164:167], v[48:51]
    v_mfma_f32_16x16x32_bf16 v[44:47], a[24:27], a[164:167], 0
    v_mfma_f32_16x16x32_bf16 v[44:47], a[8:11], a[160:163], v[44:47]
    v_mfma_f32_16x16x32_bf16 v[40:43], a[4:7], a[160:163], 0
    ds_read_b128 a[180:183], v254 offset:6144
    v_mfma_f32_16x16x32_bf16 v[40:43], a[20:23], a[164:167], v[40:43]
    buffer_load_dwordx4 v247, s[32:35], s60 offen offset:1024 lds
    v_mfma_f32_16x16x32_bf16 v[36:39], a[16:19], a[164:167], 0
    v_mfma_f32_16x16x32_bf16 v[36:39], a[0:3], a[160:163], v[36:39]
    s_waitcnt vmcnt(28) lgkmcnt(2)
    s_barrier
    v_mfma_f32_16x16x32_bf16 v[20:23], a[0:3], a[168:171], 0
    ds_read_b64_tr_b16 a[160:161], v251 offset:28672
    v_mfma_f32_16x16x32_bf16 v[20:23], a[16:19], a[172:175], v[20:23]
    buffer_load_dwordx4 v248, s[32:35], s60 offen offset:2048 lds
    v_mfma_f32_16x16x32_bf16 v[24:27], a[20:23], a[172:175], 0
    ds_read_b64_tr_b16 a[162:163], v251 offset:30464
    v_mfma_f32_16x16x32_bf16 v[24:27], a[4:7], a[168:171], v[24:27]
    s_add_u32 s60, s60, 458752
    v_mfma_f32_16x16x32_bf16 v[28:31], a[8:11], a[168:171], 0
    ds_read_b64_tr_b16 a[164:165], v251 offset:35840
    s_add_u32 m0, s64, 57344
    v_mfma_f32_16x16x32_bf16 v[28:31], a[24:27], a[172:175], v[28:31]
    buffer_load_dwordx4 v249, s[36:39], s61 offen lds
    v_mfma_f32_16x16x32_bf16 v[32:35], a[28:31], a[172:175], 0
    ds_read_b64_tr_b16 a[166:167], v251 offset:37632
    v_mfma_f32_16x16x32_bf16 v[32:35], a[12:15], a[168:171], v[32:35]
    s_waitcnt lgkmcnt(4)
    v_mfma_f32_16x16x32_bf16 v[64:67], a[12:15], a[176:179], 0
    ds_read_b64_tr_b16 a[168:169], v251 offset:43008
    v_mfma_f32_16x16x32_bf16 v[64:67], a[28:31], a[180:183], v[64:67]
    buffer_load_dwordx4 v250, s[36:39], s61 offen offset:1024 lds
    v_mfma_f32_16x16x32_bf16 v[60:63], a[24:27], a[180:183], 0
    ds_read_b64_tr_b16 a[170:171], v251 offset:44800
    v_mfma_f32_16x16x32_bf16 v[60:63], a[8:11], a[176:179], v[60:63]
    s_add_u32 s61, s61, 128
    v_mfma_f32_16x16x32_bf16 v[56:59], a[4:7], a[176:179], 0
    ds_read_b64_tr_b16 a[172:173], v251 offset:50176
    v_mfma_f32_16x16x32_bf16 v[56:59], a[20:23], a[180:183], v[56:59]
    v_mfma_f32_16x16x32_bf16 v[52:55], a[16:19], a[180:183], 0
    ds_read_b64_tr_b16 a[174:175], v251 offset:51968
    v_mfma_f32_16x16x32_bf16 v[52:55], a[0:3], a[176:179], v[52:55]
    s_waitcnt vmcnt(11)
    v_or_b32_e64 v230, s3, 1
    s_mov_b64 exec, 1
    buffer_store_dword v230, v3, s[52:55], s20 offen sc0 sc1
    s_mov_b64 exec, -1
    s_waitcnt vmcnt(15) lgkmcnt(4)
    v_mfma_f32_16x16x32_bf16 v[68:71], a[160:163], a[32:35], v[68:71]
    ds_read_b64_tr_b16 a[176:177], v251 offset:28704
    v_mfma_f32_16x16x32_bf16 v[68:71], a[164:167], a[48:51], v[68:71]
    v_mfma_f32_16x16x32_bf16 v[72:75], a[164:167], a[52:55], v[72:75]
    ds_read_b64_tr_b16 a[178:179], v251 offset:30496
    v_mfma_f32_16x16x32_bf16 v[72:75], a[160:163], a[36:39], v[72:75]
    v_mfma_f32_16x16x32_bf16 v[76:79], a[160:163], a[40:43], v[76:79]
    ds_read_b64_tr_b16 a[180:181], v251 offset:35872
    v_mfma_f32_16x16x32_bf16 v[76:79], a[164:167], a[56:59], v[76:79]
    v_mfma_f32_16x16x32_bf16 v[80:83], a[164:167], a[60:63], v[80:83]
    ds_read_b64_tr_b16 a[182:183], v251 offset:37664
    v_mfma_f32_16x16x32_bf16 v[80:83], a[160:163], a[44:47], v[80:83]
    s_waitcnt lgkmcnt(4)
    v_mfma_f32_16x16x32_bf16 v[96:99], a[168:171], a[44:47], v[96:99]
    ds_read_b64_tr_b16 a[160:161], v251 offset:43040
    v_mfma_f32_16x16x32_bf16 v[96:99], a[172:175], a[60:63], v[96:99]
    buffer_load_dwordx4 a[0:3], v2, s[40:43], s62 offen sc1
    v_mfma_f32_16x16x32_bf16 v[92:95], a[172:175], a[56:59], v[92:95]
    ds_read_b64_tr_b16 a[162:163], v251 offset:44832
    v_mfma_f32_16x16x32_bf16 v[92:95], a[168:171], a[40:43], v[92:95]
    v_mfma_f32_16x16x32_bf16 v[88:91], a[168:171], a[36:39], v[88:91]
    ds_read_b64_tr_b16 a[164:165], v251 offset:50208
    v_mfma_f32_16x16x32_bf16 v[88:91], a[172:175], a[52:55], v[88:91]
    buffer_load_dwordx4 a[4:7], v2, s[40:43], s62 offen offset:1024 sc1
    v_mfma_f32_16x16x32_bf16 v[84:87], a[172:175], a[48:51], v[84:87]
    ds_read_b64_tr_b16 a[166:167], v251 offset:52000
    v_mfma_f32_16x16x32_bf16 v[84:87], a[168:171], a[32:35], v[84:87]
    s_waitcnt lgkmcnt(4)
    v_mfma_f32_16x16x32_bf16 v[100:103], a[176:179], a[32:35], v[100:103]
    ds_read_b64_tr_b16 a[168:169], v251 offset:28736
    v_mfma_f32_16x16x32_bf16 v[100:103], a[180:183], a[48:51], v[100:103]
    v_mfma_f32_16x16x32_bf16 v[104:107], a[180:183], a[52:55], v[104:107]
    ds_read_b64_tr_b16 a[170:171], v251 offset:30528
    v_mfma_f32_16x16x32_bf16 v[104:107], a[176:179], a[36:39], v[104:107]
    v_mfma_f32_16x16x32_bf16 v[108:111], a[176:179], a[40:43], v[108:111]
    ds_read_b64_tr_b16 a[172:173], v251 offset:35904
    v_mfma_f32_16x16x32_bf16 v[108:111], a[180:183], a[56:59], v[108:111]
    buffer_load_dwordx4 a[8:11], v2, s[40:43], s62 offen offset:2048 sc1
    v_mfma_f32_16x16x32_bf16 v[112:115], a[180:183], a[60:63], v[112:115]
    ds_read_b64_tr_b16 a[174:175], v251 offset:37696
    v_mfma_f32_16x16x32_bf16 v[112:115], a[176:179], a[44:47], v[112:115]
    s_waitcnt lgkmcnt(4)
    v_mfma_f32_16x16x32_bf16 v[128:131], a[160:163], a[44:47], v[128:131]
    ds_read_b64_tr_b16 a[176:177], v251 offset:43072
    v_mfma_f32_16x16x32_bf16 v[128:131], a[164:167], a[60:63], v[128:131]
    v_mfma_f32_16x16x32_bf16 v[124:127], a[164:167], a[56:59], v[124:127]
    ds_read_b64_tr_b16 a[178:179], v251 offset:44864
    v_mfma_f32_16x16x32_bf16 v[124:127], a[160:163], a[40:43], v[124:127]
    v_mfma_f32_16x16x32_bf16 v[120:123], a[160:163], a[36:39], v[120:123]
    ds_read_b64_tr_b16 a[180:181], v251 offset:50240
    v_mfma_f32_16x16x32_bf16 v[120:123], a[164:167], a[52:55], v[120:123]
    buffer_load_dwordx4 a[12:15], v2, s[40:43], s62 offen offset:3072 sc1
    v_mfma_f32_16x16x32_bf16 v[116:119], a[164:167], a[48:51], v[116:119]
    ds_read_b64_tr_b16 a[182:183], v251 offset:52032
    v_mfma_f32_16x16x32_bf16 v[116:119], a[160:163], a[32:35], v[116:119]
    s_add_u32 s62, s62, 4096
    s_waitcnt lgkmcnt(4)
    v_mfma_f32_16x16x32_bf16 a[64:67], a[168:171], a[32:35], a[64:67]
    ds_read_b64_tr_b16 a[160:161], v251 offset:28768
    v_mfma_f32_16x16x32_bf16 a[64:67], a[172:175], a[48:51], a[64:67]
    v_mfma_f32_16x16x32_bf16 a[68:71], a[172:175], a[52:55], a[68:71]
    ds_read_b64_tr_b16 a[162:163], v251 offset:30560
    v_mfma_f32_16x16x32_bf16 a[68:71], a[168:171], a[36:39], a[68:71]
    v_mfma_f32_16x16x32_bf16 a[72:75], a[168:171], a[40:43], a[72:75]
    ds_read_b64_tr_b16 a[164:165], v251 offset:35936
    v_mfma_f32_16x16x32_bf16 a[72:75], a[172:175], a[56:59], a[72:75]
    buffer_load_dwordx4 a[16:19], v2, s[40:43], s62 offen sc1
    v_mfma_f32_16x16x32_bf16 a[76:79], a[172:175], a[60:63], a[76:79]
    ds_read_b64_tr_b16 a[166:167], v251 offset:37728
    v_mfma_f32_16x16x32_bf16 a[76:79], a[168:171], a[44:47], a[76:79]
    s_waitcnt lgkmcnt(4)
    v_mfma_f32_16x16x32_bf16 a[92:95], a[176:179], a[44:47], a[92:95]
    ds_read_b64_tr_b16 a[168:169], v251 offset:43104
    v_mfma_f32_16x16x32_bf16 a[92:95], a[180:183], a[60:63], a[92:95]
    buffer_load_dwordx4 a[20:23], v2, s[40:43], s62 offen offset:1024 sc1
    v_mfma_f32_16x16x32_bf16 a[88:91], a[180:183], a[56:59], a[88:91]
    ds_read_b64_tr_b16 a[170:171], v251 offset:44896
    v_mfma_f32_16x16x32_bf16 a[88:91], a[176:179], a[40:43], a[88:91]
    v_mfma_f32_16x16x32_bf16 a[84:87], a[176:179], a[36:39], a[84:87]
    ds_read_b64_tr_b16 a[172:173], v251 offset:50272
    v_mfma_f32_16x16x32_bf16 a[84:87], a[180:183], a[52:55], a[84:87]
    v_mfma_f32_16x16x32_bf16 a[80:83], a[180:183], a[48:51], a[80:83]
    ds_read_b64_tr_b16 a[174:175], v251 offset:52064
    v_mfma_f32_16x16x32_bf16 a[80:83], a[176:179], a[32:35], a[80:83]
    s_waitcnt lgkmcnt(4)
    v_mfma_f32_16x16x32_bf16 a[96:99], a[160:163], a[32:35], a[96:99]
    ds_read_b64_tr_b16 a[176:177], v251 offset:28800
    v_mfma_f32_16x16x32_bf16 a[96:99], a[164:167], a[48:51], a[96:99]
    buffer_load_dwordx4 a[24:27], v2, s[40:43], s62 offen offset:2048 sc1
    v_mfma_f32_16x16x32_bf16 a[100:103], a[164:167], a[52:55], a[100:103]
    ds_read_b64_tr_b16 a[178:179], v251 offset:30592
    v_mfma_f32_16x16x32_bf16 a[100:103], a[160:163], a[36:39], a[100:103]
    v_mfma_f32_16x16x32_bf16 a[104:107], a[160:163], a[40:43], a[104:107]
    ds_read_b64_tr_b16 a[180:181], v251 offset:35968
    v_mfma_f32_16x16x32_bf16 a[104:107], a[164:167], a[56:59], a[104:107]
    v_mfma_f32_16x16x32_bf16 a[108:111], a[164:167], a[60:63], a[108:111]
    ds_read_b64_tr_b16 a[182:183], v251 offset:37760
    v_mfma_f32_16x16x32_bf16 a[108:111], a[160:163], a[44:47], a[108:111]
    s_waitcnt lgkmcnt(4)
    v_mfma_f32_16x16x32_bf16 a[124:127], a[168:171], a[44:47], a[124:127]
    ds_read_b64_tr_b16 a[160:161], v251 offset:43136
    v_mfma_f32_16x16x32_bf16 a[124:127], a[172:175], a[60:63], a[124:127]
    buffer_load_dwordx4 a[28:31], v2, s[40:43], s62 offen offset:3072 sc1
    v_mfma_f32_16x16x32_bf16 a[120:123], a[172:175], a[56:59], a[120:123]
    ds_read_b64_tr_b16 a[162:163], v251 offset:44928
    v_mfma_f32_16x16x32_bf16 a[120:123], a[168:171], a[40:43], a[120:123]
    s_add_u32 s62, s62, 4096
    v_mfma_f32_16x16x32_bf16 a[116:119], a[168:171], a[36:39], a[116:119]
    ds_read_b64_tr_b16 a[164:165], v251 offset:50304
    v_mfma_f32_16x16x32_bf16 a[116:119], a[172:175], a[52:55], a[116:119]
    v_mfma_f32_16x16x32_bf16 a[112:115], a[172:175], a[48:51], a[112:115]
    ds_read_b64_tr_b16 a[166:167], v251 offset:52096
    v_mfma_f32_16x16x32_bf16 a[112:115], a[168:171], a[32:35], a[112:115]
    s_waitcnt lgkmcnt(4)
    v_mfma_f32_16x16x32_bf16 v[132:135], a[176:179], a[32:35], v[132:135]
    ds_read_b64_tr_b16 a[168:169], v251 offset:28832
    v_mfma_f32_16x16x32_bf16 v[132:135], a[180:183], a[48:51], v[132:135]
    v_mfma_f32_16x16x32_bf16 v[136:139], a[180:183], a[52:55], v[136:139]
    ds_read_b64_tr_b16 a[170:171], v251 offset:30624
    v_mfma_f32_16x16x32_bf16 v[136:139], a[176:179], a[36:39], v[136:139]
    v_mfma_f32_16x16x32_bf16 v[140:143], a[176:179], a[40:43], v[140:143]
    ds_read_b64_tr_b16 a[172:173], v251 offset:36000
    s_add_u32 m0, s63, 28672
    v_mfma_f32_16x16x32_bf16 v[140:143], a[180:183], a[56:59], v[140:143]
    buffer_load_dwordx4 v242, s[32:35], s60 offen lds
    v_mfma_f32_16x16x32_bf16 v[144:147], a[180:183], a[60:63], v[144:147]
    ds_read_b64_tr_b16 a[174:175], v251 offset:37792
    v_mfma_f32_16x16x32_bf16 v[144:147], a[176:179], a[44:47], v[144:147]
    s_waitcnt lgkmcnt(4)
    v_mfma_f32_16x16x32_bf16 v[160:163], a[160:163], a[44:47], v[160:163]
    ds_read_b64_tr_b16 a[176:177], v251 offset:43168
    v_mfma_f32_16x16x32_bf16 v[160:163], a[164:167], a[60:63], v[160:163]
    v_mfma_f32_16x16x32_bf16 v[156:159], a[164:167], a[56:59], v[156:159]
    ds_read_b64_tr_b16 a[178:179], v251 offset:44960
    v_mfma_f32_16x16x32_bf16 v[156:159], a[160:163], a[40:43], v[156:159]
    v_mfma_f32_16x16x32_bf16 v[152:155], a[160:163], a[36:39], v[152:155]
    ds_read_b64_tr_b16 a[180:181], v251 offset:50336
    v_mfma_f32_16x16x32_bf16 v[152:155], a[164:167], a[52:55], v[152:155]
    buffer_load_dwordx4 v243, s[32:35], s60 offen offset:1024 lds
    v_mfma_f32_16x16x32_bf16 v[148:151], a[164:167], a[48:51], v[148:151]
    ds_read_b64_tr_b16 a[182:183], v251 offset:52128
    v_mfma_f32_16x16x32_bf16 v[148:151], a[160:163], a[32:35], v[148:151]
    s_waitcnt lgkmcnt(4)
    v_mfma_f32_16x16x32_bf16 v[164:167], a[168:171], a[32:35], v[164:167]
    ds_read_b64_tr_b16 a[160:161], v251 offset:28864
    v_mfma_f32_16x16x32_bf16 v[164:167], a[172:175], a[48:51], v[164:167]
    v_mfma_f32_16x16x32_bf16 v[168:171], a[172:175], a[52:55], v[168:171]
    ds_read_b64_tr_b16 a[162:163], v251 offset:30656
    v_mfma_f32_16x16x32_bf16 v[168:171], a[168:171], a[36:39], v[168:171]
    buffer_load_dword v241, v255, s[52:55], 0 offen sc0 sc1
    v_mfma_f32_16x16x32_bf16 v[172:175], a[168:171], a[40:43], v[172:175]
    ds_read_b64_tr_b16 a[164:165], v251 offset:36032
    v_mfma_f32_16x16x32_bf16 v[172:175], a[172:175], a[56:59], v[172:175]
    buffer_load_dwordx4 v244, s[32:35], s60 offen offset:2048 lds
    v_mfma_f32_16x16x32_bf16 v[176:179], a[172:175], a[60:63], v[176:179]
    ds_read_b64_tr_b16 a[166:167], v251 offset:37824
    v_mfma_f32_16x16x32_bf16 v[176:179], a[168:171], a[44:47], v[176:179]
    s_waitcnt lgkmcnt(4)
    v_mfma_f32_16x16x32_bf16 v[192:195], a[176:179], a[44:47], v[192:195]
    ds_read_b64_tr_b16 a[168:169], v251 offset:43200
    v_mfma_f32_16x16x32_bf16 v[192:195], a[180:183], a[60:63], v[192:195]
    v_mfma_f32_16x16x32_bf16 v[188:191], a[180:183], a[56:59], v[188:191]
    ds_read_b64_tr_b16 a[170:171], v251 offset:44992
    v_mfma_f32_16x16x32_bf16 v[188:191], a[176:179], a[40:43], v[188:191]
    v_mfma_f32_16x16x32_bf16 v[184:187], a[176:179], a[36:39], v[184:187]
    ds_read_b64_tr_b16 a[172:173], v251 offset:50368
    v_mfma_f32_16x16x32_bf16 v[184:187], a[180:183], a[52:55], v[184:187]
    buffer_load_dwordx4 v245, s[32:35], s60 offen offset:3072 lds
    v_mfma_f32_16x16x32_bf16 v[180:183], a[180:183], a[48:51], v[180:183]
    ds_read_b64_tr_b16 a[174:175], v251 offset:52160
    v_mfma_f32_16x16x32_bf16 v[180:183], a[176:179], a[32:35], v[180:183]
    s_waitcnt lgkmcnt(4)
    v_mfma_f32_16x16x32_bf16 v[196:199], a[160:163], a[32:35], v[196:199]
    ds_read_b128 a[176:179], v253 offset:8192
    v_swap_b32 v251, v252
    v_mfma_f32_16x16x32_bf16 v[196:199], a[164:167], a[48:51], v[196:199]
    v_mfma_f32_16x16x32_bf16 v[200:203], a[164:167], a[52:55], v[200:203]
    v_mfma_f32_16x16x32_bf16 v[200:203], a[160:163], a[36:39], v[200:203]
    v_mfma_f32_16x16x32_bf16 v[204:207], a[160:163], a[40:43], v[204:207]
    ds_read_b128 a[180:183], v254 offset:8192
    s_add_u32 m0, s63, 32768
    v_mfma_f32_16x16x32_bf16 v[204:207], a[164:167], a[56:59], v[204:207]
    buffer_load_dwordx4 v246, s[32:35], s60 offen lds
    v_mfma_f32_16x16x32_bf16 v[208:211], a[164:167], a[60:63], v[208:211]
    v_mfma_f32_16x16x32_bf16 v[208:211], a[160:163], a[44:47], v[208:211]
    s_waitcnt lgkmcnt(2)
    v_mfma_f32_16x16x32_bf16 v[224:227], a[168:171], a[44:47], v[224:227]
    ds_read_b128 a[160:163], v253 offset:12288
    v_mfma_f32_16x16x32_bf16 v[224:227], a[172:175], a[60:63], v[224:227]
    v_mfma_f32_16x16x32_bf16 v[220:223], a[172:175], a[56:59], v[220:223]
    v_mfma_f32_16x16x32_bf16 v[220:223], a[168:171], a[40:43], v[220:223]
    v_mfma_f32_16x16x32_bf16 v[216:219], a[168:171], a[36:39], v[216:219]
    ds_read_b128 a[164:167], v254 offset:12288
    v_mfma_f32_16x16x32_bf16 v[216:219], a[172:175], a[52:55], v[216:219]
    buffer_load_dwordx4 v247, s[32:35], s60 offen offset:1024 lds
    v_mfma_f32_16x16x32_bf16 v[212:215], a[172:175], a[48:51], v[212:215]
    v_mfma_f32_16x16x32_bf16 v[212:215], a[168:171], a[32:35], v[212:215]
    s_waitcnt lgkmcnt(2)
    v_mfma_f32_16x16x32_bf16 v[4:7], a[32:35], a[176:179], v[4:7]
    ds_read_b128 a[168:171], v253 offset:10240
    v_mfma_f32_16x16x32_bf16 v[4:7], a[48:51], a[180:183], v[4:7]
    v_mfma_f32_16x16x32_bf16 v[8:11], a[52:55], a[180:183], v[8:11]
    v_mfma_f32_16x16x32_bf16 v[8:11], a[36:39], a[176:179], v[8:11]
    v_mfma_f32_16x16x32_bf16 v[12:15], a[40:43], a[176:179], v[12:15]
    ds_read_b128 a[172:175], v254 offset:10240
    v_mfma_f32_16x16x32_bf16 v[12:15], a[56:59], a[180:183], v[12:15]
    buffer_load_dwordx4 v248, s[32:35], s60 offen offset:2048 lds
    v_mfma_f32_16x16x32_bf16 v[16:19], a[60:63], a[180:183], v[16:19]
    v_mfma_f32_16x16x32_bf16 v[16:19], a[44:47], a[176:179], v[16:19]
    s_add_u32 s60, s60, 458752
    s_add_u32 s63, s63, s68
    s_waitcnt lgkmcnt(2)
    v_mfma_f32_16x16x32_bf16 v[48:51], a[44:47], a[160:163], v[48:51]
    ds_read_b128 a[176:179], v253 offset:14336
    v_mfma_f32_16x16x32_bf16 v[48:51], a[60:63], a[164:167], v[48:51]
    v_mfma_f32_16x16x32_bf16 v[44:47], a[56:59], a[164:167], v[44:47]
    v_mfma_f32_16x16x32_bf16 v[44:47], a[40:43], a[160:163], v[44:47]
    v_mfma_f32_16x16x32_bf16 v[40:43], a[36:39], a[160:163], v[40:43]
    ds_read_b128 a[180:183], v254 offset:14336
    s_add_u32 m0, s64, 65536
    v_swap_b32 v253, v232
    v_mfma_f32_16x16x32_bf16 v[40:43], a[52:55], a[164:167], v[40:43]
    buffer_load_dwordx4 v249, s[36:39], s61 offen lds
    v_mfma_f32_16x16x32_bf16 v[36:39], a[48:51], a[164:167], v[36:39]
    v_mfma_f32_16x16x32_bf16 v[36:39], a[32:35], a[160:163], v[36:39]
    s_waitcnt vmcnt(18) lgkmcnt(2)
    s_barrier
    v_mfma_f32_16x16x32_bf16 v[20:23], a[32:35], a[168:171], v[20:23]
    ds_read_b64_tr_b16 a[160:161], v251 offset:0
    v_swap_b32 v254, v233
    v_mfma_f32_16x16x32_bf16 v[20:23], a[48:51], a[172:175], v[20:23]
    v_mfma_f32_16x16x32_bf16 v[24:27], a[52:55], a[172:175], v[24:27]
    ds_read_b64_tr_b16 a[162:163], v251 offset:1792
    v_mfma_f32_16x16x32_bf16 v[24:27], a[36:39], a[168:171], v[24:27]
    v_mfma_f32_16x16x32_bf16 v[28:31], a[40:43], a[168:171], v[28:31]
    ds_read_b64_tr_b16 a[164:165], v251 offset:7168
    v_mfma_f32_16x16x32_bf16 v[28:31], a[56:59], a[172:175], v[28:31]
    buffer_load_dwordx4 v250, s[36:39], s61 offen offset:1024 lds
    v_mfma_f32_16x16x32_bf16 v[32:35], a[60:63], a[172:175], v[32:35]
    ds_read_b64_tr_b16 a[166:167], v251 offset:8960
    v_mfma_f32_16x16x32_bf16 v[32:35], a[44:47], a[168:171], v[32:35]
    s_add_u32 s61, s61, 128
    s_add_u32 s64, s64, s68
    s_sub_u32 s68, 0, s68
    s_add_u32 s21, s3, 1
    s_waitcnt vmcnt(7)
    v_subrev_u32 v241, s21, v241
    v_cmp_lt_u32 vcc, 14, v241
    s_cbranch_vccnz f_fm_slow
f_fm_ok:
    s_waitcnt lgkmcnt(4)
    v_mfma_f32_16x16x32_bf16 v[64:67], a[44:47], a[176:179], v[64:67]
    ds_read_b64_tr_b16 a[168:169], v251 offset:14336
    v_mov_b32 v228, -1
    v_mfma_f32_16x16x32_bf16 v[64:67], a[60:63], a[180:183], v[64:67]
    v_mov_b32 v229, -1
    v_mfma_f32_16x16x32_bf16 v[60:63], a[56:59], a[180:183], v[60:63]
    ds_read_b64_tr_b16 a[170:171], v251 offset:16128
    v_mov_b32 v230, -1
    v_mfma_f32_16x16x32_bf16 v[60:63], a[40:43], a[176:179], v[60:63]
    v_mov_b32 v231, -1
    v_mfma_f32_16x16x32_bf16 v[56:59], a[36:39], a[176:179], v[56:59]
    ds_read_b64_tr_b16 a[172:173], v251 offset:21504
    s_add_u32 s52, s22, 0x2000000
    s_addc_u32 s53, s23, 0
    v_mfma_f32_16x16x32_bf16 v[56:59], a[52:55], a[180:183], v[56:59]
    s_mov_b32 s54, 12582912
    v_mfma_f32_16x16x32_bf16 v[52:55], a[48:51], a[180:183], v[52:55]
    ds_read_b64_tr_b16 a[174:175], v251 offset:23296
    s_lshl_b32 s67, s20, 2
    v_mfma_f32_16x16x32_bf16 v[52:55], a[32:35], a[176:179], v[52:55]
    s_waitcnt vmcnt(10)
    s_mov_b32 s65, 0
.p2align 6
f_loop:
    s_waitcnt vmcnt(11) lgkmcnt(4)
    v_mfma_f32_16x16x32_bf16 v[68:71], a[160:163], a[0:3], v[68:71]
    ds_read_b64_tr_b16 a[176:177], v251 offset:32
    v_mfma_f32_16x16x32_bf16 v[68:71], a[164:167], a[16:19], v[68:71]
    buffer_load_dwordx4 a[32:35], v2, s[40:43], s62 offen sc1
    v_mfma_f32_16x16x32_bf16 v[72:75], a[164:167], a[20:23], v[72:75]
    ds_read_b64_tr_b16 a[178:179], v251 offset:1824
    v_mfma_f32_16x16x32_bf16 v[72:75], a[160:163], a[4:7], v[72:75]
    v_mfma_f32_16x16x32_bf16 v[76:79], a[160:163], a[8:11], v[76:79]
    ds_read_b64_tr_b16 a[180:181], v251 offset:7200
    v_mfma_f32_16x16x32_bf16 v[76:79], a[164:167], a[24:27], v[76:79]
    buffer_load_dwordx4 a[36:39], v2, s[40:43], s62 offen offset:1024 sc1
    v_mfma_f32_16x16x32_bf16 v[80:83], a[164:167], a[28:31], v[80:83]
    ds_read_b64_tr_b16 a[182:183], v251 offset:8992
    v_mfma_f32_16x16x32_bf16 v[80:83], a[160:163], a[12:15], v[80:83]
    s_waitcnt lgkmcnt(4)
    v_mfma_f32_16x16x32_bf16 v[96:99], a[168:171], a[12:15], v[96:99]
    ds_read_b64_tr_b16 a[160:161], v251 offset:14368
    v_mfma_f32_16x16x32_bf16 v[96:99], a[172:175], a[28:31], v[96:99]
    buffer_load_dwordx4 a[40:43], v2, s[40:43], s62 offen offset:2048 sc1
    v_mfma_f32_16x16x32_bf16 v[92:95], a[172:175], a[24:27], v[92:95]
    ds_read_b64_tr_b16 a[162:163], v251 offset:16160
    v_mfma_f32_16x16x32_bf16 v[92:95], a[168:171], a[8:11], v[92:95]
    v_mfma_f32_16x16x32_bf16 v[88:91], a[168:171], a[4:7], v[88:91]
    ds_read_b64_tr_b16 a[164:165], v251 offset:21536
    v_mfma_f32_16x16x32_bf16 v[88:91], a[172:175], a[20:23], v[88:91]
    buffer_load_dwordx4 a[44:47], v2, s[40:43], s62 offen offset:3072 sc1
    v_mfma_f32_16x16x32_bf16 v[84:87], a[172:175], a[16:19], v[84:87]
    ds_read_b64_tr_b16 a[166:167], v251 offset:23328
    v_mfma_f32_16x16x32_bf16 v[84:87], a[168:171], a[0:3], v[84:87]
    s_add_u32 s62, s62, 4096
    s_waitcnt lgkmcnt(4)
    v_mfma_f32_16x16x32_bf16 v[100:103], a[176:179], a[0:3], v[100:103]
    ds_read_b64_tr_b16 a[168:169], v251 offset:64
    v_mfma_f32_16x16x32_bf16 v[100:103], a[180:183], a[16:19], v[100:103]
    v_mfma_f32_16x16x32_bf16 v[104:107], a[180:183], a[20:23], v[104:107]
    ds_read_b64_tr_b16 a[170:171], v251 offset:1856
    v_mfma_f32_16x16x32_bf16 v[104:107], a[176:179], a[4:7], v[104:107]
    v_mfma_f32_16x16x32_bf16 v[108:111], a[176:179], a[8:11], v[108:111]
    ds_read_b64_tr_b16 a[172:173], v251 offset:7232
    v_mfma_f32_16x16x32_bf16 v[108:111], a[180:183], a[24:27], v[108:111]
    buffer_load_dwordx4 a[48:51], v2, s[40:43], s62 offen sc1
    v_mfma_f32_16x16x32_bf16 v[112:115], a[180:183], a[28:31], v[112:115]
    ds_read_b64_tr_b16 a[174:175], v251 offset:9024
    v_mfma_f32_16x16x32_bf16 v[112:115], a[176:179], a[12:15], v[112:115]
    s_waitcnt lgkmcnt(4)
    v_mfma_f32_16x16x32_bf16 v[128:131], a[160:163], a[12:15], v[128:131]
    ds_read_b64_tr_b16 a[176:177], v251 offset:14400
    v_mfma_f32_16x16x32_bf16 v[128:131], a[164:167], a[28:31], v[128:131]
    buffer_load_dwordx4 a[52:55], v2, s[40:43], s62 offen offset:1024 sc1
    v_mfma_f32_16x16x32_bf16 v[124:127], a[164:167], a[24:27], v[124:127]
    ds_read_b64_tr_b16 a[178:179], v251 offset:16192
    v_mfma_f32_16x16x32_bf16 v[124:127], a[160:163], a[8:11], v[124:127]
    v_mfma_f32_16x16x32_bf16 v[120:123], a[160:163], a[4:7], v[120:123]
    ds_read_b64_tr_b16 a[180:181], v251 offset:21568
    v_mfma_f32_16x16x32_bf16 v[120:123], a[164:167], a[20:23], v[120:123]
    buffer_load_dwordx4 a[56:59], v2, s[40:43], s62 offen offset:2048 sc1
    v_mfma_f32_16x16x32_bf16 v[116:119], a[164:167], a[16:19], v[116:119]
    ds_read_b64_tr_b16 a[182:183], v251 offset:23360
    v_mfma_f32_16x16x32_bf16 v[116:119], a[160:163], a[0:3], v[116:119]
    s_waitcnt lgkmcnt(4)
    v_mfma_f32_16x16x32_bf16 a[64:67], a[168:171], a[0:3], a[64:67]
    ds_read_b64_tr_b16 a[160:161], v251 offset:96
    v_mfma_f32_16x16x32_bf16 a[64:67], a[172:175], a[16:19], a[64:67]
    buffer_load_dwordx4 a[60:63], v2, s[40:43], s62 offen offset:3072 sc1
    v_mfma_f32_16x16x32_bf16 a[68:71], a[172:175], a[20:23], a[68:71]
    ds_read_b64_tr_b16 a[162:163], v251 offset:1888
    v_mfma_f32_16x16x32_bf16 a[68:71], a[168:171], a[4:7], a[68:71]
    s_add_u32 s62, s62, 4096
    v_mfma_f32_16x16x32_bf16 a[72:75], a[168:171], a[8:11], a[72:75]
    ds_read_b64_tr_b16 a[164:165], v251 offset:7264
    v_mfma_f32_16x16x32_bf16 a[72:75], a[172:175], a[24:27], a[72:75]
    v_mfma_f32_16x16x32_bf16 a[76:79], a[172:175], a[28:31], a[76:79]
    ds_read_b64_tr_b16 a[166:167], v251 offset:9056
    v_mfma_f32_16x16x32_bf16 a[76:79], a[168:171], a[12:15], a[76:79]
    s_waitcnt lgkmcnt(4)
    v_mfma_f32_16x16x32_bf16 a[92:95], a[176:179], a[12:15], a[92:95]
    ds_read_b64_tr_b16 a[168:169], v251 offset:14432
    v_mfma_f32_16x16x32_bf16 a[92:95], a[180:183], a[28:31], a[92:95]
    buffer_load_dword v240, v236, s[32:35], s60 offen
    v_mfma_f32_16x16x32_bf16 a[88:91], a[180:183], a[24:27], a[88:91]
    ds_read_b64_tr_b16 a[170:171], v251 offset:16224
    v_mfma_f32_16x16x32_bf16 a[88:91], a[176:179], a[8:11], a[88:91]
    v_mfma_f32_16x16x32_bf16 a[84:87], a[176:179], a[4:7], a[84:87]
    ds_read_b64_tr_b16 a[172:173], v251 offset:21600
    v_mfma_f32_16x16x32_bf16 a[84:87], a[180:183], a[20:23], a[84:87]
    buffer_load_dword v240, v237, s[36:39], s70 offen
    v_mfma_f32_16x16x32_bf16 a[80:83], a[180:183], a[16:19], a[80:83]
    ds_read_b64_tr_b16 a[174:175], v251 offset:23392
    v_mfma_f32_16x16x32_bf16 a[80:83], a[176:179], a[0:3], a[80:83]
    s_add_u32 s70, s70, 256
    s_waitcnt lgkmcnt(4)
    v_mfma_f32_16x16x32_bf16 a[96:99], a[160:163], a[0:3], a[96:99]
    ds_read_b64_tr_b16 a[176:177], v251 offset:128
    v_mfma_f32_16x16x32_bf16 a[96:99], a[164:167], a[16:19], a[96:99]
    global_load_dword v240, v[234:235], off
    v_mfma_f32_16x16x32_bf16 a[100:103], a[164:167], a[20:23], a[100:103]
    ds_read_b64_tr_b16 a[178:179], v251 offset:1920
    v_mfma_f32_16x16x32_bf16 a[100:103], a[160:163], a[4:7], a[100:103]
    v_mfma_f32_16x16x32_bf16 a[104:107], a[160:163], a[8:11], a[104:107]
    ds_read_b64_tr_b16 a[180:181], v251 offset:7296
    v_mfma_f32_16x16x32_bf16 a[104:107], a[164:167], a[24:27], a[104:107]
    buffer_load_dword v240, v238, s[48:51], 0 offen
    v_mfma_f32_16x16x32_bf16 a[108:111], a[164:167], a[28:31], a[108:111]
    ds_read_b64_tr_b16 a[182:183], v251 offset:9088
    v_mfma_f32_16x16x32_bf16 a[108:111], a[160:163], a[12:15], a[108:111]
    v_add_u32 v238, 1536, v238
    s_waitcnt lgkmcnt(4)
    v_mfma_f32_16x16x32_bf16 a[124:127], a[168:171], a[12:15], a[124:127]
    ds_read_b64_tr_b16 a[160:161], v251 offset:14464
    v_mfma_f32_16x16x32_bf16 a[124:127], a[172:175], a[28:31], a[124:127]
    v_mfma_f32_16x16x32_bf16 a[120:123], a[172:175], a[24:27], a[120:123]
    ds_read_b64_tr_b16 a[162:163], v251 offset:16256
    v_mfma_f32_16x16x32_bf16 a[120:123], a[168:171], a[8:11], a[120:123]
    v_mfma_f32_16x16x32_bf16 a[116:119], a[168:171], a[4:7], a[116:119]
    ds_read_b64_tr_b16 a[164:165], v251 offset:21632
    v_mfma_f32_16x16x32_bf16 a[116:119], a[172:175], a[20:23], a[116:119]
    v_mfma_f32_16x16x32_bf16 a[112:115], a[172:175], a[16:19], a[112:115]
    ds_read_b64_tr_b16 a[166:167], v251 offset:23424
    v_mfma_f32_16x16x32_bf16 a[112:115], a[168:171], a[0:3], a[112:115]
    s_waitcnt lgkmcnt(4)
    v_mfma_f32_16x16x32_bf16 v[132:135], a[176:179], a[0:3], v[132:135]
    ds_read_b64_tr_b16 a[168:169], v251 offset:160
    v_mfma_f32_16x16x32_bf16 v[132:135], a[180:183], a[16:19], v[132:135]
    v_mfma_f32_16x16x32_bf16 v[136:139], a[180:183], a[20:23], v[136:139]
    ds_read_b64_tr_b16 a[170:171], v251 offset:1952
    v_mfma_f32_16x16x32_bf16 v[136:139], a[176:179], a[4:7], v[136:139]
    v_mfma_f32_16x16x32_bf16 v[140:143], a[176:179], a[8:11], v[140:143]
    ds_read_b64_tr_b16 a[172:173], v251 offset:7328
    v_mfma_f32_16x16x32_bf16 v[140:143], a[180:183], a[24:27], v[140:143]
    v_mfma_f32_16x16x32_bf16 v[144:147], a[180:183], a[28:31], v[144:147]
    ds_read_b64_tr_b16 a[174:175], v251 offset:9120
    v_mfma_f32_16x16x32_bf16 v[144:147], a[176:179], a[12:15], v[144:147]
    s_waitcnt lgkmcnt(4)
    v_mfma_f32_16x16x32_bf16 v[160:163], a[160:163], a[12:15], v[160:163]
    ds_read_b64_tr_b16 a[176:177], v251 offset:14496
    v_mfma_f32_16x16x32_bf16 v[160:163], a[164:167], a[28:31], v[160:163]
    v_mfma_f32_16x16x32_bf16 v[156:159], a[164:167], a[24:27], v[156:159]
    ds_read_b64_tr_b16 a[178:179], v251 offset:16288
    v_mfma_f32_16x16x32_bf16 v[156:159], a[160:163], a[8:11], v[156:159]
    v_mfma_f32_16x16x32_bf16 v[152:155], a[160:163], a[4:7], v[152:155]
    ds_read_b64_tr_b16 a[180:181], v251 offset:21664
    v_mfma_f32_16x16x32_bf16 v[152:155], a[164:167], a[20:23], v[152:155]
    v_mfma_f32_16x16x32_bf16 v[148:151], a[164:167], a[16:19], v[148:151]
    ds_read_b64_tr_b16 a[182:183], v251 offset:23456
    v_mfma_f32_16x16x32_bf16 v[148:151], a[160:163], a[0:3], v[148:151]
    s_waitcnt lgkmcnt(4)
    v_mfma_f32_16x16x32_bf16 v[164:167], a[168:171], a[0:3], v[164:167]
    ds_read_b64_tr_b16 a[160:161], v251 offset:192
    v_mfma_f32_16x16x32_bf16 v[164:167], a[172:175], a[16:19], v[164:167]
    v_mfma_f32_16x16x32_bf16 v[168:171], a[172:175], a[20:23], v[168:171]
    ds_read_b64_tr_b16 a[162:163], v251 offset:1984
    v_mfma_f32_16x16x32_bf16 v[168:171], a[168:171], a[4:7], v[168:171]
    v_mfma_f32_16x16x32_bf16 v[172:175], a[168:171], a[8:11], v[172:175]
    ds_read_b64_tr_b16 a[164:165], v251 offset:7360
    v_mfma_f32_16x16x32_bf16 v[172:175], a[172:175], a[24:27], v[172:175]
    v_mfma_f32_16x16x32_bf16 v[176:179], a[172:175], a[28:31], v[176:179]
    ds_read_b64_tr_b16 a[166:167], v251 offset:9152
    v_mfma_f32_16x16x32_bf16 v[176:179], a[168:171], a[12:15], v[176:179]
    s_waitcnt lgkmcnt(4)
    v_mfma_f32_16x16x32_bf16 v[192:195], a[176:179], a[12:15], v[192:195]
    ds_read_b64_tr_b16 a[168:169], v251 offset:14528
    v_mfma_f32_16x16x32_bf16 v[192:195], a[180:183], a[28:31], v[192:195]
    v_mfma_f32_16x16x32_bf16 v[188:191], a[180:183], a[24:27], v[188:191]
    ds_read_b64_tr_b16 a[170:171], v251 offset:16320
    v_mfma_f32_16x16x32_bf16 v[188:191], a[176:179], a[8:11], v[188:191]
    v_mfma_f32_16x16x32_bf16 v[184:187], a[176:179], a[4:7], v[184:187]
    ds_read_b64_tr_b16 a[172:173], v251 offset:21696
    v_mfma_f32_16x16x32_bf16 v[184:187], a[180:183], a[20:23], v[184:187]
    v_mfma_f32_16x16x32_bf16 v[180:183], a[180:183], a[16:19], v[180:183]
    ds_read_b64_tr_b16 a[174:175], v251 offset:23488
    v_mfma_f32_16x16x32_bf16 v[180:183], a[176:179], a[0:3], v[180:183]
    s_waitcnt lgkmcnt(4)
    v_mfma_f32_16x16x32_bf16 v[196:199], a[160:163], a[0:3], v[196:199]
    ds_read_b128 a[176:179], v253 offset:0
    v_mfma_f32_16x16x32_bf16 v[196:199], a[164:167], a[16:19], v[196:199]
    v_mfma_f32_16x16x32_bf16 v[200:203], a[164:167], a[20:23], v[200:203]
    v_mfma_f32_16x16x32_bf16 v[200:203], a[160:163], a[4:7], v[200:203]
    v_mfma_f32_16x16x32_bf16 v[204:207], a[160:163], a[8:11], v[204:207]
    ds_read_b128 a[180:183], v254 offset:0
    v_mfma_f32_16x16x32_bf16 v[204:207], a[164:167], a[24:27], v[204:207]
    v_mfma_f32_16x16x32_bf16 v[208:211], a[164:167], a[28:31], v[208:211]
    v_mfma_f32_16x16x32_bf16 v[208:211], a[160:163], a[12:15], v[208:211]
    s_waitcnt lgkmcnt(2)
    v_mfma_f32_16x16x32_bf16 v[224:227], a[168:171], a[12:15], v[224:227]
    ds_read_b128 a[160:163], v253 offset:4096
    v_mfma_f32_16x16x32_bf16 v[224:227], a[172:175], a[28:31], v[224:227]
    v_mfma_f32_16x16x32_bf16 v[220:223], a[172:175], a[24:27], v[220:223]
    v_mfma_f32_16x16x32_bf16 v[220:223], a[168:171], a[8:11], v[220:223]
    v_mfma_f32_16x16x32_bf16 v[216:219], a[168:171], a[4:7], v[216:219]
    ds_read_b128 a[164:167], v254 offset:4096
    v_mfma_f32_16x16x32_bf16 v[216:219], a[172:175], a[20:23], v[216:219]
    v_mfma_f32_16x16x32_bf16 v[212:215], a[172:175], a[16:19], v[212:215]
    v_mfma_f32_16x16x32_bf16 v[212:215], a[168:171], a[0:3], v[212:215]
    s_waitcnt lgkmcnt(2)
    v_mfma_f32_16x16x32_bf16 v[4:7], a[0:3], a[176:179], v[4:7]
    ds_read_b128 a[168:171], v253 offset:2048
    s_add_u32 m0, s63, 0
    v_mfma_f32_16x16x32_bf16 v[4:7], a[16:19], a[180:183], v[4:7]
    buffer_load_dwordx4 v242, s[32:35], s60 offen lds
    v_mfma_f32_16x16x32_bf16 v[8:11], a[20:23], a[180:183], v[8:11]
    v_mfma_f32_16x16x32_bf16 v[8:11], a[4:7], a[176:179], v[8:11]
    v_mfma_f32_16x16x32_bf16 v[12:15], a[8:11], a[176:179], v[12:15]
    ds_read_b128 a[172:175], v254 offset:2048
    v_mfma_f32_16x16x32_bf16 v[12:15], a[24:27], a[180:183], v[12:15]
    buffer_load_dwordx4 v243, s[32:35], s60 offen offset:1024 lds
    v_mfma_f32_16x16x32_bf16 v[16:19], a[28:31], a[180:183], v[16:19]
    v_mfma_f32_16x16x32_bf16 v[16:19], a[12:15], a[176:179], v[16:19]
    s_waitcnt lgkmcnt(2)
    v_mfma_f32_16x16x32_bf16 v[48:51], a[12:15], a[160:163], v[48:51]
    ds_read_b128 a[176:179], v253 offset:6144
    v_mfma_f32_16x16x32_bf16 v[48:51], a[28:31], a[164:167], v[48:51]
    v_mfma_f32_16x16x32_bf16 v[44:47], a[24:27], a[164:167], v[44:47]
    v_mfma_f32_16x16x32_bf16 v[44:47], a[8:11], a[160:163], v[44:47]
    v_mfma_f32_16x16x32_bf16 v[40:43], a[4:7], a[160:163], v[40:43]
    ds_read_b128 a[180:183], v254 offset:6144
    v_mfma_f32_16x16x32_bf16 v[40:43], a[20:23], a[164:167], v[40:43]
    buffer_load_dwordx4 v244, s[32:35], s60 offen offset:2048 lds
    v_mfma_f32_16x16x32_bf16 v[36:39], a[16:19], a[164:167], v[36:39]
    v_mfma_f32_16x16x32_bf16 v[36:39], a[0:3], a[160:163], v[36:39]
    s_waitcnt vmcnt(15) lgkmcnt(2)
    s_barrier
    v_mfma_f32_16x16x32_bf16 v[20:23], a[0:3], a[168:171], v[20:23]
    ds_read_b64_tr_b16 a[160:161], v251 offset:28672
    v_mfma_f32_16x16x32_bf16 v[20:23], a[16:19], a[172:175], v[20:23]
    v_mfma_f32_16x16x32_bf16 v[24:27], a[20:23], a[172:175], v[24:27]
    ds_read_b64_tr_b16 a[162:163], v251 offset:30464
    v_mfma_f32_16x16x32_bf16 v[24:27], a[4:7], a[168:171], v[24:27]
    v_mfma_f32_16x16x32_bf16 v[28:31], a[8:11], a[168:171], v[28:31]
    ds_read_b64_tr_b16 a[164:165], v251 offset:35840
    v_mfma_f32_16x16x32_bf16 v[28:31], a[24:27], a[172:175], v[28:31]
    buffer_load_dwordx4 v245, s[32:35], s60 offen offset:3072 lds
    v_mfma_f32_16x16x32_bf16 v[32:35], a[28:31], a[172:175], v[32:35]
    ds_read_b64_tr_b16 a[166:167], v251 offset:37632
    v_mfma_f32_16x16x32_bf16 v[32:35], a[12:15], a[168:171], v[32:35]
    s_waitcnt lgkmcnt(4)
    v_mfma_f32_16x16x32_bf16 v[64:67], a[12:15], a[176:179], v[64:67]
    ds_read_b64_tr_b16 a[168:169], v251 offset:43008
    s_add_u32 m0, s63, 4096
    v_mfma_f32_16x16x32_bf16 v[64:67], a[28:31], a[180:183], v[64:67]
    buffer_load_dwordx4 v246, s[32:35], s60 offen lds
    v_mfma_f32_16x16x32_bf16 v[60:63], a[24:27], a[180:183], v[60:63]
    ds_read_b64_tr_b16 a[170:171], v251 offset:44800
    v_mfma_f32_16x16x32_bf16 v[60:63], a[8:11], a[176:179], v[60:63]
    v_mfma_f32_16x16x32_bf16 v[56:59], a[4:7], a[176:179], v[56:59]
    ds_read_b64_tr_b16 a[172:173], v251 offset:50176
    v_mfma_f32_16x16x32_bf16 v[56:59], a[20:23], a[180:183], v[56:59]
    v_mfma_f32_16x16x32_bf16 v[52:55], a[16:19], a[180:183], v[52:55]
    ds_read_b64_tr_b16 a[174:175], v251 offset:51968
    v_mfma_f32_16x16x32_bf16 v[52:55], a[0:3], a[176:179], v[52:55]
    s_waitcnt vmcnt(9) lgkmcnt(4)
    v_mfma_f32_16x16x32_bf16 v[68:71], a[160:163], a[32:35], v[68:71]
    ds_read_b64_tr_b16 a[176:177], v251 offset:28704
    v_mfma_f32_16x16x32_bf16 v[68:71], a[164:167], a[48:51], v[68:71]
    buffer_load_dwordx4 v247, s[32:35], s60 offen offset:1024 lds
    v_mfma_f32_16x16x32_bf16 v[72:75], a[164:167], a[52:55], v[72:75]
    ds_read_b64_tr_b16 a[178:179], v251 offset:30496
    v_mfma_f32_16x16x32_bf16 v[72:75], a[160:163], a[36:39], v[72:75]
    v_mfma_f32_16x16x32_bf16 v[76:79], a[160:163], a[40:43], v[76:79]
    ds_read_b64_tr_b16 a[180:181], v251 offset:35872
    v_mfma_f32_16x16x32_bf16 v[76:79], a[164:167], a[56:59], v[76:79]
    v_mfma_f32_16x16x32_bf16 v[80:83], a[164:167], a[60:63], v[80:83]
    ds_read_b64_tr_b16 a[182:183], v251 offset:37664
    v_mfma_f32_16x16x32_bf16 v[80:83], a[160:163], a[44:47], v[80:83]
    s_waitcnt lgkmcnt(4)
    v_mfma_f32_16x16x32_bf16 v[96:99], a[168:171], a[44:47], v[96:99]
    ds_read_b64_tr_b16 a[160:161], v251 offset:43040
    v_mfma_f32_16x16x32_bf16 v[96:99], a[172:175], a[60:63], v[96:99]
    buffer_load_dwordx4 v248, s[32:35], s60 offen offset:2048 lds
    v_mfma_f32_16x16x32_bf16 v[92:95], a[172:175], a[56:59], v[92:95]
    ds_read_b64_tr_b16 a[162:163], v251 offset:44832
    v_mfma_f32_16x16x32_bf16 v[92:95], a[168:171], a[40:43], v[92:95]
    s_add_u32 s60, s60, 458752
    v_mfma_f32_16x16x32_bf16 v[88:91], a[168:171], a[36:39], v[88:91]
    ds_read_b64_tr_b16 a[164:165], v251 offset:50208
    s_add_u32 m0, s64, 57344
    v_mfma_f32_16x16x32_bf16 v[88:91], a[172:175], a[52:55], v[88:91]
    buffer_load_dwordx4 v249, s[36:39], s61 offen lds
    v_mfma_f32_16x16x32_bf16 v[84:87], a[172:175], a[48:51], v[84:87]
    ds_read_b64_tr_b16 a[166:167], v251 offset:52000
    v_mfma_f32_16x16x32_bf16 v[84:87], a[168:171], a[32:35], v[84:87]
    s_waitcnt lgkmcnt(4)
    v_mfma_f32_16x16x32_bf16 v[100:103], a[176:179], a[32:35], v[100:103]
    ds_read_b64_tr_b16 a[168:169], v251 offset:28736
    v_mfma_f32_16x16x32_bf16 v[100:103], a[180:183], a[48:51], v[100:103]
    v_mfma_f32_16x16x32_bf16 v[104:107], a[180:183], a[52:55], v[104:107]
    ds_read_b64_tr_b16 a[170:171], v251 offset:30528
    v_mfma_f32_16x16x32_bf16 v[104:107], a[176:179], a[36:39], v[104:107]
    v_mfma_f32_16x16x32_bf16 v[108:111], a[176:179], a[40:43], v[108:111]
    ds_read_b64_tr_b16 a[172:173], v251 offset:35904
    v_mfma_f32_16x16x32_bf16 v[108:111], a[180:183], a[56:59], v[108:111]
    buffer_load_dwordx4 v250, s[36:39], s61 offen offset:1024 lds
    v_mfma_f32_16x16x32_bf16 v[112:115], a[180:183], a[60:63], v[112:115]
    ds_read_b64_tr_b16 a[174:175], v251 offset:37696
    v_mfma_f32_16x16x32_bf16 v[112:115], a[176:179], a[44:47], v[112:115]
    s_add_u32 s61, s61, 128
    s_waitcnt lgkmcnt(4)
    v_mfma_f32_16x16x32_bf16 v[128:131], a[160:163], a[44:47], v[128:131]
    ds_read_b64_tr_b16 a[176:177], v251 offset:43072
    v_mfma_f32_16x16x32_bf16 v[128:131], a[164:167], a[60:63], v[128:131]
    v_mfma_f32_16x16x32_bf16 v[124:127], a[164:167], a[56:59], v[124:127]
    ds_read_b64_tr_b16 a[178:179], v251 offset:44864
    v_mfma_f32_16x16x32_bf16 v[124:127], a[160:163], a[40:43], v[124:127]
    v_mfma_f32_16x16x32_bf16 v[120:123], a[160:163], a[36:39], v[120:123]
    ds_read_b64_tr_b16 a[180:181], v251 offset:50240
    v_mfma_f32_16x16x32_bf16 v[120:123], a[164:167], a[52:55], v[120:123]
    buffer_load_dwordx4 a[0:3], v2, s[40:43], s62 offen sc1
    v_mfma_f32_16x16x32_bf16 v[116:119], a[164:167], a[48:51], v[116:119]
    ds_read_b64_tr_b16 a[182:183], v251 offset:52032
    v_mfma_f32_16x16x32_bf16 v[116:119], a[160:163], a[32:35], v[116:119]
    s_waitcnt lgkmcnt(4)
    v_mfma_f32_16x16x32_bf16 a[64:67], a[168:171], a[32:35], a[64:67]
    ds_read_b64_tr_b16 a[160:161], v251 offset:28768
    v_mfma_f32_16x16x32_bf16 a[64:67], a[172:175], a[48:51], a[64:67]
    buffer_load_dwordx4 a[4:7], v2, s[40:43], s62 offen offset:1024 sc1
    v_mfma_f32_16x16x32_bf16 a[68:71], a[172:175], a[52:55], a[68:71]
    ds_read_b64_tr_b16 a[162:163], v251 offset:30560
    v_mfma_f32_16x16x32_bf16 a[68:71], a[168:171], a[36:39], a[68:71]
    v_mfma_f32_16x16x32_bf16 a[72:75], a[168:171], a[40:43], a[72:75]
    ds_read_b64_tr_b16 a[164:165], v251 offset:35936
    v_mfma_f32_16x16x32_bf16 a[72:75], a[172:175], a[56:59], a[72:75]
    v_mfma_f32_16x16x32_bf16 a[76:79], a[172:175], a[60:63], a[76:79]
    ds_read_b64_tr_b16 a[166:167], v251 offset:37728
    v_mfma_f32_16x16x32_bf16 a[76:79], a[168:171], a[44:47], a[76:79]
    s_waitcnt lgkmcnt(4)
    v_mfma_f32_16x16x32_bf16 a[92:95], a[176:179], a[44:47], a[92:95]
    ds_read_b64_tr_b16 a[168:169], v251 offset:43104
    v_mfma_f32_16x16x32_bf16 a[92:95], a[180:183], a[60:63], a[92:95]
    buffer_load_dwordx4 a[8:11], v2, s[40:43], s62 offen offset:2048 sc1
    v_mfma_f32_16x16x32_bf16 a[88:91], a[180:183], a[56:59], a[88:91]
    ds_read_b64_tr_b16 a[170:171], v251 offset:44896
    v_mfma_f32_16x16x32_bf16 a[88:91], a[176:179], a[40:43], a[88:91]
    v_mfma_f32_16x16x32_bf16 a[84:87], a[176:179], a[36:39], a[84:87]
    ds_read_b64_tr_b16 a[172:173], v251 offset:50272
    v_mfma_f32_16x16x32_bf16 a[84:87], a[180:183], a[52:55], a[84:87]
    buffer_load_dwordx4 a[12:15], v2, s[40:43], s62 offen offset:3072 sc1
    v_mfma_f32_16x16x32_bf16 a[80:83], a[180:183], a[48:51], a[80:83]
    ds_read_b64_tr_b16 a[174:175], v251 offset:52064
    v_mfma_f32_16x16x32_bf16 a[80:83], a[176:179], a[32:35], a[80:83]
    s_add_u32 s62, s62, 4096
    s_waitcnt lgkmcnt(4)
    v_mfma_f32_16x16x32_bf16 a[96:99], a[160:163], a[32:35], a[96:99]
    ds_read_b64_tr_b16 a[176:177], v251 offset:28800
    v_mfma_f32_16x16x32_bf16 a[96:99], a[164:167], a[48:51], a[96:99]
    v_mfma_f32_16x16x32_bf16 a[100:103], a[164:167], a[52:55], a[100:103]
    ds_read_b64_tr_b16 a[178:179], v251 offset:30592
    v_mfma_f32_16x16x32_bf16 a[100:103], a[160:163], a[36:39], a[100:103]
    v_mfma_f32_16x16x32_bf16 a[104:107], a[160:163], a[40:43], a[104:107]
    ds_read_b64_tr_b16 a[180:181], v251 offset:35968
    v_mfma_f32_16x16x32_bf16 a[104:107], a[164:167], a[56:59], a[104:107]
    buffer_load_dwordx4 a[16:19], v2, s[40:43], s62 offen sc1
    v_mfma_f32_16x16x32_bf16 a[108:111], a[164:167], a[60:63], a[108:111]
    ds_read_b64_tr_b16 a[182:183], v251 offset:37760
    v_mfma_f32_16x16x32_bf16 a[108:111], a[160:163], a[44:47], a[108:111]
    s_waitcnt lgkmcnt(4)
    v_mfma_f32_16x16x32_bf16 a[124:127], a[168:171], a[44:47], a[124:127]
    ds_read_b64_tr_b16 a[160:161], v251 offset:43136
    v_mfma_f32_16x16x32_bf16 a[124:127], a[172:175], a[60:63], a[124:127]
    v_mfma_f32_16x16x32_bf16 a[120:123], a[172:175], a[56:59], a[120:123]
    ds_read_b64_tr_b16 a[162:163], v251 offset:44928
    v_mfma_f32_16x16x32_bf16 a[120:123], a[168:171], a[40:43], a[120:123]
    v_mfma_f32_16x16x32_bf16 a[116:119], a[168:171], a[36:39], a[116:119]
    ds_read_b64_tr_b16 a[164:165], v251 offset:50304
    v_mfma_f32_16x16x32_bf16 a[116:119], a[172:175], a[52:55], a[116:119]
    buffer_load_dwordx4 a[20:23], v2, s[40:43], s62 offen offset:1024 sc1
    v_mfma_f32_16x16x32_bf16 a[112:115], a[172:175], a[48:51], a[112:115]
    ds_read_b64_tr_b16 a[166:167], v251 offset:52096
    v_mfma_f32_16x16x32_bf16 a[112:115], a[168:171], a[32:35], a[112:115]
    s_waitcnt lgkmcnt(4)
    v_mfma_f32_16x16x32_bf16 v[132:135], a[176:179], a[32:35], v[132:135]
    ds_read_b64_tr_b16 a[168:169], v251 offset:28832
    v_mfma_f32_16x16x32_bf16 v[132:135], a[180:183], a[48:51], v[132:135]
    buffer_load_dwordx4 a[24:27], v2, s[40:43], s62 offen offset:2048 sc1
    v_mfma_f32_16x16x32_bf16 v[136:139], a[180:183], a[52:55], v[136:139]
    ds_read_b64_tr_b16 a[170:171], v251 offset:30624
    v_mfma_f32_16x16x32_bf16 v[136:139], a[176:179], a[36:39], v[136:139]
    v_mfma_f32_16x16x32_bf16 v[140:143], a[176:179], a[40:43], v[140:143]
    ds_read_b64_tr_b16 a[172:173], v251 offset:36000
    v_mfma_f32_16x16x32_bf16 v[140:143], a[180:183], a[56:59], v[140:143]
    v_mfma_f32_16x16x32_bf16 v[144:147], a[180:183], a[60:63], v[144:147]
    ds_read_b64_tr_b16 a[174:175], v251 offset:37792
    v_mfma_f32_16x16x32_bf16 v[144:147], a[176:179], a[44:47], v[144:147]
    s_waitcnt lgkmcnt(4)
    v_mfma_f32_16x16x32_bf16 v[160:163], a[160:163], a[44:47], v[160:163]
    ds_read_b64_tr_b16 a[176:177], v251 offset:43168
    v_mfma_f32_16x16x32_bf16 v[160:163], a[164:167], a[60:63], v[160:163]
    buffer_load_dwordx4 a[28:31], v2, s[40:43], s62 offen offset:3072 sc1
    v_mfma_f32_16x16x32_bf16 v[156:159], a[164:167], a[56:59], v[156:159]
    ds_read_b64_tr_b16 a[178:179], v251 offset:44960
    v_mfma_f32_16x16x32_bf16 v[156:159], a[160:163], a[40:43], v[156:159]
    s_add_u32 s62, s62, 4096
    v_mfma_f32_16x16x32_bf16 v[152:155], a[160:163], a[36:39], v[152:155]
    ds_read_b64_tr_b16 a[180:181], v251 offset:50336
    v_mfma_f32_16x16x32_bf16 v[152:155], a[164:167], a[52:55], v[152:155]
    v_mfma_f32_16x16x32_bf16 v[148:151], a[164:167], a[48:51], v[148:151]
    ds_read_b64_tr_b16 a[182:183], v251 offset:52128
    v_mfma_f32_16x16x32_bf16 v[148:151], a[160:163], a[32:35], v[148:151]
    s_waitcnt lgkmcnt(4)
    v_mfma_f32_16x16x32_bf16 v[164:167], a[168:171], a[32:35], v[164:167]
    ds_read_b64_tr_b16 a[160:161], v251 offset:28864
    s_add_u32 m0, s63, 28672
    v_mfma_f32_16x16x32_bf16 v[164:167], a[172:175], a[48:51], v[164:167]
    buffer_load_dwordx4 v242, s[32:35], s60 offen lds
    v_mfma_f32_16x16x32_bf16 v[168:171], a[172:175], a[52:55], v[168:171]
    ds_read_b64_tr_b16 a[162:163], v251 offset:30656
    v_mfma_f32_16x16x32_bf16 v[168:171], a[168:171], a[36:39], v[168:171]
    v_mfma_f32_16x16x32_bf16 v[172:175], a[168:171], a[40:43], v[172:175]
    ds_read_b64_tr_b16 a[164:165], v251 offset:36032
    v_mfma_f32_16x16x32_bf16 v[172:175], a[172:175], a[56:59], v[172:175]
    buffer_load_dwordx4 v243, s[32:35], s60 offen offset:1024 lds
    v_mfma_f32_16x16x32_bf16 v[176:179], a[172:175], a[60:63], v[176:179]
    ds_read_b64_tr_b16 a[166:167], v251 offset:37824
    v_mfma_f32_16x16x32_bf16 v[176:179], a[168:171], a[44:47], v[176:179]
    s_waitcnt lgkmcnt(4)
    v_mfma_f32_16x16x32_bf16 v[192:195], a[176:179], a[44:47], v[192:195]
    ds_read_b64_tr_b16 a[168:169], v251 offset:43200
    v_mfma_f32_16x16x32_bf16 v[192:195], a[180:183], a[60:63], v[192:195]
    buffer_load_dwordx4 v244, s[32:35], s60 offen offset:2048 lds
    v_mfma_f32_16x16x32_bf16 v[188:191], a[180:183], a[56:59], v[188:191]
    ds_read_b64_tr_b16 a[170:171], v251 offset:44992
    v_mfma_f32_16x16x32_bf16 v[188:191], a[176:179], a[40:43], v[188:191]
    v_mfma_f32_16x16x32_bf16 v[184:187], a[176:179], a[36:39], v[184:187]
    ds_read_b64_tr_b16 a[172:173], v251 offset:50368
    v_mfma_f32_16x16x32_bf16 v[184:187], a[180:183], a[52:55], v[184:187]
    v_mfma_f32_16x16x32_bf16 v[180:183], a[180:183], a[48:51], v[180:183]
    ds_read_b64_tr_b16 a[174:175], v251 offset:52160
    v_mfma_f32_16x16x32_bf16 v[180:183], a[176:179], a[32:35], v[180:183]
    s_waitcnt lgkmcnt(4)
    v_mfma_f32_16x16x32_bf16 v[196:199], a[160:163], a[32:35], v[196:199]
    ds_read_b128 a[176:179], v253 offset:8192
    v_swap_b32 v251, v252
    v_mfma_f32_16x16x32_bf16 v[196:199], a[164:167], a[48:51], v[196:199]
    buffer_load_dwordx4 v245, s[32:35], s60 offen offset:3072 lds
    v_mfma_f32_16x16x32_bf16 v[200:203], a[164:167], a[52:55], v[200:203]
    v_mfma_f32_16x16x32_bf16 v[200:203], a[160:163], a[36:39], v[200:203]
    v_mfma_f32_16x16x32_bf16 v[204:207], a[160:163], a[40:43], v[204:207]
    ds_read_b128 a[180:183], v254 offset:8192
    s_add_u32 m0, s63, 32768
    v_mfma_f32_16x16x32_bf16 v[204:207], a[164:167], a[56:59], v[204:207]
    buffer_load_dwordx4 v246, s[32:35], s60 offen lds
    v_mfma_f32_16x16x32_bf16 v[208:211], a[164:167], a[60:63], v[208:211]
    v_mfma_f32_16x16x32_bf16 v[208:211], a[160:163], a[44:47], v[208:211]
    s_waitcnt lgkmcnt(2)
    v_mfma_f32_16x16x32_bf16 v[224:227], a[168:171], a[44:47], v[224:227]
    ds_read_b128 a[160:163], v253 offset:12288
    v_mfma_f32_16x16x32_bf16 v[224:227], a[172:175], a[60:63], v[224:227]
    v_mfma_f32_16x16x32_bf16 v[220:223], a[172:175], a[56:59], v[220:223]
    v_mfma_f32_16x16x32_bf16 v[220:223], a[168:171], a[40:43], v[220:223]
    v_mfma_f32_16x16x32_bf16 v[216:219], a[168:171], a[36:39], v[216:219]
    ds_read_b128 a[164:167], v254 offset:12288
    v_mfma_f32_16x16x32_bf16 v[216:219], a[172:175], a[52:55], v[216:219]
    buffer_load_dwordx4 v247, s[32:35], s60 offen offset:1024 lds
    v_mfma_f32_16x16x32_bf16 v[212:215], a[172:175], a[48:51], v[212:215]
    v_mfma_f32_16x16x32_bf16 v[212:215], a[168:171], a[32:35], v[212:215]
    s_waitcnt lgkmcnt(2)
    v_mfma_f32_16x16x32_bf16 v[4:7], a[32:35], a[176:179], v[4:7]
    ds_read_b128 a[168:171], v253 offset:10240
    v_mfma_f32_16x16x32_bf16 v[4:7], a[48:51], a[180:183], v[4:7]
    buffer_load_dwordx4 v248, s[32:35], s60 offen offset:2048 lds
    v_mfma_f32_16x16x32_bf16 v[8:11], a[52:55], a[180:183], v[8:11]
    v_mfma_f32_16x16x32_bf16 v[8:11], a[36:39], a[176:179], v[8:11]
    s_add_u32 s60, s60, 458752
    s_add_u32 s63, s63, s68
    v_mfma_f32_16x16x32_bf16 v[12:15], a[40:43], a[176:179], v[12:15]
    ds_read_b128 a[172:175], v254 offset:10240
    v_mfma_f32_16x16x32_bf16 v[12:15], a[56:59], a[180:183], v[12:15]
    v_mfma_f32_16x16x32_bf16 v[16:19], a[60:63], a[180:183], v[16:19]
    v_mfma_f32_16x16x32_bf16 v[16:19], a[44:47], a[176:179], v[16:19]
    s_waitcnt lgkmcnt(2)
    v_mfma_f32_16x16x32_bf16 v[48:51], a[44:47], a[160:163], v[48:51]
    ds_read_b128 a[176:179], v253 offset:14336
    s_add_u32 m0, s64, 65536
    v_mfma_f32_16x16x32_bf16 v[48:51], a[60:63], a[164:167], v[48:51]
    buffer_load_dwordx4 v249, s[36:39], s61 offen lds
    v_mfma_f32_16x16x32_bf16 v[44:47], a[56:59], a[164:167], v[44:47]
    v_mfma_f32_16x16x32_bf16 v[44:47], a[40:43], a[160:163], v[44:47]
    v_mfma_f32_16x16x32_bf16 v[40:43], a[36:39], a[160:163], v[40:43]
    ds_read_b128 a[180:183], v254 offset:14336
    v_swap_b32 v253, v232
    v_mfma_f32_16x16x32_bf16 v[40:43], a[52:55], a[164:167], v[40:43]
    buffer_load_dwordx4 v250, s[36:39], s61 offen offset:1024 lds
    v_mfma_f32_16x16x32_bf16 v[36:39], a[48:51], a[164:167], v[36:39]
    v_mfma_f32_16x16x32_bf16 v[36:39], a[32:35], a[160:163], v[36:39]
    s_add_u32 s61, s61, 128
    s_add_u32 s64, s64, s68
    s_sub_u32 s68, 0, s68
    s_waitcnt vmcnt(17) lgkmcnt(2)
    s_barrier
    v_mfma_f32_16x16x32_bf16 v[20:23], a[32:35], a[168:171], v[20:23]
    ds_read_b64_tr_b16 a[160:161], v251 offset:0
    v_swap_b32 v254, v233
    v_mfma_f32_16x16x32_bf16 v[20:23], a[48:51], a[172:175], v[20:23]
    v_mfma_f32_16x16x32_bf16 v[24:27], a[52:55], a[172:175], v[24:27]
    ds_read_b64_tr_b16 a[162:163], v251 offset:1792
    v_mfma_f32_16x16x32_bf16 v[24:27], a[36:39], a[168:171], v[24:27]
    v_mfma_f32_16x16x32_bf16 v[28:31], a[40:43], a[168:171], v[28:31]
    ds_read_b64_tr_b16 a[164:165], v251 offset:7168
    v_mfma_f32_16x16x32_bf16 v[28:31], a[56:59], a[172:175], v[28:31]
    buffer_store_dwordx4 v[228:231], v2, s[52:55], s67 offen sc0 sc1
    v_mfma_f32_16x16x32_bf16 v[32:35], a[60:63], a[172:175], v[32:35]
    ds_read_b64_tr_b16 a[166:167], v251 offset:8960
    v_mfma_f32_16x16x32_bf16 v[32:35], a[44:47], a[168:171], v[32:35]
    s_add_u32 s67, s67, 0x100000
    s_waitcnt lgkmcnt(4)
    v_mfma_f32_16x16x32_bf16 v[64:67], a[44:47], a[176:179], v[64:67]
    ds_read_b64_tr_b16 a[168:169], v251 offset:14336
    v_mfma_f32_16x16x32_bf16 v[64:67], a[60:63], a[180:183], v[64:67]
    buffer_store_dwordx4 v[228:231], v2, s[52:55], s67 offen sc0 sc1
    v_mfma_f32_16x16x32_bf16 v[60:63], a[56:59], a[180:183], v[60:63]
    ds_read_b64_tr_b16 a[170:171], v251 offset:16128
    v_mfma_f32_16x16x32_bf16 v[60:63], a[40:43], a[176:179], v[60:63]
    s_add_u32 s67, s67, 0x100000
    v_mfma_f32_16x16x32_bf16 v[56:59], a[36:39], a[176:179], v[56:59]
    ds_read_b64_tr_b16 a[172:173], v251 offset:21504
    v_mfma_f32_16x16x32_bf16 v[56:59], a[52:55], a[180:183], v[56:59]
    v_mfma_f32_16x16x32_bf16 v[52:55], a[48:51], a[180:183], v[52:55]
    ds_read_b64_tr_b16 a[174:175], v251 offset:23296
    v_mfma_f32_16x16x32_bf16 v[52:55], a[32:35], a[176:179], v[52:55]
    s_add_u32 s65, s65, 1
    s_cmp_lt_u32 s65, 5
    s_cbranch_scc1 f_loop
fa_tail:
    s_waitcnt vmcnt(11) lgkmcnt(4)
    v_mfma_f32_16x16x32_bf16 v[68:71], a[160:163], a[0:3], v[68:71]
    ds_read_b64_tr_b16 a[176:177], v251 offset:32
    v_mfma_f32_16x16x32_bf16 v[68:71], a[164:167], a[16:19], v[68:71]
    buffer_load_dwordx4 a[32:35], v2, s[40:43], s62 offen sc1
    v_mfma_f32_16x16x32_bf16 v[72:75], a[164:167], a[20:23], v[72:75]
    ds_read_b64_tr_b16 a[178:179], v251 offset:1824
    v_mfma_f32_16x16x32_bf16 v[72:75], a[160:163], a[4:7], v[72:75]
    v_mfma_f32_16x16x32_bf16 v[76:79], a[160:163], a[8:11], v[76:79]
    ds_read_b64_tr_b16 a[180:181], v251 offset:7200
    v_mfma_f32_16x16x32_bf16 v[76:79], a[164:167], a[24:27], v[76:79]
    buffer_load_dwordx4 a[36:39], v2, s[40:43], s62 offen offset:1024 sc1
    v_mfma_f32_16x16x32_bf16 v[80:83], a[164:167], a[28:31], v[80:83]
    ds_read_b64_tr_b16 a[182:183], v251 offset:8992
    v_mfma_f32_16x16x32_bf16 v[80:83], a[160:163], a[12:15], v[80:83]
    s_waitcnt lgkmcnt(4)
    v_mfma_f32_16x16x32_bf16 v[96:99], a[168:171], a[12:15], v[96:99]
    ds_read_b64_tr_b16 a[160:161], v251 offset:14368
    v_mfma_f32_16x16x32_bf16 v[96:99], a[172:175], a[28:31], v[96:99]
    buffer_load_dwordx4 a[40:43], v2, s[40:43], s62 offen offset:2048 sc1
    v_mfma_f32_16x16x32_bf16 v[92:95], a[172:175], a[24:27], v[92:95]
    ds_read_b64_tr_b16 a[162:163], v251 offset:16160
    v_mfma_f32_16x16x32_bf16 v[92:95], a[168:171], a[8:11], v[92:95]
    v_mfma_f32_16x16x32_bf16 v[88:91], a[168:171], a[4:7], v[88:91]
    ds_read_b64_tr_b16 a[164:165], v251 offset:21536
    v_mfma_f32_16x16x32_bf16 v[88:91], a[172:175], a[20:23], v[88:91]
    buffer_load_dwordx4 a[44:47], v2, s[40:43], s62 offen offset:3072 sc1
    v_mfma_f32_16x16x32_bf16 v[84:87], a[172:175], a[16:19], v[84:87]
    ds_read_b64_tr_b16 a[166:167], v251 offset:23328
    v_mfma_f32_16x16x32_bf16 v[84:87], a[168:171], a[0:3], v[84:87]
    s_add_u32 s62, s62, 4096
    s_waitcnt lgkmcnt(4)
    v_mfma_f32_16x16x32_bf16 v[100:103], a[176:179], a[0:3], v[100:103]
    ds_read_b64_tr_b16 a[168:169], v251 offset:64
    v_mfma_f32_16x16x32_bf16 v[100:103], a[180:183], a[16:19], v[100:103]
    v_mfma_f32_16x16x32_bf16 v[104:107], a[180:183], a[20:23], v[104:107]
    ds_read_b64_tr_b16 a[170:171], v251 offset:1856
    v_mfma_f32_16x16x32_bf16 v[104:107], a[176:179], a[4:7], v[104:107]
    v_mfma_f32_16x16x32_bf16 v[108:111], a[176:179], a[8:11], v[108:111]
    ds_read_b64_tr_b16 a[172:173], v251 offset:7232
    v_mfma_f32_16x16x32_bf16 v[108:111], a[180:183], a[24:27], v[108:111]
    buffer_load_dwordx4 a[48:51], v2, s[40:43], s62 offen sc1
    v_mfma_f32_16x16x32_bf16 v[112:115], a[180:183], a[28:31], v[112:115]
    ds_read_b64_tr_b16 a[174:175], v251 offset:9024
    v_mfma_f32_16x16x32_bf16 v[112:115], a[176:179], a[12:15], v[112:115]
    s_waitcnt lgkmcnt(4)
    v_mfma_f32_16x16x32_bf16 v[128:131], a[160:163], a[12:15], v[128:131]
    ds_read_b64_tr_b16 a[176:177], v251 offset:14400
    v_mfma_f32_16x16x32_bf16 v[128:131], a[164:167], a[28:31], v[128:131]
    buffer_load_dwordx4 a[52:55], v2, s[40:43], s62 offen offset:1024 sc1
    v_mfma_f32_16x16x32_bf16 v[124:127], a[164:167], a[24:27], v[124:127]
    ds_read_b64_tr_b16 a[178:179], v251 offset:16192
    v_mfma_f32_16x16x32_bf16 v[124:127], a[160:163], a[8:11], v[124:127]
    v_mfma_f32_16x16x32_bf16 v[120:123], a[160:163], a[4:7], v[120:123]
    ds_read_b64_tr_b16 a[180:181], v251 offset:21568
    v_mfma_f32_16x16x32_bf16 v[120:123], a[164:167], a[20:23], v[120:123]
    buffer_load_dwordx4 a[56:59], v2, s[40:43], s62 offen offset:2048 sc1
    v_mfma_f32_16x16x32_bf16 v[116:119], a[164:167], a[16:19], v[116:119]
    ds_read_b64_tr_b16 a[182:183], v251 offset:23360
    v_mfma_f32_16x16x32_bf16 v[116:119], a[160:163], a[0:3], v[116:119]
    s_waitcnt lgkmcnt(4)
    v_mfma_f32_16x16x32_bf16 a[64:67], a[168:171], a[0:3], a[64:67]
    ds_read_b64_tr_b16 a[160:161], v251 offset:96
    v_mfma_f32_16x16x32_bf16 a[64:67], a[172:175], a[16:19], a[64:67]
    buffer_load_dwordx4 a[60:63], v2, s[40:43], s62 offen offset:3072 sc1
    v_mfma_f32_16x16x32_bf16 a[68:71], a[172:175], a[20:23], a[68:71]
    ds_read_b64_tr_b16 a[162:163], v251 offset:1888
    v_mfma_f32_16x16x32_bf16 a[68:71], a[168:171], a[4:7], a[68:71]
    s_add_u32 s62, s62, 4096
    v_mfma_f32_16x16x32_bf16 a[72:75], a[168:171], a[8:11], a[72:75]
    ds_read_b64_tr_b16 a[164:165], v251 offset:7264
    v_mfma_f32_16x16x32_bf16 a[72:75], a[172:175], a[24:27], a[72:75]
    v_mfma_f32_16x16x32_bf16 a[76:79], a[172:175], a[28:31], a[76:79]
    ds_read_b64_tr_b16 a[166:167], v251 offset:9056
    v_mfma_f32_16x16x32_bf16 a[76:79], a[168:171], a[12:15], a[76:79]
    s_waitcnt lgkmcnt(4)
    v_mfma_f32_16x16x32_bf16 a[92:95], a[176:179], a[12:15], a[92:95]
    ds_read_b64_tr_b16 a[168:169], v251 offset:14432
    v_mfma_f32_16x16x32_bf16 a[92:95], a[180:183], a[28:31], a[92:95]
    global_load_dword v240, v[234:235], off
    v_mfma_f32_16x16x32_bf16 a[88:91], a[180:183], a[24:27], a[88:91]
    ds_read_b64_tr_b16 a[170:171], v251 offset:16224
    v_mfma_f32_16x16x32_bf16 a[88:91], a[176:179], a[8:11], a[88:91]
    v_mfma_f32_16x16x32_bf16 a[84:87], a[176:179], a[4:7], a[84:87]
    ds_read_b64_tr_b16 a[172:173], v251 offset:21600
    v_mfma_f32_16x16x32_bf16 a[84:87], a[180:183], a[20:23], a[84:87]
    buffer_load_dword v240, v239, s[44:47], 0 offen
    v_mfma_f32_16x16x32_bf16 a[80:83], a[180:183], a[16:19], a[80:83]
    ds_read_b64_tr_b16 a[174:175], v251 offset:23392
    v_mfma_f32_16x16x32_bf16 a[80:83], a[176:179], a[0:3], a[80:83]
    s_waitcnt lgkmcnt(4)
    v_mfma_f32_16x16x32_bf16 a[96:99], a[160:163], a[0:3], a[96:99]
    ds_read_b64_tr_b16 a[176:177], v251 offset:128
    v_mfma_f32_16x16x32_bf16 a[96:99], a[164:167], a[16:19], a[96:99]
    buffer_store_dwordx4 v[228:231], v2, s[52:55], s67 offen sc0 sc1
    v_mfma_f32_16x16x32_bf16 a[100:103], a[164:167], a[20:23], a[100:103]
    ds_read_b64_tr_b16 a[178:179], v251 offset:1920
    v_mfma_f32_16x16x32_bf16 a[100:103], a[160:163], a[4:7], a[100:103]
    s_add_u32 s67, s67, 0x100000
    v_mfma_f32_16x16x32_bf16 a[104:107], a[160:163], a[8:11], a[104:107]
    ds_read_b64_tr_b16 a[180:181], v251 offset:7296
    v_mfma_f32_16x16x32_bf16 a[104:107], a[164:167], a[24:27], a[104:107]
    buffer_store_dwordx4 v[228:231], v2, s[52:55], s67 offen sc0 sc1
    v_mfma_f32_16x16x32_bf16 a[108:111], a[164:167], a[28:31], a[108:111]
    ds_read_b64_tr_b16 a[182:183], v251 offset:9088
    v_mfma_f32_16x16x32_bf16 a[108:111], a[160:163], a[12:15], a[108:111]
    s_add_u32 s67, s67, 0x100000
    s_waitcnt lgkmcnt(4)
    v_mfma_f32_16x16x32_bf16 a[124:127], a[168:171], a[12:15], a[124:127]
    ds_read_b64_tr_b16 a[160:161], v251 offset:14464
    v_bfe_u32 v228, v1, 4, 1
    v_mfma_f32_16x16x32_bf16 a[124:127], a[172:175], a[28:31], a[124:127]
    v_bfe_u32 v229, v1, 3, 1
    v_mfma_f32_16x16x32_bf16 a[120:123], a[172:175], a[24:27], a[120:123]
    ds_read_b64_tr_b16 a[162:163], v251 offset:16256
    v_lshl_add_u32 v228, v229, 3, v228
    v_mfma_f32_16x16x32_bf16 a[120:123], a[168:171], a[8:11], a[120:123]
    v_lshrrev_b32 v229, 5, v1
    v_mfma_f32_16x16x32_bf16 a[116:119], a[168:171], a[4:7], a[116:119]
    ds_read_b64_tr_b16 a[164:165], v251 offset:21632
    v_lshl_add_u32 v228, v229, 4, v228
    v_mfma_f32_16x16x32_bf16 a[116:119], a[172:175], a[20:23], a[116:119]
    s_lshl_b32 s66, s69, 6
    v_mfma_f32_16x16x32_bf16 a[112:115], a[172:175], a[16:19], a[112:115]
    ds_read_b64_tr_b16 a[166:167], v251 offset:23424
    v_add_u32 v228, s66, v228
    v_mfma_f32_16x16x32_bf16 a[112:115], a[168:171], a[0:3], a[112:115]
    v_and_b32 v229, 7, v1
    s_waitcnt lgkmcnt(4)
    v_mfma_f32_16x16x32_bf16 v[132:135], a[176:179], a[0:3], v[132:135]
    ds_read_b64_tr_b16 a[168:169], v251 offset:160
    s_lshl_b32 s66, s56, 2
    v_mfma_f32_16x16x32_bf16 v[132:135], a[180:183], a[16:19], v[132:135]
    s_add_u32 s66, s66, s57
    v_mfma_f32_16x16x32_bf16 v[136:139], a[180:183], a[20:23], v[136:139]
    ds_read_b64_tr_b16 a[170:171], v251 offset:1952
    s_lshl_b32 s66, s66, 6
    v_mfma_f32_16x16x32_bf16 v[136:139], a[176:179], a[4:7], v[136:139]
    v_lshl_add_u32 v229, v229, 3, s66
    v_mfma_f32_16x16x32_bf16 v[140:143], a[176:179], a[8:11], v[140:143]
    ds_read_b64_tr_b16 a[172:173], v251 offset:7328
    v_lshl_add_u32 v230, v228, 11, v229
    v_mfma_f32_16x16x32_bf16 v[140:143], a[180:183], a[24:27], v[140:143]
    v_accvgpr_write_b32 a221, v230
    v_mfma_f32_16x16x32_bf16 v[144:147], a[180:183], a[28:31], v[144:147]
    ds_read_b64_tr_b16 a[174:175], v251 offset:9120
    s_mul_i32 s5, s57, 56
    v_mfma_f32_16x16x32_bf16 v[144:147], a[176:179], a[12:15], v[144:147]
    s_add_u32 s5, s5, s26
    s_waitcnt lgkmcnt(4)
    v_mfma_f32_16x16x32_bf16 v[160:163], a[160:163], a[12:15], v[160:163]
    ds_read_b64_tr_b16 a[176:177], v251 offset:14496
    s_lshr_b32 s4, s26, 1
    v_mfma_f32_16x16x32_bf16 v[160:163], a[164:167], a[28:31], v[160:163]
    s_mul_i32 s4, s4, 5
    v_mfma_f32_16x16x32_bf16 v[156:159], a[164:167], a[24:27], v[156:159]
    ds_read_b64_tr_b16 a[178:179], v251 offset:16288
    s_add_u32 s4, s4, s5
    v_mfma_f32_16x16x32_bf16 v[156:159], a[160:163], a[8:11], v[156:159]
    s_lshl_b32 s4, s4, 15
    v_mfma_f32_16x16x32_bf16 v[152:155], a[160:163], a[4:7], v[152:155]
    ds_read_b64_tr_b16 a[180:181], v251 offset:21664
    s_and_b32 s66, s26, 0
    v_mfma_f32_16x16x32_bf16 v[152:155], a[164:167], a[20:23], v[152:155]
    s_lshl_b32 s66, s66, 14
    v_mfma_f32_16x16x32_bf16 v[148:151], a[164:167], a[16:19], v[148:151]
    ds_read_b64_tr_b16 a[182:183], v251 offset:23456
    s_sub_u32 s4, s4, s66
    v_mfma_f32_16x16x32_bf16 v[148:151], a[160:163], a[0:3], v[148:151]
    s_mul_i32 s66, s26, 6
    s_waitcnt lgkmcnt(4)
    v_mfma_f32_16x16x32_bf16 v[164:167], a[168:171], a[0:3], v[164:167]
    ds_read_b64_tr_b16 a[160:161], v251 offset:192
    s_add_u32 s5, s5, s66
    v_mfma_f32_16x16x32_bf16 v[164:167], a[172:175], a[16:19], v[164:167]
    s_add_u32 s5, s5, 6
    v_mfma_f32_16x16x32_bf16 v[168:171], a[172:175], a[20:23], v[168:171]
    ds_read_b64_tr_b16 a[162:163], v251 offset:1984
    s_lshl_b32 s5, s5, 15
    v_mfma_f32_16x16x32_bf16 v[168:171], a[168:171], a[4:7], v[168:171]
    s_mul_i32 s70, s69, 724992
    v_mfma_f32_16x16x32_bf16 v[172:175], a[168:171], a[8:11], v[172:175]
    ds_read_b64_tr_b16 a[164:165], v251 offset:7360
    s_mul_i32 s66, s57, 180224
    v_mfma_f32_16x16x32_bf16 v[172:175], a[172:175], a[24:27], v[172:175]
    s_add_u32 s70, s70, s66
    v_mfma_f32_16x16x32_bf16 v[176:179], a[172:175], a[28:31], v[176:179]
    ds_read_b64_tr_b16 a[166:167], v251 offset:9152
    s_lshl_b32 s65, s56, 12
    v_mfma_f32_16x16x32_bf16 v[176:179], a[168:171], a[12:15], v[176:179]
    s_add_u32 s65, s65, s70
    s_waitcnt lgkmcnt(4)
    v_mfma_f32_16x16x32_bf16 v[192:195], a[176:179], a[12:15], v[192:195]
    ds_read_b64_tr_b16 a[168:169], v251 offset:14528
    s_lshr_b32 s6, s56, 1
    v_mfma_f32_16x16x32_bf16 v[192:195], a[180:183], a[28:31], v[192:195]
    s_add_u32 s6, s6, 24
    v_mfma_f32_16x16x32_bf16 v[188:191], a[180:183], a[24:27], v[188:191]
    ds_read_b64_tr_b16 a[170:171], v251 offset:16320
    s_lshl_b32 s6, s6, 12
    v_mfma_f32_16x16x32_bf16 v[188:191], a[176:179], a[8:11], v[188:191]
    s_add_u32 s6, s6, s70
    v_mfma_f32_16x16x32_bf16 v[184:187], a[176:179], a[4:7], v[184:187]
    ds_read_b64_tr_b16 a[172:173], v251 offset:21696
    s_and_b32 s66, s56, 1
    v_mfma_f32_16x16x32_bf16 v[184:187], a[180:183], a[20:23], v[184:187]
    s_lshl_b32 s66, s66, 9
    v_mfma_f32_16x16x32_bf16 v[180:183], a[180:183], a[16:19], v[180:183]
    ds_read_b64_tr_b16 a[174:175], v251 offset:23488
    s_add_u32 s6, s6, s66
    v_mfma_f32_16x16x32_bf16 v[180:183], a[176:179], a[0:3], v[180:183]
    s_add_u32 s7, s65, 114688
    s_waitcnt lgkmcnt(4)
    v_mfma_f32_16x16x32_bf16 v[196:199], a[160:163], a[0:3], v[196:199]
    ds_read_b128 a[176:179], v253 offset:0
    s_add_u32 s27, s65, 147456
    v_mfma_f32_16x16x32_bf16 v[196:199], a[164:167], a[16:19], v[196:199]
    v_bfe_u32 v236, v1, 2, 3
    v_mfma_f32_16x16x32_bf16 v[200:203], a[164:167], a[20:23], v[200:203]
    v_mul_u32_u24 v236, 288, v236
    v_mfma_f32_16x16x32_bf16 v[200:203], a[160:163], a[4:7], v[200:203]
    v_lshrrev_b32 v237, 5, v1
    v_mfma_f32_16x16x32_bf16 v[204:207], a[160:163], a[8:11], v[204:207]
    ds_read_b128 a[180:183], v254 offset:0
    s_add_u32 m0, s63, 0
    v_lshl_add_u32 v236, v237, 12, v236
    v_mfma_f32_16x16x32_bf16 v[204:207], a[164:167], a[24:27], v[204:207]
    buffer_load_dwordx4 v242, s[32:35], s60 offen lds
    v_and_b32 v237, 3, v1
    v_mfma_f32_16x16x32_bf16 v[208:211], a[164:167], a[28:31], v[208:211]
    v_lshl_add_u32 v236, v237, 3, v236
    v_mfma_f32_16x16x32_bf16 v[208:211], a[160:163], a[12:15], v[208:211]
    v_accvgpr_write_b32 a220, v236
    s_waitcnt lgkmcnt(2)
    v_mfma_f32_16x16x32_bf16 v[224:227], a[168:171], a[12:15], v[224:227]
    ds_read_b128 a[160:163], v253 offset:4096
    v_bfe_u32 v236, v1, 2, 3
    v_mfma_f32_16x16x32_bf16 v[224:227], a[172:175], a[28:31], v[224:227]
    buffer_load_dwordx4 v243, s[32:35], s60 offen offset:1024 lds
    v_and_b32 v255, 3, v1
    v_mfma_f32_16x16x32_bf16 v[220:223], a[172:175], a[24:27], v[220:223]
    v_lshl_or_b32 v255, v236, 5, v255
    v_mfma_f32_16x16x32_bf16 v[220:223], a[168:171], a[8:11], v[220:223]
    s_and_b32 s66, s20, 203776
    v_mfma_f32_16x16x32_bf16 v[216:219], a[168:171], a[4:7], v[216:219]
    ds_read_b128 a[164:167], v254 offset:4096
    v_lshl_or_b32 v255, v255, 8, s66
    v_mfma_f32_16x16x32_bf16 v[216:219], a[172:175], a[20:23], v[216:219]
    buffer_load_dwordx4 v244, s[32:35], s60 offen offset:2048 lds
    s_lshl_b32 s28, s56, 12
    v_mfma_f32_16x16x32_bf16 v[212:215], a[172:175], a[16:19], v[212:215]
    s_xor_b32 s8, s57, 0
    v_mfma_f32_16x16x32_bf16 v[212:215], a[168:171], a[0:3], v[212:215]
    s_lshl_b32 s8, s8, 16
    s_waitcnt lgkmcnt(2)
    v_mfma_f32_16x16x32_bf16 v[4:7], a[0:3], a[176:179], v[4:7]
    ds_read_b128 a[168:171], v253 offset:2048
    s_xor_b32 s9, s57, 1
    v_mfma_f32_16x16x32_bf16 v[4:7], a[16:19], a[180:183], v[4:7]
    buffer_load_dwordx4 v245, s[32:35], s60 offen offset:3072 lds
    s_lshl_b32 s9, s9, 16
    v_mfma_f32_16x16x32_bf16 v[8:11], a[20:23], a[180:183], v[8:11]
    s_xor_b32 s10, s57, 2
    v_mfma_f32_16x16x32_bf16 v[8:11], a[4:7], a[176:179], v[8:11]
    s_lshl_b32 s10, s10, 16
    v_mfma_f32_16x16x32_bf16 v[12:15], a[8:11], a[176:179], v[12:15]
    ds_read_b128 a[172:175], v254 offset:2048
    s_add_u32 m0, s63, 4096
    s_xor_b32 s11, s57, 3
    v_mfma_f32_16x16x32_bf16 v[12:15], a[24:27], a[180:183], v[12:15]
    buffer_load_dwordx4 v246, s[32:35], s60 offen lds
    s_lshl_b32 s11, s11, 16
    v_mfma_f32_16x16x32_bf16 v[16:19], a[28:31], a[180:183], v[16:19]
    s_add_u32 s52, s22, 0x1c60000
    s_addc_u32 s53, s23, 0
    v_mfma_f32_16x16x32_bf16 v[16:19], a[12:15], a[176:179], v[16:19]
    s_mov_b32 s54, 524288
    s_waitcnt lgkmcnt(2)
    v_mfma_f32_16x16x32_bf16 v[48:51], a[12:15], a[160:163], v[48:51]
    ds_read_b128 a[176:179], v253 offset:6144
    s_lshr_b32 s66, s58, 1
    s_lshl_b32 s66, s66, 7
    v_mfma_f32_16x16x32_bf16 v[48:51], a[28:31], a[164:167], v[48:51]
    s_add_u32 s8, s8, s66
    v_mfma_f32_16x16x32_bf16 v[44:47], a[24:27], a[164:167], v[44:47]
    s_add_u32 s9, s9, s66
    v_mfma_f32_16x16x32_bf16 v[44:47], a[8:11], a[160:163], v[44:47]
    s_add_u32 s10, s10, s66
    v_mfma_f32_16x16x32_bf16 v[40:43], a[4:7], a[160:163], v[40:43]
    ds_read_b128 a[180:183], v254 offset:6144
    s_add_u32 s11, s11, s66
    v_mfma_f32_16x16x32_bf16 v[40:43], a[20:23], a[164:167], v[40:43]
    buffer_load_dwordx4 v247, s[32:35], s60 offen offset:1024 lds
    v_mfma_f32_16x16x32_bf16 v[36:39], a[16:19], a[164:167], v[36:39]
    v_mfma_f32_16x16x32_bf16 v[36:39], a[0:3], a[160:163], v[36:39]
    s_waitcnt vmcnt(20) lgkmcnt(2)
    s_barrier
    v_mfma_f32_16x16x32_bf16 v[20:23], a[0:3], a[168:171], v[20:23]
    ds_read_b64_tr_b16 a[160:161], v251 offset:28672
    v_mfma_f32_16x16x32_bf16 v[20:23], a[16:19], a[172:175], v[20:23]
    buffer_load_dwordx4 v248, s[32:35], s60 offen offset:2048 lds
    v_mfma_f32_16x16x32_bf16 v[24:27], a[20:23], a[172:175], v[24:27]
    ds_read_b64_tr_b16 a[162:163], v251 offset:30464
    v_mfma_f32_16x16x32_bf16 v[24:27], a[4:7], a[168:171], v[24:27]
    s_add_u32 s60, s60, 458752
    v_mfma_f32_16x16x32_bf16 v[28:31], a[8:11], a[168:171], v[28:31]
    ds_read_b64_tr_b16 a[164:165], v251 offset:35840
    s_add_u32 m0, s64, 57344
    v_mfma_f32_16x16x32_bf16 v[28:31], a[24:27], a[172:175], v[28:31]
    buffer_load_dwordx4 v249, s[36:39], s61 offen lds
    v_mfma_f32_16x16x32_bf16 v[32:35], a[28:31], a[172:175], v[32:35]
    ds_read_b64_tr_b16 a[166:167], v251 offset:37632
    v_mfma_f32_16x16x32_bf16 v[32:35], a[12:15], a[168:171], v[32:35]
    s_waitcnt lgkmcnt(4)
    v_mfma_f32_16x16x32_bf16 v[64:67], a[12:15], a[176:179], v[64:67]
    ds_read_b64_tr_b16 a[168:169], v251 offset:43008
    v_mfma_f32_16x16x32_bf16 v[64:67], a[28:31], a[180:183], v[64:67]
    buffer_load_dwordx4 v250, s[36:39], s61 offen offset:1024 lds
    v_mfma_f32_16x16x32_bf16 v[60:63], a[24:27], a[180:183], v[60:63]
    ds_read_b64_tr_b16 a[170:171], v251 offset:44800
    v_mfma_f32_16x16x32_bf16 v[60:63], a[8:11], a[176:179], v[60:63]
    s_add_u32 s61, s61, 128
    v_mfma_f32_16x16x32_bf16 v[56:59], a[4:7], a[176:179], v[56:59]
    ds_read_b64_tr_b16 a[172:173], v251 offset:50176
    v_mfma_f32_16x16x32_bf16 v[56:59], a[20:23], a[180:183], v[56:59]
    v_mfma_f32_16x16x32_bf16 v[52:55], a[16:19], a[180:183], v[52:55]
    ds_read_b64_tr_b16 a[174:175], v251 offset:51968
    v_mfma_f32_16x16x32_bf16 v[52:55], a[0:3], a[176:179], v[52:55]
    s_waitcnt vmcnt(13) lgkmcnt(4)
    v_mfma_f32_16x16x32_bf16 v[68:71], a[160:163], a[32:35], v[68:71]
    ds_read_b64_tr_b16 a[176:177], v251 offset:28704
    v_mfma_f32_16x16x32_bf16 v[68:71], a[164:167], a[48:51], v[68:71]
    buffer_load_dwordx4 a[0:3], v2, s[40:43], s62 offen sc1
    v_mfma_f32_16x16x32_bf16 v[72:75], a[164:167], a[52:55], v[72:75]
    ds_read_b64_tr_b16 a[178:179], v251 offset:30496
    v_mfma_f32_16x16x32_bf16 v[72:75], a[160:163], a[36:39], v[72:75]
    v_mfma_f32_16x16x32_bf16 v[76:79], a[160:163], a[40:43], v[76:79]
    ds_read_b64_tr_b16 a[180:181], v251 offset:35872
    v_mfma_f32_16x16x32_bf16 v[76:79], a[164:167], a[56:59], v[76:79]
    buffer_load_dwordx4 a[4:7], v2, s[40:43], s62 offen offset:1024 sc1
    v_mfma_f32_16x16x32_bf16 v[80:83], a[164:167], a[60:63], v[80:83]
    ds_read_b64_tr_b16 a[182:183], v251 offset:37664
    v_mfma_f32_16x16x32_bf16 v[80:83], a[160:163], a[44:47], v[80:83]
    s_waitcnt lgkmcnt(4)
    v_mfma_f32_16x16x32_bf16 v[96:99], a[168:171], a[44:47], v[96:99]
    ds_read_b64_tr_b16 a[160:161], v251 offset:43040
    v_mfma_f32_16x16x32_bf16 v[96:99], a[172:175], a[60:63], v[96:99]
    buffer_load_dwordx4 a[8:11], v2, s[40:43], s62 offen offset:2048 sc1
    v_mfma_f32_16x16x32_bf16 v[92:95], a[172:175], a[56:59], v[92:95]
    ds_read_b64_tr_b16 a[162:163], v251 offset:44832
    v_mfma_f32_16x16x32_bf16 v[92:95], a[168:171], a[40:43], v[92:95]
    v_mfma_f32_16x16x32_bf16 v[88:91], a[168:171], a[36:39], v[88:91]
    ds_read_b64_tr_b16 a[164:165], v251 offset:50208
    v_mfma_f32_16x16x32_bf16 v[88:91], a[172:175], a[52:55], v[88:91]
    v_mfma_f32_16x16x32_bf16 v[84:87], a[172:175], a[48:51], v[84:87]
    ds_read_b64_tr_b16 a[166:167], v251 offset:52000
    v_mfma_f32_16x16x32_bf16 v[84:87], a[168:171], a[32:35], v[84:87]
    s_waitcnt lgkmcnt(4)
    v_mfma_f32_16x16x32_bf16 v[100:103], a[176:179], a[32:35], v[100:103]
    ds_read_b64_tr_b16 a[168:169], v251 offset:28736
    v_mfma_f32_16x16x32_bf16 v[100:103], a[180:183], a[48:51], v[100:103]
    buffer_load_dwordx4 a[12:15], v2, s[40:43], s62 offen offset:3072 sc1
    v_mfma_f32_16x16x32_bf16 v[104:107], a[180:183], a[52:55], v[104:107]
    ds_read_b64_tr_b16 a[170:171], v251 offset:30528
    v_mfma_f32_16x16x32_bf16 v[104:107], a[176:179], a[36:39], v[104:107]
    s_add_u32 s62, s62, 4096
    v_mfma_f32_16x16x32_bf16 v[108:111], a[176:179], a[40:43], v[108:111]
    ds_read_b64_tr_b16 a[172:173], v251 offset:35904
    v_mfma_f32_16x16x32_bf16 v[108:111], a[180:183], a[56:59], v[108:111]
    buffer_load_dwordx4 a[16:19], v2, s[40:43], s62 offen sc1
    v_mfma_f32_16x16x32_bf16 v[112:115], a[180:183], a[60:63], v[112:115]
    ds_read_b64_tr_b16 a[174:175], v251 offset:37696
    v_mfma_f32_16x16x32_bf16 v[112:115], a[176:179], a[44:47], v[112:115]
    s_waitcnt lgkmcnt(4)
    v_mfma_f32_16x16x32_bf16 v[128:131], a[160:163], a[44:47], v[128:131]
    ds_read_b64_tr_b16 a[176:177], v251 offset:43072
    v_mfma_f32_16x16x32_bf16 v[128:131], a[164:167], a[60:63], v[128:131]
    v_mfma_f32_16x16x32_bf16 v[124:127], a[164:167], a[56:59], v[124:127]
    ds_read_b64_tr_b16 a[178:179], v251 offset:44864
    v_mfma_f32_16x16x32_bf16 v[124:127], a[160:163], a[40:43], v[124:127]
    v_mfma_f32_16x16x32_bf16 v[120:123], a[160:163], a[36:39], v[120:123]
    ds_read_b64_tr_b16 a[180:181], v251 offset:50240
    v_mfma_f32_16x16x32_bf16 v[120:123], a[164:167], a[52:55], v[120:123]
    buffer_load_dwordx4 a[20:23], v2, s[40:43], s62 offen offset:1024 sc1
    v_mfma_f32_16x16x32_bf16 v[116:119], a[164:167], a[48:51], v[116:119]
    ds_read_b64_tr_b16 a[182:183], v251 offset:52032
    v_mfma_f32_16x16x32_bf16 v[116:119], a[160:163], a[32:35], v[116:119]
    s_waitcnt lgkmcnt(4)
    v_mfma_f32_16x16x32_bf16 a[64:67], a[168:171], a[32:35], a[64:67]
    ds_read_b64_tr_b16 a[160:161], v251 offset:28768
    v_mfma_f32_16x16x32_bf16 a[64:67], a[172:175], a[48:51], a[64:67]
    buffer_load_dwordx4 a[24:27], v2, s[40:43], s62 offen offset:2048 sc1
    v_mfma_f32_16x16x32_bf16 a[68:71], a[172:175], a[52:55], a[68:71]
    ds_read_b64_tr_b16 a[162:163], v251 offset:30560
    v_mfma_f32_16x16x32_bf16 a[68:71], a[168:171], a[36:39], a[68:71]
    v_mfma_f32_16x16x32_bf16 a[72:75], a[168:171], a[40:43], a[72:75]
    ds_read_b64_tr_b16 a[164:165], v251 offset:35936
    v_mfma_f32_16x16x32_bf16 a[72:75], a[172:175], a[56:59], a[72:75]
    buffer_load_dwordx4 a[28:31], v2, s[40:43], s62 offen offset:3072 sc1
    v_mfma_f32_16x16x32_bf16 a[76:79], a[172:175], a[60:63], a[76:79]
    ds_read_b64_tr_b16 a[166:167], v251 offset:37728
    v_mfma_f32_16x16x32_bf16 a[76:79], a[168:171], a[44:47], a[76:79]
    s_add_u32 s62, s62, 4096
    s_waitcnt lgkmcnt(4)
    v_mfma_f32_16x16x32_bf16 a[92:95], a[176:179], a[44:47], a[92:95]
    ds_read_b64_tr_b16 a[168:169], v251 offset:43104
    v_mfma_f32_16x16x32_bf16 a[92:95], a[180:183], a[60:63], a[92:95]
    v_mfma_f32_16x16x32_bf16 a[88:91], a[180:183], a[56:59], a[88:91]
    ds_read_b64_tr_b16 a[170:171], v251 offset:44896
    v_mfma_f32_16x16x32_bf16 a[88:91], a[176:179], a[40:43], a[88:91]
    v_mfma_f32_16x16x32_bf16 a[84:87], a[176:179], a[36:39], a[84:87]
    ds_read_b64_tr_b16 a[172:173], v251 offset:50272
    s_add_u32 m0, s63, 28672
    v_mfma_f32_16x16x32_bf16 a[84:87], a[180:183], a[52:55], a[84:87]
    buffer_load_dwordx4 v242, s[32:35], s60 offen lds
    v_mfma_f32_16x16x32_bf16 a[80:83], a[180:183], a[48:51], a[80:83]
    ds_read_b64_tr_b16 a[174:175], v251 offset:52064
    v_mfma_f32_16x16x32_bf16 a[80:83], a[176:179], a[32:35], a[80:83]
    s_waitcnt lgkmcnt(4)
    v_mfma_f32_16x16x32_bf16 a[96:99], a[160:163], a[32:35], a[96:99]
    ds_read_b64_tr_b16 a[176:177], v251 offset:28800
    v_mfma_f32_16x16x32_bf16 a[96:99], a[164:167], a[48:51], a[96:99]
    buffer_load_dwordx4 v243, s[32:35], s60 offen offset:1024 lds
    v_mfma_f32_16x16x32_bf16 a[100:103], a[164:167], a[52:55], a[100:103]
    ds_read_b64_tr_b16 a[178:179], v251 offset:30592
    v_mfma_f32_16x16x32_bf16 a[100:103], a[160:163], a[36:39], a[100:103]
    v_mfma_f32_16x16x32_bf16 a[104:107], a[160:163], a[40:43], a[104:107]
    ds_read_b64_tr_b16 a[180:181], v251 offset:35968
    v_mfma_f32_16x16x32_bf16 a[104:107], a[164:167], a[56:59], a[104:107]
    v_mfma_f32_16x16x32_bf16 a[108:111], a[164:167], a[60:63], a[108:111]
    ds_read_b64_tr_b16 a[182:183], v251 offset:37760
    v_mfma_f32_16x16x32_bf16 a[108:111], a[160:163], a[44:47], a[108:111]
    s_waitcnt lgkmcnt(4)
    v_mfma_f32_16x16x32_bf16 a[124:127], a[168:171], a[44:47], a[124:127]
    ds_read_b64_tr_b16 a[160:161], v251 offset:43136
    v_mfma_f32_16x16x32_bf16 a[124:127], a[172:175], a[60:63], a[124:127]
    buffer_load_dwordx4 v244, s[32:35], s60 offen offset:2048 lds
    v_mfma_f32_16x16x32_bf16 a[120:123], a[172:175], a[56:59], a[120:123]
    ds_read_b64_tr_b16 a[162:163], v251 offset:44928
    v_mfma_f32_16x16x32_bf16 a[120:123], a[168:171], a[40:43], a[120:123]
    v_mfma_f32_16x16x32_bf16 a[116:119], a[168:171], a[36:39], a[116:119]
    ds_read_b64_tr_b16 a[164:165], v251 offset:50304
    v_mfma_f32_16x16x32_bf16 a[116:119], a[172:175], a[52:55], a[116:119]
    buffer_load_dwordx4 v245, s[32:35], s60 offen offset:3072 lds
    v_mfma_f32_16x16x32_bf16 a[112:115], a[172:175], a[48:51], a[112:115]
    ds_read_b64_tr_b16 a[166:167], v251 offset:52096
    v_mfma_f32_16x16x32_bf16 a[112:115], a[168:171], a[32:35], a[112:115]
    s_waitcnt lgkmcnt(4)
    v_mfma_f32_16x16x32_bf16 v[132:135], a[176:179], a[32:35], v[132:135]
    ds_read_b64_tr_b16 a[168:169], v251 offset:28832
    s_add_u32 m0, s63, 32768
    v_mfma_f32_16x16x32_bf16 v[132:135], a[180:183], a[48:51], v[132:135]
    buffer_load_dwordx4 v246, s[32:35], s60 offen lds
    v_mfma_f32_16x16x32_bf16 v[136:139], a[180:183], a[52:55], v[136:139]
    ds_read_b64_tr_b16 a[170:171], v251 offset:30624
    v_mfma_f32_16x16x32_bf16 v[136:139], a[176:179], a[36:39], v[136:139]
    v_mfma_f32_16x16x32_bf16 v[140:143], a[176:179], a[40:43], v[140:143]
    ds_read_b64_tr_b16 a[172:173], v251 offset:36000
    v_mfma_f32_16x16x32_bf16 v[140:143], a[180:183], a[56:59], v[140:143]
    v_mfma_f32_16x16x32_bf16 v[144:147], a[180:183], a[60:63], v[144:147]
    ds_read_b64_tr_b16 a[174:175], v251 offset:37792
    v_mfma_f32_16x16x32_bf16 v[144:147], a[176:179], a[44:47], v[144:147]
    s_waitcnt lgkmcnt(4)
    v_mfma_f32_16x16x32_bf16 v[160:163], a[160:163], a[44:47], v[160:163]
    ds_read_b64_tr_b16 a[176:177], v251 offset:43168
    v_mfma_f32_16x16x32_bf16 v[160:163], a[164:167], a[60:63], v[160:163]
    buffer_load_dwordx4 v247, s[32:35], s60 offen offset:1024 lds
    v_mfma_f32_16x16x32_bf16 v[156:159], a[164:167], a[56:59], v[156:159]
    ds_read_b64_tr_b16 a[178:179], v251 offset:44960
    v_mfma_f32_16x16x32_bf16 v[156:159], a[160:163], a[40:43], v[156:159]
    v_mfma_f32_16x16x32_bf16 v[152:155], a[160:163], a[36:39], v[152:155]
    ds_read_b64_tr_b16 a[180:181], v251 offset:50336
    v_mfma_f32_16x16x32_bf16 v[152:155], a[164:167], a[52:55], v[152:155]
    buffer_load_dwordx4 v248, s[32:35], s60 offen offset:2048 lds
    v_mfma_f32_16x16x32_bf16 v[148:151], a[164:167], a[48:51], v[148:151]
    ds_read_b64_tr_b16 a[182:183], v251 offset:52128
    v_mfma_f32_16x16x32_bf16 v[148:151], a[160:163], a[32:35], v[148:151]
    s_add_u32 s60, s60, 458752
    s_add_u32 s63, s63, s68
    s_waitcnt lgkmcnt(4)
    v_mfma_f32_16x16x32_bf16 v[164:167], a[168:171], a[32:35], v[164:167]
    ds_read_b64_tr_b16 a[160:161], v251 offset:28864
    v_mfma_f32_16x16x32_bf16 v[164:167], a[172:175], a[48:51], v[164:167]
    v_mfma_f32_16x16x32_bf16 v[168:171], a[172:175], a[52:55], v[168:171]
    ds_read_b64_tr_b16 a[162:163], v251 offset:30656
    v_mfma_f32_16x16x32_bf16 v[168:171], a[168:171], a[36:39], v[168:171]
    v_mfma_f32_16x16x32_bf16 v[172:175], a[168:171], a[40:43], v[172:175]
    ds_read_b64_tr_b16 a[164:165], v251 offset:36032
    s_add_u32 m0, s64, 65536
    v_mfma_f32_16x16x32_bf16 v[172:175], a[172:175], a[56:59], v[172:175]
    buffer_load_dwordx4 v249, s[36:39], s61 offen lds
    v_mfma_f32_16x16x32_bf16 v[176:179], a[172:175], a[60:63], v[176:179]
    ds_read_b64_tr_b16 a[166:167], v251 offset:37824
    v_mfma_f32_16x16x32_bf16 v[176:179], a[168:171], a[44:47], v[176:179]
    s_waitcnt lgkmcnt(4)
    v_mfma_f32_16x16x32_bf16 v[192:195], a[176:179], a[44:47], v[192:195]
    ds_read_b64_tr_b16 a[168:169], v251 offset:43200
    v_mfma_f32_16x16x32_bf16 v[192:195], a[180:183], a[60:63], v[192:195]
    buffer_load_dwordx4 v250, s[36:39], s61 offen offset:1024 lds
    v_mfma_f32_16x16x32_bf16 v[188:191], a[180:183], a[56:59], v[188:191]
    ds_read_b64_tr_b16 a[170:171], v251 offset:44992
    v_mfma_f32_16x16x32_bf16 v[188:191], a[176:179], a[40:43], v[188:191]
    s_add_u32 s61, s61, 128
    s_add_u32 s64, s64, s68
    s_sub_u32 s68, 0, s68
    v_mfma_f32_16x16x32_bf16 v[184:187], a[176:179], a[36:39], v[184:187]
    ds_read_b64_tr_b16 a[172:173], v251 offset:50368
    v_mfma_f32_16x16x32_bf16 v[184:187], a[180:183], a[52:55], v[184:187]
    buffer_load_dwordx4 a[128:131], v2, s[40:43], s62 offen sc1
    v_mfma_f32_16x16x32_bf16 v[180:183], a[180:183], a[48:51], v[180:183]
    ds_read_b64_tr_b16 a[174:175], v251 offset:52160
    v_mfma_f32_16x16x32_bf16 v[180:183], a[176:179], a[32:35], v[180:183]
    s_waitcnt lgkmcnt(4)
    v_mfma_f32_16x16x32_bf16 v[196:199], a[160:163], a[32:35], v[196:199]
    ds_read_b128 a[176:179], v253 offset:8192
    v_swap_b32 v251, v252
    v_mfma_f32_16x16x32_bf16 v[196:199], a[164:167], a[48:51], v[196:199]
    v_lshrrev_b32 v236, 4, v1
    v_mfma_f32_16x16x32_bf16 v[200:203], a[164:167], a[52:55], v[200:203]
    v_lshlrev_b32 v237, 1, v236
    v_mfma_f32_16x16x32_bf16 v[200:203], a[160:163], a[36:39], v[200:203]
    v_xor_b32 v237, v237, v1
    v_mfma_f32_16x16x32_bf16 v[204:207], a[160:163], a[40:43], v[204:207]
    ds_read_b128 a[180:183], v254 offset:8192
    s_lshl_b32 s66, s57, 2
    v_mfma_f32_16x16x32_bf16 v[204:207], a[164:167], a[56:59], v[204:207]
    buffer_load_dwordx4 a[132:135], v2, s[40:43], s62 offen offset:1024 sc1
    v_xor_b32 v237, s66, v237
    v_mfma_f32_16x16x32_bf16 v[208:211], a[164:167], a[60:63], v[208:211]
    v_and_b32 v237, 15, v237
    v_mfma_f32_16x16x32_bf16 v[208:211], a[160:163], a[44:47], v[208:211]
    v_lshlrev_b32 v237, 4, v237
    s_waitcnt lgkmcnt(2)
    v_mfma_f32_16x16x32_bf16 v[224:227], a[168:171], a[44:47], v[224:227]
    ds_read_b128 a[160:163], v253 offset:12288
    v_lshl_add_u32 v237, v236, 11, v237
    v_mfma_f32_16x16x32_bf16 v[224:227], a[172:175], a[60:63], v[224:227]
    buffer_load_dwordx4 a[136:139], v2, s[40:43], s62 offen offset:2048 sc1
    s_lshl_b32 s66, s56, 8
    v_mfma_f32_16x16x32_bf16 v[220:223], a[172:175], a[56:59], v[220:223]
    v_add_u32 v242, s66, v237
    v_mfma_f32_16x16x32_bf16 v[220:223], a[168:171], a[40:43], v[220:223]
    v_xor_b32 v237, 128, v242
    v_mfma_f32_16x16x32_bf16 v[216:219], a[168:171], a[36:39], v[216:219]
    ds_read_b128 a[164:167], v254 offset:12288
    v_add_u32 v243, 15360, v237
    v_mfma_f32_16x16x32_bf16 v[216:219], a[172:175], a[52:55], v[216:219]
    v_add_u32 v244, 6144, v242
    v_mfma_f32_16x16x32_bf16 v[212:215], a[172:175], a[48:51], v[212:215]
    v_add_u32 v245, 21504, v237
    v_mfma_f32_16x16x32_bf16 v[212:215], a[168:171], a[32:35], v[212:215]
    s_lshl_b32 s64, s26, 12
    s_waitcnt lgkmcnt(2)
    v_mfma_f32_16x16x32_bf16 v[4:7], a[32:35], a[176:179], v[4:7]
    ds_read_b128 a[168:171], v253 offset:10240
    s_lshl_b32 s68, s26, 10
    v_mfma_f32_16x16x32_bf16 v[4:7], a[48:51], a[180:183], v[4:7]
    buffer_load_dwordx4 a[140:143], v2, s[40:43], s62 offen offset:3072 sc1
    v_and_b32 v237, 1, v236
    v_mfma_f32_16x16x32_bf16 v[8:11], a[52:55], a[180:183], v[8:11]
    v_lshl_add_u32 v246, v237, 10, v3
    v_mfma_f32_16x16x32_bf16 v[8:11], a[36:39], a[176:179], v[8:11]
    s_add_u32 s62, s62, 4096
    v_lshrrev_b32 v237, 1, v236
    v_mfma_f32_16x16x32_bf16 v[12:15], a[40:43], a[176:179], v[12:15]
    ds_read_b128 a[172:175], v254 offset:10240
    v_lshl_add_u32 v246, v237, 8, v246
    v_mfma_f32_16x16x32_bf16 v[12:15], a[56:59], a[180:183], v[12:15]
    buffer_load_dwordx4 a[144:147], v2, s[40:43], s62 offen sc1
    s_add_u32 s32, s22, 0x500000
    s_addc_u32 s33, s23, 0
    v_mfma_f32_16x16x32_bf16 v[16:19], a[60:63], a[180:183], v[16:19]
    s_mov_b32 s34, 23199744
    v_mfma_f32_16x16x32_bf16 v[16:19], a[44:47], a[176:179], v[16:19]
    s_lshl_b32 s63, s26, 13
    s_waitcnt lgkmcnt(2)
    v_mfma_f32_16x16x32_bf16 v[48:51], a[44:47], a[160:163], v[48:51]
    ds_read_b128 a[176:179], v253 offset:14336
    s_add_u32 s63, s63, 131072
    v_mfma_f32_16x16x32_bf16 v[48:51], a[60:63], a[164:167], v[48:51]
    buffer_load_dwordx4 a[148:151], v2, s[40:43], s62 offen offset:1024 sc1
    v_add_u32 v247, s63, v2
    v_mfma_f32_16x16x32_bf16 v[44:47], a[56:59], a[164:167], v[44:47]
    v_add_u32 v248, s63, v3
    v_mfma_f32_16x16x32_bf16 v[44:47], a[40:43], a[160:163], v[44:47]
    v_and_b32 v249, 7, v1
    v_mfma_f32_16x16x32_bf16 v[40:43], a[36:39], a[160:163], v[40:43]
    ds_read_b128 a[180:183], v254 offset:14336
    v_swap_b32 v253, v232
    v_mfma_f32_16x16x32_bf16 v[40:43], a[52:55], a[164:167], v[40:43]
    s_andn2_b32 s66, s20, 7168
    v_mfma_f32_16x16x32_bf16 v[36:39], a[48:51], a[164:167], v[36:39]
    v_lshl_or_b32 v249, v249, 10, s66
    v_mfma_f32_16x16x32_bf16 v[36:39], a[32:35], a[160:163], v[36:39]
    s_mov_b32 s60, s70
    s_waitcnt vmcnt(23) lgkmcnt(2)
    s_barrier
    v_mfma_f32_16x16x32_bf16 v[20:23], a[32:35], a[168:171], v[20:23]
    ds_read_b128 a[160:163], v253 offset:0
    v_swap_b32 v254, v233
    v_mfma_f32_16x16x32_bf16 v[20:23], a[48:51], a[172:175], v[20:23]
    buffer_load_dwordx4 a[152:155], v2, s[40:43], s62 offen offset:2048 sc1
    v_mfma_f32_16x16x32_bf16 v[24:27], a[52:55], a[172:175], v[24:27]
    v_mfma_f32_16x16x32_bf16 v[24:27], a[36:39], a[168:171], v[24:27]
    v_mfma_f32_16x16x32_bf16 v[28:31], a[40:43], a[168:171], v[28:31]
    ds_read_b128 a[164:167], v254 offset:0
    v_mfma_f32_16x16x32_bf16 v[28:31], a[56:59], a[172:175], v[28:31]
    buffer_load_dwordx4 a[156:159], v2, s[40:43], s62 offen offset:3072 sc1
    v_mfma_f32_16x16x32_bf16 v[32:35], a[60:63], a[172:175], v[32:35]
    v_mfma_f32_16x16x32_bf16 v[32:35], a[44:47], a[168:171], v[32:35]
    s_add_u32 s62, s62, 4096
    s_waitcnt lgkmcnt(2)
    v_mfma_f32_16x16x32_bf16 v[64:67], a[44:47], a[176:179], v[64:67]
    ds_read_b128 a[168:171], v253 offset:4096
    v_mfma_f32_16x16x32_bf16 v[64:67], a[60:63], a[180:183], v[64:67]
    v_mfma_f32_16x16x32_bf16 v[60:63], a[56:59], a[180:183], v[60:63]
    v_mfma_f32_16x16x32_bf16 v[60:63], a[40:43], a[176:179], v[60:63]
    v_mfma_f32_16x16x32_bf16 v[56:59], a[36:39], a[176:179], v[56:59]
    ds_read_b128 a[172:175], v254 offset:4096
    v_mfma_f32_16x16x32_bf16 v[56:59], a[52:55], a[180:183], v[56:59]
    v_mfma_f32_16x16x32_bf16 v[52:55], a[48:51], a[180:183], v[52:55]
    v_mfma_f32_16x16x32_bf16 v[52:55], a[32:35], a[176:179], v[52:55]
    s_waitcnt vmcnt(17) lgkmcnt(2)
    v_mfma_f32_16x16x32_bf16 v[4:7], a[0:3], a[160:163], v[4:7]
    ds_read_b128 a[176:179], v253 offset:2048
    s_lshl_b32 s66, s58, 13
    v_mfma_f32_16x16x32_bf16 v[4:7], a[16:19], a[164:167], v[4:7]
    global_load_dword a255, v[234:235], off
    buffer_load_dword v252, v255, s[52:55], 0 offen sc0 sc1
    v_mfma_f32_16x16x32_bf16 v[8:11], a[20:23], a[164:167], v[8:11]
    s_add_u32 s66, s66, 0x1c20000
    s_add_u32 s40, s22, s66
    s_addc_u32 s41, s23, 0
    s_mov_b32 s42, 8192
    v_mfma_f32_16x16x32_bf16 v[8:11], a[4:7], a[160:163], v[8:11]
    v_mfma_f32_16x16x32_bf16 v[12:15], a[8:11], a[160:163], v[12:15]
    ds_read_b128 a[180:183], v254 offset:2048
    v_mfma_f32_16x16x32_bf16 v[12:15], a[24:27], a[164:167], v[12:15]
    v_mfma_f32_16x16x32_bf16 v[16:19], a[28:31], a[164:167], v[16:19]
    v_mfma_f32_16x16x32_bf16 v[16:19], a[12:15], a[160:163], v[16:19]
    s_waitcnt vmcnt(10) lgkmcnt(2)
    s_barrier
    v_mfma_f32_16x16x32_bf16 v[48:51], a[12:15], a[168:171], v[48:51]
    ds_read_b128 a[160:163], v253 offset:6144
    v_mfma_f32_16x16x32_bf16 v[48:51], a[28:31], a[172:175], v[48:51]
    v_mfma_f32_16x16x32_bf16 v[44:47], a[24:27], a[172:175], v[44:47]
    v_mfma_f32_16x16x32_bf16 v[44:47], a[8:11], a[168:171], v[44:47]
    v_mfma_f32_16x16x32_bf16 v[40:43], a[4:7], a[168:171], v[40:43]
    ds_read_b128 a[164:167], v254 offset:6144
    v_mfma_f32_16x16x32_bf16 v[40:43], a[20:23], a[172:175], v[40:43]
    s_add_u32 s61, s4, 0
    s_add_u32 m0, s64, 0
    v_mfma_f32_16x16x32_bf16 v[36:39], a[16:19], a[172:175], v[36:39]
    v_mfma_f32_16x16x32_bf16 v[36:39], a[0:3], a[168:171], v[36:39]
    buffer_load_dwordx4 v242, s[48:51], s61 offen lds
    s_waitcnt lgkmcnt(2)
    v_mfma_f32_16x16x32_bf16 v[20:23], a[0:3], a[176:179], v[20:23]
    ds_read_b128 a[168:171], v253 offset:8192
    v_mfma_f32_16x16x32_bf16 v[20:23], a[16:19], a[180:183], v[20:23]
    v_mfma_f32_16x16x32_bf16 v[24:27], a[20:23], a[180:183], v[24:27]
    v_mfma_f32_16x16x32_bf16 v[24:27], a[4:7], a[176:179], v[24:27]
    buffer_load_dwordx4 v243, s[48:51], s61 offen offset:1024 lds
    v_mfma_f32_16x16x32_bf16 v[28:31], a[8:11], a[176:179], v[28:31]
    ds_read_b128 a[172:175], v254 offset:8192
    v_mfma_f32_16x16x32_bf16 v[28:31], a[24:27], a[180:183], v[28:31]
    buffer_load_dwordx4 v244, s[48:51], s61 offen offset:2048 lds
    v_mfma_f32_16x16x32_bf16 v[32:35], a[28:31], a[180:183], v[32:35]
    v_mfma_f32_16x16x32_bf16 v[32:35], a[12:15], a[176:179], v[32:35]
    s_waitcnt lgkmcnt(2)
    v_mfma_f32_16x16x32_bf16 v[64:67], a[12:15], a[160:163], v[64:67]
    ds_read_b128 a[176:179], v253 offset:12288
    v_mfma_f32_16x16x32_bf16 v[64:67], a[28:31], a[164:167], v[64:67]
    v_mfma_f32_16x16x32_bf16 v[60:63], a[24:27], a[164:167], v[60:63]
    v_mfma_f32_16x16x32_bf16 v[60:63], a[8:11], a[160:163], v[60:63]
    buffer_load_dwordx4 v245, s[48:51], s61 offen offset:3072 lds
    v_mfma_f32_16x16x32_bf16 v[56:59], a[4:7], a[160:163], v[56:59]
    ds_read_b128 a[180:183], v254 offset:12288
    v_mfma_f32_16x16x32_bf16 v[56:59], a[20:23], a[164:167], v[56:59]
    s_add_u32 s61, s4, 458752
    s_add_u32 m0, s64, 16384
    v_mfma_f32_16x16x32_bf16 v[52:55], a[16:19], a[164:167], v[52:55]
    v_mfma_f32_16x16x32_bf16 v[52:55], a[0:3], a[160:163], v[52:55]
    buffer_load_dwordx4 v242, s[48:51], s61 offen lds
    s_waitcnt vmcnt(7) lgkmcnt(2)
    v_mfma_f32_16x16x32_bf16 v[4:7], a[128:131], a[168:171], v[4:7]
    ds_read_b128 a[160:163], v253 offset:10240
    v_mfma_f32_16x16x32_bf16 v[4:7], a[144:147], a[172:175], v[4:7]
    v_mfma_f32_16x16x32_bf16 v[8:11], a[148:151], a[172:175], v[8:11]
    v_mfma_f32_16x16x32_bf16 v[8:11], a[132:135], a[168:171], v[8:11]
    v_mfma_f32_16x16x32_bf16 v[12:15], a[136:139], a[168:171], v[12:15]
    ds_read_b128 a[164:167], v254 offset:10240
    v_mfma_f32_16x16x32_bf16 v[12:15], a[152:155], a[172:175], v[12:15]
    buffer_load_dwordx4 v243, s[48:51], s61 offen offset:1024 lds
    v_mfma_f32_16x16x32_bf16 v[16:19], a[156:159], a[172:175], v[16:19]
    v_mfma_f32_16x16x32_bf16 v[16:19], a[140:143], a[168:171], v[16:19]
    s_waitcnt lgkmcnt(2)
    v_mfma_f32_16x16x32_bf16 v[48:51], a[140:143], a[176:179], v[48:51]
    ds_read_b128 a[168:171], v253 offset:14336
    v_mfma_f32_16x16x32_bf16 v[48:51], a[156:159], a[180:183], v[48:51]
    v_mfma_f32_16x16x32_bf16 v[44:47], a[152:155], a[180:183], v[44:47]
    v_mfma_f32_16x16x32_bf16 v[44:47], a[136:139], a[176:179], v[44:47]
    buffer_load_dwordx4 v244, s[48:51], s61 offen offset:2048 lds
    v_mfma_f32_16x16x32_bf16 v[40:43], a[132:135], a[176:179], v[40:43]
    ds_read_b128 a[172:175], v254 offset:14336
    v_mfma_f32_16x16x32_bf16 v[40:43], a[148:151], a[180:183], v[40:43]
    buffer_load_dwordx4 v245, s[48:51], s61 offen offset:3072 lds
    v_mfma_f32_16x16x32_bf16 v[36:39], a[144:147], a[180:183], v[36:39]
    v_mfma_f32_16x16x32_bf16 v[36:39], a[128:131], a[176:179], v[36:39]
    s_waitcnt lgkmcnt(2)
    v_mfma_f32_16x16x32_bf16 v[20:23], a[128:131], a[160:163], v[20:23]
    ds_read_b64_tr_b16 a[176:177], v251 offset:0
    v_mfma_f32_16x16x32_bf16 v[20:23], a[144:147], a[164:167], v[20:23]
    s_add_u32 s61, s4, 917504
    s_add_u32 m0, s64, 32768
    v_mfma_f32_16x16x32_bf16 v[24:27], a[148:151], a[164:167], v[24:27]
    ds_read_b64_tr_b16 a[178:179], v251 offset:1792
    v_mfma_f32_16x16x32_bf16 v[24:27], a[132:135], a[160:163], v[24:27]
    buffer_load_dwordx4 v242, s[48:51], s61 offen lds
    v_mfma_f32_16x16x32_bf16 v[28:31], a[136:139], a[160:163], v[28:31]
    ds_read_b64_tr_b16 a[180:181], v251 offset:7168
    v_mfma_f32_16x16x32_bf16 v[28:31], a[152:155], a[164:167], v[28:31]
    buffer_load_dwordx4 v243, s[48:51], s61 offen offset:1024 lds
    v_mfma_f32_16x16x32_bf16 v[32:35], a[156:159], a[164:167], v[32:35]
    ds_read_b64_tr_b16 a[182:183], v251 offset:8960
    v_mfma_f32_16x16x32_bf16 v[32:35], a[140:143], a[160:163], v[32:35]
    s_waitcnt lgkmcnt(4)
    v_mfma_f32_16x16x32_bf16 v[64:67], a[140:143], a[168:171], v[64:67]
    ds_read_b64_tr_b16 a[160:161], v251 offset:14336
    v_mfma_f32_16x16x32_bf16 v[64:67], a[156:159], a[172:175], v[64:67]
    v_mfma_f32_16x16x32_bf16 v[60:63], a[152:155], a[172:175], v[60:63]
    ds_read_b64_tr_b16 a[162:163], v251 offset:16128
    v_mfma_f32_16x16x32_bf16 v[60:63], a[136:139], a[168:171], v[60:63]
    v_mfma_f32_16x16x32_bf16 v[56:59], a[132:135], a[168:171], v[56:59]
    ds_read_b64_tr_b16 a[164:165], v251 offset:21504
    v_mfma_f32_16x16x32_bf16 v[56:59], a[148:151], a[172:175], v[56:59]
    buffer_load_dwordx4 v244, s[48:51], s61 offen offset:2048 lds
    v_mfma_f32_16x16x32_bf16 v[52:55], a[144:147], a[172:175], v[52:55]
    ds_read_b64_tr_b16 a[166:167], v251 offset:23296
    v_mfma_f32_16x16x32_bf16 v[52:55], a[128:131], a[168:171], v[52:55]
    s_waitcnt lgkmcnt(4)
    s_barrier
    v_mfma_f32_16x16x32_bf16 v[68:71], a[176:179], a[0:3], v[68:71]
    ds_read_b64_tr_b16 a[168:169], v251 offset:28672
    v_mfma_f32_16x16x32_bf16 v[68:71], a[180:183], a[16:19], v[68:71]
    v_mfma_f32_16x16x32_bf16 v[72:75], a[180:183], a[20:23], v[72:75]
    ds_read_b64_tr_b16 a[170:171], v251 offset:30464
    v_mfma_f32_16x16x32_bf16 v[72:75], a[176:179], a[4:7], v[72:75]
    buffer_load_dwordx4 v245, s[48:51], s61 offen offset:3072 lds
    v_mfma_f32_16x16x32_bf16 v[76:79], a[176:179], a[8:11], v[76:79]
    ds_read_b64_tr_b16 a[172:173], v251 offset:35840
    v_mfma_f32_16x16x32_bf16 v[76:79], a[180:183], a[24:27], v[76:79]
    s_add_u32 s61, s4, 1376256
    s_add_u32 m0, s64, 49152
    v_mfma_f32_16x16x32_bf16 v[80:83], a[180:183], a[28:31], v[80:83]
    ds_read_b64_tr_b16 a[174:175], v251 offset:37632
    v_mfma_f32_16x16x32_bf16 v[80:83], a[176:179], a[12:15], v[80:83]
    buffer_load_dwordx4 v242, s[48:51], s61 offen lds
    s_waitcnt lgkmcnt(4)
    v_mfma_f32_16x16x32_bf16 v[96:99], a[160:163], a[12:15], v[96:99]
    ds_read_b64_tr_b16 a[176:177], v251 offset:43008
    v_mfma_f32_16x16x32_bf16 v[96:99], a[164:167], a[28:31], v[96:99]
    v_mfma_f32_16x16x32_bf16 v[92:95], a[164:167], a[24:27], v[92:95]
    ds_read_b64_tr_b16 a[178:179], v251 offset:44800
    v_mfma_f32_16x16x32_bf16 v[92:95], a[160:163], a[8:11], v[92:95]
    buffer_load_dwordx4 v243, s[48:51], s61 offen offset:1024 lds
    v_mfma_f32_16x16x32_bf16 v[88:91], a[160:163], a[4:7], v[88:91]
    ds_read_b64_tr_b16 a[180:181], v251 offset:50176
    v_mfma_f32_16x16x32_bf16 v[88:91], a[164:167], a[20:23], v[88:91]
    v_mfma_f32_16x16x32_bf16 v[84:87], a[164:167], a[16:19], v[84:87]
    ds_read_b64_tr_b16 a[182:183], v251 offset:51968
    v_mfma_f32_16x16x32_bf16 v[84:87], a[160:163], a[0:3], v[84:87]
    s_waitcnt lgkmcnt(4)
    v_mfma_f32_16x16x32_bf16 v[68:71], a[168:171], a[128:131], v[68:71]
    ds_read_b64_tr_b16 a[160:161], v251 offset:32
    v_mfma_f32_16x16x32_bf16 v[68:71], a[172:175], a[144:147], v[68:71]
    s_add_u32 s21, s3, 1
    s_waitcnt vmcnt(14)
    v_subrev_u32 v252, s21, v252
    v_cmp_lt_u32 vcc, 14, v252
    s_cbranch_vccnz fa_fx_slow
fa_fx_ok:
    v_mfma_f32_16x16x32_bf16 v[72:75], a[172:175], a[148:151], v[72:75]
    ds_read_b64_tr_b16 a[162:163], v251 offset:1824
    v_accvgpr_read_b32 v254, a221
    v_mfma_f32_16x16x32_bf16 v[72:75], a[168:171], a[132:135], v[72:75]
    buffer_load_dwordx4 v244, s[48:51], s61 offen offset:2048 lds
    s_mov_b32 s36, s24
    v_mfma_f32_16x16x32_bf16 v[76:79], a[168:171], a[136:139], v[76:79]
    ds_read_b64_tr_b16 a[164:165], v251 offset:7200
    s_mov_b32 s37, s25
    v_mfma_f32_16x16x32_bf16 v[76:79], a[172:175], a[152:155], v[76:79]
    buffer_load_dwordx4 v245, s[48:51], s61 offen offset:3072 lds
    s_mov_b32 s38, 4194304
    v_mfma_f32_16x16x32_bf16 v[80:83], a[172:175], a[156:159], v[80:83]
    ds_read_b64_tr_b16 a[166:167], v251 offset:8992
    v_mfma_f32_16x16x32_bf16 v[80:83], a[168:171], a[140:143], v[80:83]
    s_waitcnt lgkmcnt(4)
    v_mfma_f32_16x16x32_bf16 v[96:99], a[176:179], a[140:143], v[96:99]
    ds_read_b64_tr_b16 a[168:169], v251 offset:14368
    v_mfma_f32_16x16x32_bf16 v[96:99], a[180:183], a[156:159], v[96:99]
    s_mov_b32 s67, 0
    buffer_load_dwordx2 a[200:201], v254, s[36:39], s67 offen
    v_mfma_f32_16x16x32_bf16 v[92:95], a[180:183], a[152:155], v[92:95]
    ds_read_b64_tr_b16 a[170:171], v251 offset:16160
    v_mfma_f32_16x16x32_bf16 v[92:95], a[176:179], a[136:139], v[92:95]
    v_mfma_f32_16x16x32_bf16 v[88:91], a[176:179], a[132:135], v[88:91]
    ds_read_b64_tr_b16 a[172:173], v251 offset:21536
    v_mfma_f32_16x16x32_bf16 v[88:91], a[180:183], a[148:151], v[88:91]
    v_mfma_f32_16x16x32_bf16 v[84:87], a[180:183], a[144:147], v[84:87]
    ds_read_b64_tr_b16 a[174:175], v251 offset:23328
    v_mfma_f32_16x16x32_bf16 v[84:87], a[176:179], a[128:131], v[84:87]
    v_mov_b32 v240, 0xc0135761
    v_mov_b32 v241, 0xbdd2d3e8
    v_pk_mul_f32 v[228:229], v[76:77], v[76:77]
    v_pk_mul_f32 v[230:231], v[78:79], v[78:79]
    v_pk_mul_f32 v[232:233], v[80:81], v[80:81]
    v_pk_mul_f32 v[234:235], v[82:83], v[82:83]
    v_pk_fma_f32 v[228:229], v[228:229], v[240:241], v[240:241] op_sel:[0,1,0] op_sel_hi:[1,1,0]
    v_pk_fma_f32 v[230:231], v[230:231], v[240:241], v[240:241] op_sel:[0,1,0] op_sel_hi:[1,1,0]
    v_pk_fma_f32 v[232:233], v[232:233], v[240:241], v[240:241] op_sel:[0,1,0] op_sel_hi:[1,1,0]
    v_pk_fma_f32 v[234:235], v[234:235], v[240:241], v[240:241] op_sel:[0,1,0] op_sel_hi:[1,1,0]
    v_pk_mul_f32 v[228:229], v[228:229], v[76:77]
    v_pk_mul_f32 v[230:231], v[230:231], v[78:79]
    v_pk_mul_f32 v[232:233], v[232:233], v[80:81]
    v_pk_mul_f32 v[234:235], v[234:235], v[82:83]
    v_exp_f32 v228, v228
    v_exp_f32 v229, v229
    v_exp_f32 v230, v230
    v_exp_f32 v231, v231
    v_exp_f32 v232, v232
    v_exp_f32 v233, v233
    v_exp_f32 v234, v234
    v_exp_f32 v235, v235
    v_pk_mul_f32 v[76:77], v[76:77], v[92:93]
    v_pk_mul_f32 v[78:79], v[78:79], v[94:95]
    v_pk_mul_f32 v[80:81], v[80:81], v[96:97]
    v_pk_mul_f32 v[82:83], v[82:83], v[98:99]
    v_pk_add_f32 v[228:229], v[228:229], 1.0 op_sel_hi:[1,0]
    v_pk_add_f32 v[230:231], v[230:231], 1.0 op_sel_hi:[1,0]
    v_pk_add_f32 v[232:233], v[232:233], 1.0 op_sel_hi:[1,0]
    v_pk_add_f32 v[234:235], v[234:235], 1.0 op_sel_hi:[1,0]
    v_rcp_f32 v228, v228
    v_rcp_f32 v229, v229
    v_rcp_f32 v230, v230
    v_rcp_f32 v231, v231
    v_rcp_f32 v232, v232
    v_rcp_f32 v233, v233
    v_rcp_f32 v234, v234
    v_rcp_f32 v235, v235
    v_pk_mul_f32 v[76:77], v[76:77], v[228:229]
    v_pk_mul_f32 v[78:79], v[78:79], v[230:231]
    v_pk_mul_f32 v[80:81], v[80:81], v[232:233]
    v_pk_mul_f32 v[82:83], v[82:83], v[234:235]
    v_cvt_pk_bf16_f32 v236, v76, v77
    v_cvt_pk_bf16_f32 v238, v80, v81
    v_cvt_pk_bf16_f32 v237, v78, v79
    v_cvt_pk_bf16_f32 v239, v82, v83
    v_permlane16_swap_b32 v236, v238
    s_nop 0
    v_permlane16_swap_b32 v237, v239
    s_nop 0
    buffer_store_dwordx4 v[236:239], v246, s[32:35], s65 offen offset:2048 sc0 sc1
    v_pk_mul_f32 v[228:229], v[68:69], v[68:69]
    v_pk_mul_f32 v[230:231], v[70:71], v[70:71]
    v_pk_mul_f32 v[232:233], v[72:73], v[72:73]
    v_pk_mul_f32 v[234:235], v[74:75], v[74:75]
    v_pk_fma_f32 v[228:229], v[228:229], v[240:241], v[240:241] op_sel:[0,1,0] op_sel_hi:[1,1,0]
    v_pk_fma_f32 v[230:231], v[230:231], v[240:241], v[240:241] op_sel:[0,1,0] op_sel_hi:[1,1,0]
    v_pk_fma_f32 v[232:233], v[232:233], v[240:241], v[240:241] op_sel:[0,1,0] op_sel_hi:[1,1,0]
    v_pk_fma_f32 v[234:235], v[234:235], v[240:241], v[240:241] op_sel:[0,1,0] op_sel_hi:[1,1,0]
    v_pk_mul_f32 v[228:229], v[228:229], v[68:69]
    v_pk_mul_f32 v[230:231], v[230:231], v[70:71]
    v_pk_mul_f32 v[232:233], v[232:233], v[72:73]
    v_pk_mul_f32 v[234:235], v[234:235], v[74:75]
    v_exp_f32 v228, v228
    v_exp_f32 v229, v229
    v_exp_f32 v230, v230
    v_exp_f32 v231, v231
    v_exp_f32 v232, v232
    v_exp_f32 v233, v233
    v_exp_f32 v234, v234
    v_exp_f32 v235, v235
    v_pk_mul_f32 v[68:69], v[68:69], v[84:85]
    v_pk_mul_f32 v[70:71], v[70:71], v[86:87]
    v_pk_mul_f32 v[72:73], v[72:73], v[88:89]
    v_pk_mul_f32 v[74:75], v[74:75], v[90:91]
    v_pk_add_f32 v[228:229], v[228:229], 1.0 op_sel_hi:[1,0]
    v_pk_add_f32 v[230:231], v[230:231], 1.0 op_sel_hi:[1,0]
    v_pk_add_f32 v[232:233], v[232:233], 1.0 op_sel_hi:[1,0]
    v_pk_add_f32 v[234:235], v[234:235], 1.0 op_sel_hi:[1,0]
    v_rcp_f32 v228, v228
    v_rcp_f32 v229, v229
    v_rcp_f32 v230, v230
    v_rcp_f32 v231, v231
    v_rcp_f32 v232, v232
    v_rcp_f32 v233, v233
    v_rcp_f32 v234, v234
    v_rcp_f32 v235, v235
    v_pk_mul_f32 v[68:69], v[68:69], v[228:229]
    v_pk_mul_f32 v[70:71], v[70:71], v[230:231]
    v_pk_mul_f32 v[72:73], v[72:73], v[232:233]
    v_pk_mul_f32 v[74:75], v[74:75], v[234:235]
    v_cvt_pk_bf16_f32 v92, v68, v69
    v_cvt_pk_bf16_f32 v94, v72, v73
    v_cvt_pk_bf16_f32 v93, v70, v71
    v_cvt_pk_bf16_f32 v95, v74, v75
    v_permlane16_swap_b32 v92, v94
    s_nop 0
    v_permlane16_swap_b32 v93, v95
    buffer_store_dwordx4 v[92:95], v246, s[32:35], s65 offen sc0 sc1
    s_waitcnt lgkmcnt(4)
    v_mfma_f32_16x16x32_bf16 v[100:103], a[160:163], a[0:3], v[100:103]
    ds_read_b64_tr_b16 a[176:177], v251 offset:28704
    v_accvgpr_read_b32 v236, a224
    v_mfma_f32_16x16x32_bf16 v[100:103], a[164:167], a[16:19], v[100:103]
    v_accvgpr_read_b32 v237, a225
    v_accvgpr_read_b32 v238, a226
    v_mfma_f32_16x16x32_bf16 v[104:107], a[164:167], a[20:23], v[104:107]
    ds_read_b64_tr_b16 a[178:179], v251 offset:30496
    v_accvgpr_read_b32 v239, a227
    v_mfma_f32_16x16x32_bf16 v[104:107], a[160:163], a[4:7], v[104:107]
    v_fma_f32 v84, v236, v4, v6
    v_fma_f32 v86, v236, v36, v38
    v_mfma_f32_16x16x32_bf16 v[108:111], a[160:163], a[8:11], v[108:111]
    ds_read_b64_tr_b16 a[180:181], v251 offset:35872
    v_fma_f32 v84, -v238, v36, v84
    v_mfma_f32_16x16x32_bf16 v[108:111], a[164:167], a[24:27], v[108:111]
    s_mov_b32 s67, 65536
    buffer_load_dwordx2 a[202:203], v254, s[36:39], s67 offen
    v_mfma_f32_16x16x32_bf16 v[112:115], a[164:167], a[28:31], v[112:115]
    ds_read_b64_tr_b16 a[182:183], v251 offset:37664
    v_fmac_f32 v86, v238, v4
    v_mfma_f32_16x16x32_bf16 v[112:115], a[160:163], a[12:15], v[112:115]
    v_fma_f32 v85, v236, v5, v7
    s_waitcnt lgkmcnt(4)
    v_mfma_f32_16x16x32_bf16 v[128:131], a[168:171], a[12:15], v[128:131]
    ds_read_b64_tr_b16 a[160:161], v251 offset:43040
    v_fma_f32 v87, v236, v37, v39
    v_mfma_f32_16x16x32_bf16 v[128:131], a[172:175], a[28:31], v[128:131]
    v_fma_f32 v85, -v238, v37, v85
    v_fmac_f32 v87, v238, v5
    v_mfma_f32_16x16x32_bf16 v[124:127], a[172:175], a[24:27], v[124:127]
    ds_read_b64_tr_b16 a[162:163], v251 offset:44832
    v_fma_f32 v88, v236, v84, v8
    v_mfma_f32_16x16x32_bf16 v[124:127], a[168:171], a[8:11], v[124:127]
    v_fma_f32 v90, v236, v86, v40
    v_fma_f32 v88, -v238, v86, v88
    v_mfma_f32_16x16x32_bf16 v[120:123], a[168:171], a[4:7], v[120:123]
    ds_read_b64_tr_b16 a[164:165], v251 offset:50208
    v_fmac_f32 v90, v238, v84
    v_mfma_f32_16x16x32_bf16 v[120:123], a[172:175], a[20:23], v[120:123]
    v_fma_f32 v89, v236, v85, v9
    v_fma_f32 v91, v236, v87, v41
    v_mfma_f32_16x16x32_bf16 v[116:119], a[172:175], a[16:19], v[116:119]
    ds_read_b64_tr_b16 a[166:167], v251 offset:52000
    v_fma_f32 v89, -v238, v87, v89
    v_mfma_f32_16x16x32_bf16 v[116:119], a[168:171], a[0:3], v[116:119]
    v_fmac_f32 v91, v238, v85
    s_waitcnt lgkmcnt(4)
    v_mfma_f32_16x16x32_bf16 v[100:103], a[176:179], a[128:131], v[100:103]
    ds_read_b64_tr_b16 a[168:169], v251 offset:64
    v_fma_f32 v84, v236, v88, v10
    v_mfma_f32_16x16x32_bf16 v[100:103], a[180:183], a[144:147], v[100:103]
    v_fma_f32 v86, v236, v90, v42
    v_fma_f32 v84, -v238, v90, v84
    v_mfma_f32_16x16x32_bf16 v[104:107], a[180:183], a[148:151], v[104:107]
    ds_read_b64_tr_b16 a[170:171], v251 offset:1856
    v_fmac_f32 v86, v238, v88
    v_mfma_f32_16x16x32_bf16 v[104:107], a[176:179], a[132:135], v[104:107]
    v_fma_f32 v85, v236, v89, v11
    v_fma_f32 v87, v236, v91, v43
    v_mfma_f32_16x16x32_bf16 v[108:111], a[176:179], a[136:139], v[108:111]
    ds_read_b64_tr_b16 a[172:173], v251 offset:7232
    v_fma_f32 v85, -v238, v91, v85
    v_mfma_f32_16x16x32_bf16 v[108:111], a[180:183], a[152:155], v[108:111]
    s_mov_b32 s67, 4096
    buffer_load_dwordx2 a[204:205], v254, s[36:39], s67 offen
    v_mfma_f32_16x16x32_bf16 v[112:115], a[180:183], a[156:159], v[112:115]
    ds_read_b64_tr_b16 a[174:175], v251 offset:9024
    v_fmac_f32 v87, v238, v89
    v_mfma_f32_16x16x32_bf16 v[112:115], a[176:179], a[140:143], v[112:115]
    v_fma_f32 v88, v236, v84, v12
    s_waitcnt lgkmcnt(4)
    v_mfma_f32_16x16x32_bf16 v[128:131], a[160:163], a[140:143], v[128:131]
    ds_read_b64_tr_b16 a[176:177], v251 offset:14400
    v_fma_f32 v90, v236, v86, v44
    v_mfma_f32_16x16x32_bf16 v[128:131], a[164:167], a[156:159], v[128:131]
    v_fma_f32 v88, -v238, v86, v88
    v_fmac_f32 v90, v238, v84
    v_mfma_f32_16x16x32_bf16 v[124:127], a[164:167], a[152:155], v[124:127]
    ds_read_b64_tr_b16 a[178:179], v251 offset:16192
    v_fma_f32 v89, v236, v85, v13
    v_mfma_f32_16x16x32_bf16 v[124:127], a[160:163], a[136:139], v[124:127]
    v_fma_f32 v91, v236, v87, v45
    v_fma_f32 v89, -v238, v87, v89
    v_mfma_f32_16x16x32_bf16 v[120:123], a[160:163], a[132:135], v[120:123]
    ds_read_b64_tr_b16 a[180:181], v251 offset:21568
    v_fmac_f32 v91, v238, v85
    v_mfma_f32_16x16x32_bf16 v[120:123], a[164:167], a[148:151], v[120:123]
    v_fma_f32 v84, v236, v88, v14
    v_fma_f32 v86, v236, v90, v46
    v_mfma_f32_16x16x32_bf16 v[116:119], a[164:167], a[144:147], v[116:119]
    ds_read_b64_tr_b16 a[182:183], v251 offset:23360
    v_fma_f32 v84, -v238, v90, v84
    v_mfma_f32_16x16x32_bf16 v[116:119], a[160:163], a[128:131], v[116:119]
    v_fmac_f32 v86, v238, v88
    v_pk_mul_f32 v[68:69], v[108:109], v[108:109]
    v_pk_mul_f32 v[70:71], v[110:111], v[110:111]
    v_pk_mul_f32 v[72:73], v[112:113], v[112:113]
    v_pk_mul_f32 v[74:75], v[114:115], v[114:115]
    v_pk_fma_f32 v[68:69], v[68:69], v[240:241], v[240:241] op_sel:[0,1,0] op_sel_hi:[1,1,0]
    v_pk_fma_f32 v[70:71], v[70:71], v[240:241], v[240:241] op_sel:[0,1,0] op_sel_hi:[1,1,0]
    v_pk_fma_f32 v[72:73], v[72:73], v[240:241], v[240:241] op_sel:[0,1,0] op_sel_hi:[1,1,0]
    v_pk_fma_f32 v[74:75], v[74:75], v[240:241], v[240:241] op_sel:[0,1,0] op_sel_hi:[1,1,0]
    v_pk_mul_f32 v[68:69], v[68:69], v[108:109]
    v_pk_mul_f32 v[70:71], v[70:71], v[110:111]
    v_pk_mul_f32 v[72:73], v[72:73], v[112:113]
    v_pk_mul_f32 v[74:75], v[74:75], v[114:115]
    v_exp_f32 v68, v68
    v_exp_f32 v69, v69
    v_exp_f32 v70, v70
    v_exp_f32 v71, v71
    v_exp_f32 v72, v72
    v_exp_f32 v73, v73
    v_exp_f32 v74, v74
    v_exp_f32 v75, v75
    v_pk_mul_f32 v[108:109], v[108:109], v[124:125]
    v_pk_mul_f32 v[110:111], v[110:111], v[126:127]
    v_pk_mul_f32 v[112:113], v[112:113], v[128:129]
    v_pk_mul_f32 v[114:115], v[114:115], v[130:131]
    v_pk_add_f32 v[68:69], v[68:69], 1.0 op_sel_hi:[1,0]
    v_pk_add_f32 v[70:71], v[70:71], 1.0 op_sel_hi:[1,0]
    v_pk_add_f32 v[72:73], v[72:73], 1.0 op_sel_hi:[1,0]
    v_pk_add_f32 v[74:75], v[74:75], 1.0 op_sel_hi:[1,0]
    v_rcp_f32 v68, v68
    v_rcp_f32 v69, v69
    v_rcp_f32 v70, v70
    v_rcp_f32 v71, v71
    v_rcp_f32 v72, v72
    v_rcp_f32 v73, v73
    v_rcp_f32 v74, v74
    v_rcp_f32 v75, v75
    v_pk_mul_f32 v[108:109], v[108:109], v[68:69]
    v_pk_mul_f32 v[110:111], v[110:111], v[70:71]
    v_pk_mul_f32 v[112:113], v[112:113], v[72:73]
    v_pk_mul_f32 v[114:115], v[114:115], v[74:75]
    v_cvt_pk_bf16_f32 v76, v108, v109
    v_cvt_pk_bf16_f32 v78, v112, v113
    v_cvt_pk_bf16_f32 v77, v110, v111
    v_cvt_pk_bf16_f32 v79, v114, v115
    v_permlane16_swap_b32 v76, v78
    s_nop 0
    v_permlane16_swap_b32 v77, v79
    s_nop 0
    buffer_store_dwordx4 v[76:79], v246, s[32:35], s65 offen offset:2560 sc0 sc1
    v_pk_mul_f32 v[68:69], v[100:101], v[100:101]
    v_pk_mul_f32 v[70:71], v[102:103], v[102:103]
    v_pk_mul_f32 v[72:73], v[104:105], v[104:105]
    v_pk_mul_f32 v[74:75], v[106:107], v[106:107]
    v_pk_fma_f32 v[68:69], v[68:69], v[240:241], v[240:241] op_sel:[0,1,0] op_sel_hi:[1,1,0]
    v_pk_fma_f32 v[70:71], v[70:71], v[240:241], v[240:241] op_sel:[0,1,0] op_sel_hi:[1,1,0]
    v_pk_fma_f32 v[72:73], v[72:73], v[240:241], v[240:241] op_sel:[0,1,0] op_sel_hi:[1,1,0]
    v_pk_fma_f32 v[74:75], v[74:75], v[240:241], v[240:241] op_sel:[0,1,0] op_sel_hi:[1,1,0]
    v_pk_mul_f32 v[68:69], v[68:69], v[100:101]
    v_pk_mul_f32 v[70:71], v[70:71], v[102:103]
    v_pk_mul_f32 v[72:73], v[72:73], v[104:105]
    v_pk_mul_f32 v[74:75], v[74:75], v[106:107]
    v_exp_f32 v68, v68
    v_exp_f32 v69, v69
    v_exp_f32 v70, v70
    v_exp_f32 v71, v71
    v_exp_f32 v72, v72
    v_exp_f32 v73, v73
    v_exp_f32 v74, v74
    v_exp_f32 v75, v75
    v_pk_mul_f32 v[100:101], v[100:101], v[116:117]
    v_pk_mul_f32 v[102:103], v[102:103], v[118:119]
    v_pk_mul_f32 v[104:105], v[104:105], v[120:121]
    v_pk_mul_f32 v[106:107], v[106:107], v[122:123]
    v_pk_add_f32 v[68:69], v[68:69], 1.0 op_sel_hi:[1,0]
    v_pk_add_f32 v[70:71], v[70:71], 1.0 op_sel_hi:[1,0]
    v_pk_add_f32 v[72:73], v[72:73], 1.0 op_sel_hi:[1,0]
    v_pk_add_f32 v[74:75], v[74:75], 1.0 op_sel_hi:[1,0]
    v_rcp_f32 v68, v68
    v_rcp_f32 v69, v69
    v_rcp_f32 v70, v70
    v_rcp_f32 v71, v71
    v_rcp_f32 v72, v72
    v_rcp_f32 v73, v73
    v_rcp_f32 v74, v74
    v_rcp_f32 v75, v75
    v_pk_mul_f32 v[100:101], v[100:101], v[68:69]
    v_pk_mul_f32 v[102:103], v[102:103], v[70:71]
    v_pk_mul_f32 v[104:105], v[104:105], v[72:73]
    v_pk_mul_f32 v[106:107], v[106:107], v[74:75]
    v_cvt_pk_bf16_f32 v80, v100, v101
    v_cvt_pk_bf16_f32 v82, v104, v105
    v_cvt_pk_bf16_f32 v81, v102, v103
    v_cvt_pk_bf16_f32 v83, v106, v107
    v_permlane16_swap_b32 v80, v82
    s_nop 0
    v_permlane16_swap_b32 v81, v83
    buffer_store_dwordx4 v[80:83], v246, s[32:35], s65 offen offset:512 sc0 sc1
    s_waitcnt lgkmcnt(4)
    v_mfma_f32_16x16x32_bf16 a[64:67], a[168:171], a[0:3], a[64:67]
    ds_read_b64_tr_b16 a[160:161], v251 offset:28736
    v_fma_f32 v85, v236, v89, v15
    v_mfma_f32_16x16x32_bf16 a[64:67], a[172:175], a[16:19], a[64:67]
    v_fma_f32 v87, v236, v91, v47
    v_fma_f32 v85, -v238, v91, v85
    v_mfma_f32_16x16x32_bf16 a[68:71], a[172:175], a[20:23], a[68:71]
    ds_read_b64_tr_b16 a[162:163], v251 offset:30528
    v_fmac_f32 v87, v238, v89
    v_mfma_f32_16x16x32_bf16 a[68:71], a[168:171], a[4:7], a[68:71]
    v_fma_f32 v88, v236, v84, v16
    v_fma_f32 v90, v236, v86, v48
    v_mfma_f32_16x16x32_bf16 a[72:75], a[168:171], a[8:11], a[72:75]
    ds_read_b64_tr_b16 a[164:165], v251 offset:35904
    v_fma_f32 v88, -v238, v86, v88
    v_mfma_f32_16x16x32_bf16 a[72:75], a[172:175], a[24:27], a[72:75]
    s_mov_b32 s67, 69632
    buffer_load_dwordx2 a[206:207], v254, s[36:39], s67 offen
    v_mfma_f32_16x16x32_bf16 a[76:79], a[172:175], a[28:31], a[76:79]
    ds_read_b64_tr_b16 a[166:167], v251 offset:37696
    v_fmac_f32 v90, v238, v84
    v_mfma_f32_16x16x32_bf16 a[76:79], a[168:171], a[12:15], a[76:79]
    v_fma_f32 v89, v236, v85, v17
    s_waitcnt lgkmcnt(4)
    v_mfma_f32_16x16x32_bf16 a[92:95], a[176:179], a[12:15], a[92:95]
    ds_read_b64_tr_b16 a[168:169], v251 offset:43072
    v_fma_f32 v91, v236, v87, v49
    v_mfma_f32_16x16x32_bf16 a[92:95], a[180:183], a[28:31], a[92:95]
    v_fma_f32 v89, -v238, v87, v89
    v_fmac_f32 v91, v238, v85
    v_mfma_f32_16x16x32_bf16 a[88:91], a[180:183], a[24:27], a[88:91]
    ds_read_b64_tr_b16 a[170:171], v251 offset:44864
    v_fma_f32 v92, v236, v88, v18
    v_mfma_f32_16x16x32_bf16 a[88:91], a[176:179], a[8:11], a[88:91]
    v_fma_f32 v94, v236, v90, v50
    v_fma_f32 v92, -v238, v90, v92
    v_mfma_f32_16x16x32_bf16 a[84:87], a[176:179], a[4:7], a[84:87]
    ds_read_b64_tr_b16 a[172:173], v251 offset:50240
    v_fmac_f32 v94, v238, v88
    v_mfma_f32_16x16x32_bf16 a[84:87], a[180:183], a[20:23], a[84:87]
    v_fma_f32 v96, v236, v89, v19
    v_fma_f32 v98, v236, v91, v51
    v_mfma_f32_16x16x32_bf16 a[80:83], a[180:183], a[16:19], a[80:83]
    ds_read_b64_tr_b16 a[174:175], v251 offset:52032
    v_fma_f32 v96, -v238, v91, v96
    v_mfma_f32_16x16x32_bf16 a[80:83], a[176:179], a[0:3], a[80:83]
    v_fmac_f32 v98, v238, v89
    s_waitcnt lgkmcnt(4)
    v_mfma_f32_16x16x32_bf16 a[64:67], a[160:163], a[128:131], a[64:67]
    ds_read_b64_tr_b16 a[176:177], v251 offset:96
    v_fma_f32 v84, v237, v20, v22
    v_mfma_f32_16x16x32_bf16 a[64:67], a[164:167], a[144:147], a[64:67]
    v_fma_f32 v86, v237, v52, v54
    v_fma_f32 v84, -v239, v52, v84
    v_mfma_f32_16x16x32_bf16 a[68:71], a[164:167], a[148:151], a[68:71]
    ds_read_b64_tr_b16 a[178:179], v251 offset:1888
    v_fmac_f32 v86, v239, v20
    v_mfma_f32_16x16x32_bf16 a[68:71], a[160:163], a[132:135], a[68:71]
    v_fma_f32 v85, v237, v21, v23
    v_fma_f32 v87, v237, v53, v55
    v_mfma_f32_16x16x32_bf16 a[72:75], a[160:163], a[136:139], a[72:75]
    ds_read_b64_tr_b16 a[180:181], v251 offset:7264
    v_fma_f32 v85, -v239, v53, v85
    v_mfma_f32_16x16x32_bf16 a[72:75], a[164:167], a[152:155], a[72:75]
    s_mov_b32 s67, 8192
    buffer_load_dwordx2 a[208:209], v254, s[36:39], s67 offen
    v_mfma_f32_16x16x32_bf16 a[76:79], a[164:167], a[156:159], a[76:79]
    ds_read_b64_tr_b16 a[182:183], v251 offset:9056
    v_fmac_f32 v87, v239, v21
    v_mfma_f32_16x16x32_bf16 a[76:79], a[160:163], a[140:143], a[76:79]
    v_fma_f32 v88, v237, v84, v24
    s_waitcnt lgkmcnt(4)
    v_mfma_f32_16x16x32_bf16 a[92:95], a[168:171], a[140:143], a[92:95]
    ds_read_b64_tr_b16 a[160:161], v251 offset:14432
    v_fma_f32 v90, v237, v86, v56
    v_mfma_f32_16x16x32_bf16 a[92:95], a[172:175], a[156:159], a[92:95]
    v_fma_f32 v88, -v239, v86, v88
    v_fmac_f32 v90, v239, v84
    v_mfma_f32_16x16x32_bf16 a[88:91], a[172:175], a[152:155], a[88:91]
    ds_read_b64_tr_b16 a[162:163], v251 offset:16224
    v_fma_f32 v89, v237, v85, v25
    v_mfma_f32_16x16x32_bf16 a[88:91], a[168:171], a[136:139], a[88:91]
    v_fma_f32 v91, v237, v87, v57
    v_fma_f32 v89, -v239, v87, v89
    v_mfma_f32_16x16x32_bf16 a[84:87], a[168:171], a[132:135], a[84:87]
    ds_read_b64_tr_b16 a[164:165], v251 offset:21600
    v_fmac_f32 v91, v239, v85
    v_mfma_f32_16x16x32_bf16 a[84:87], a[172:175], a[148:151], a[84:87]
    v_fma_f32 v84, v237, v88, v26
    v_fma_f32 v86, v237, v90, v58
    v_mfma_f32_16x16x32_bf16 a[80:83], a[172:175], a[144:147], a[80:83]
    ds_read_b64_tr_b16 a[166:167], v251 offset:23392
    v_fma_f32 v84, -v239, v90, v84
    v_mfma_f32_16x16x32_bf16 a[80:83], a[168:171], a[128:131], a[80:83]
    v_fmac_f32_e64 v86, v239, v88
    s_add_u32 s65, s65, 32768
    v_accvgpr_read_b32 v100, a72
    v_accvgpr_read_b32 v101, a73
    v_accvgpr_read_b32 v102, a74
    v_accvgpr_read_b32 v103, a75
    v_accvgpr_read_b32 v104, a76
    v_accvgpr_read_b32 v105, a77
    v_accvgpr_read_b32 v106, a78
    v_accvgpr_read_b32 v107, a79
    v_accvgpr_read_b32 v108, a88
    v_accvgpr_read_b32 v109, a89
    v_accvgpr_read_b32 v110, a90
    v_accvgpr_read_b32 v111, a91
    v_accvgpr_read_b32 v112, a92
    v_accvgpr_read_b32 v113, a93
    v_accvgpr_read_b32 v114, a94
    v_accvgpr_read_b32 v115, a95
    v_pk_mul_f32 v[68:69], v[100:101], v[100:101]
    v_pk_mul_f32 v[70:71], v[102:103], v[102:103]
    v_pk_mul_f32 v[72:73], v[104:105], v[104:105]
    v_pk_mul_f32 v[74:75], v[106:107], v[106:107]
    v_pk_fma_f32 v[68:69], v[68:69], v[240:241], v[240:241] op_sel:[0,1,0] op_sel_hi:[1,1,0]
    v_pk_fma_f32 v[70:71], v[70:71], v[240:241], v[240:241] op_sel:[0,1,0] op_sel_hi:[1,1,0]
    v_pk_fma_f32 v[72:73], v[72:73], v[240:241], v[240:241] op_sel:[0,1,0] op_sel_hi:[1,1,0]
    v_pk_fma_f32 v[74:75], v[74:75], v[240:241], v[240:241] op_sel:[0,1,0] op_sel_hi:[1,1,0]
    v_pk_mul_f32 v[68:69], v[68:69], v[100:101]
    v_pk_mul_f32 v[70:71], v[70:71], v[102:103]
    v_pk_mul_f32 v[72:73], v[72:73], v[104:105]
    v_pk_mul_f32 v[74:75], v[74:75], v[106:107]
    v_exp_f32 v68, v68
    v_exp_f32 v69, v69
    v_exp_f32 v70, v70
    v_exp_f32 v71, v71
    v_exp_f32 v72, v72
    v_exp_f32 v73, v73
    v_exp_f32 v74, v74
    v_exp_f32 v75, v75
    v_pk_mul_f32 v[100:101], v[100:101], v[108:109]
    v_pk_mul_f32 v[102:103], v[102:103], v[110:111]
    v_pk_mul_f32 v[104:105], v[104:105], v[112:113]
    v_pk_mul_f32 v[106:107], v[106:107], v[114:115]
    v_pk_add_f32 v[68:69], v[68:69], 1.0 op_sel_hi:[1,0]
    v_pk_add_f32 v[70:71], v[70:71], 1.0 op_sel_hi:[1,0]
    v_pk_add_f32 v[72:73], v[72:73], 1.0 op_sel_hi:[1,0]
    v_pk_add_f32 v[74:75], v[74:75], 1.0 op_sel_hi:[1,0]
    v_rcp_f32 v68, v68
    v_rcp_f32 v69, v69
    v_rcp_f32 v70, v70
    v_rcp_f32 v71, v71
    v_rcp_f32 v72, v72
    v_rcp_f32 v73, v73
    v_rcp_f32 v74, v74
    v_rcp_f32 v75, v75
    v_pk_mul_f32 v[100:101], v[100:101], v[68:69]
    v_pk_mul_f32 v[102:103], v[102:103], v[70:71]
    v_pk_mul_f32 v[104:105], v[104:105], v[72:73]
    v_pk_mul_f32 v[106:107], v[106:107], v[74:75]
    v_cvt_pk_bf16_f32 v76, v100, v101
    v_cvt_pk_bf16_f32 v78, v104, v105
    v_cvt_pk_bf16_f32 v77, v102, v103
    v_cvt_pk_bf16_f32 v79, v106, v107
    v_permlane16_swap_b32 v76, v78
    s_nop 0
    v_permlane16_swap_b32 v77, v79
    s_nop 0
    buffer_store_dwordx4 v[76:79], v246, s[32:35], s65 offen offset:2048 sc0 sc1
    v_accvgpr_read_b32 v100, a64
    v_accvgpr_read_b32 v101, a65
    v_accvgpr_read_b32 v102, a66
    v_accvgpr_read_b32 v103, a67
    v_accvgpr_read_b32 v104, a68
    v_accvgpr_read_b32 v105, a69
    v_accvgpr_read_b32 v106, a70
    v_accvgpr_read_b32 v107, a71
    v_accvgpr_read_b32 v108, a80
    v_accvgpr_read_b32 v109, a81
    v_accvgpr_read_b32 v110, a82
    v_accvgpr_read_b32 v111, a83
    v_accvgpr_read_b32 v112, a84
    v_accvgpr_read_b32 v113, a85
    v_accvgpr_read_b32 v114, a86
    v_accvgpr_read_b32 v115, a87
    v_pk_mul_f32 v[68:69], v[100:101], v[100:101]
    v_pk_mul_f32 v[70:71], v[102:103], v[102:103]
    v_pk_mul_f32 v[72:73], v[104:105], v[104:105]
    v_pk_mul_f32 v[74:75], v[106:107], v[106:107]
    v_pk_fma_f32 v[68:69], v[68:69], v[240:241], v[240:241] op_sel:[0,1,0] op_sel_hi:[1,1,0]
    v_pk_fma_f32 v[70:71], v[70:71], v[240:241], v[240:241] op_sel:[0,1,0] op_sel_hi:[1,1,0]
    v_pk_fma_f32 v[72:73], v[72:73], v[240:241], v[240:241] op_sel:[0,1,0] op_sel_hi:[1,1,0]
    v_pk_fma_f32 v[74:75], v[74:75], v[240:241], v[240:241] op_sel:[0,1,0] op_sel_hi:[1,1,0]
    v_pk_mul_f32 v[68:69], v[68:69], v[100:101]
    v_pk_mul_f32 v[70:71], v[70:71], v[102:103]
    v_pk_mul_f32 v[72:73], v[72:73], v[104:105]
    v_pk_mul_f32 v[74:75], v[74:75], v[106:107]
    v_exp_f32 v68, v68
    v_exp_f32 v69, v69
    v_exp_f32 v70, v70
    v_exp_f32 v71, v71
    v_exp_f32 v72, v72
    v_exp_f32 v73, v73
    v_exp_f32 v74, v74
    v_exp_f32 v75, v75
    v_pk_mul_f32 v[100:101], v[100:101], v[108:109]
    v_pk_mul_f32 v[102:103], v[102:103], v[110:111]
    v_pk_mul_f32 v[104:105], v[104:105], v[112:113]
    v_pk_mul_f32 v[106:107], v[106:107], v[114:115]
    v_pk_add_f32 v[68:69], v[68:69], 1.0 op_sel_hi:[1,0]
    v_pk_add_f32 v[70:71], v[70:71], 1.0 op_sel_hi:[1,0]
    v_pk_add_f32 v[72:73], v[72:73], 1.0 op_sel_hi:[1,0]
    v_pk_add_f32 v[74:75], v[74:75], 1.0 op_sel_hi:[1,0]
    v_rcp_f32 v68, v68
    v_rcp_f32 v69, v69
    v_rcp_f32 v70, v70
    v_rcp_f32 v71, v71
    v_rcp_f32 v72, v72
    v_rcp_f32 v73, v73
    v_rcp_f32 v74, v74
    v_rcp_f32 v75, v75
    v_pk_mul_f32 v[100:101], v[100:101], v[68:69]
    v_pk_mul_f32 v[102:103], v[102:103], v[70:71]
    v_pk_mul_f32 v[104:105], v[104:105], v[72:73]
    v_pk_mul_f32 v[106:107], v[106:107], v[74:75]
    v_cvt_pk_bf16_f32 v80, v100, v101
    v_cvt_pk_bf16_f32 v82, v104, v105
    v_cvt_pk_bf16_f32 v81, v102, v103
    v_cvt_pk_bf16_f32 v83, v106, v107
    v_permlane16_swap_b32 v80, v82
    s_nop 0
    v_permlane16_swap_b32 v81, v83
    buffer_store_dwordx4 v[80:83], v246, s[32:35], s65 offen sc0 sc1
    s_waitcnt lgkmcnt(4)
    v_mfma_f32_16x16x32_bf16 a[96:99], a[176:179], a[0:3], a[96:99]
    ds_read_b64_tr_b16 a[168:169], v251 offset:28768
    v_fma_f32 v85, v237, v89, v27
    v_mfma_f32_16x16x32_bf16 a[96:99], a[180:183], a[16:19], a[96:99]
    s_waitcnt vmcnt(4)
    v_or_b32_e64 v250, s3, 2
    s_mov_b64 exec, 1
    buffer_store_dword v250, v3, s[52:55], s20 offen sc0 sc1
    s_mov_b64 exec, -1
    v_mfma_f32_16x16x32_bf16 a[100:103], a[180:183], a[20:23], a[100:103]
    ds_read_b64_tr_b16 a[170:171], v251 offset:30560
    v_fma_f32 v87, v237, v91, v59
    v_mfma_f32_16x16x32_bf16 a[100:103], a[176:179], a[4:7], a[100:103]
    v_fma_f32 v85, -v239, v91, v85
    v_fmac_f32 v87, v239, v89
    v_mfma_f32_16x16x32_bf16 a[104:107], a[176:179], a[8:11], a[104:107]
    ds_read_b64_tr_b16 a[172:173], v251 offset:35936
    v_fma_f32 v88, v237, v84, v28
    v_mfma_f32_16x16x32_bf16 a[104:107], a[180:183], a[24:27], a[104:107]
    s_mov_b32 s67, 73728
    buffer_load_dwordx2 a[210:211], v254, s[36:39], s67 offen
    v_mfma_f32_16x16x32_bf16 a[108:111], a[180:183], a[28:31], a[108:111]
    ds_read_b64_tr_b16 a[174:175], v251 offset:37728
    v_fma_f32 v90, v237, v86, v60
    v_mfma_f32_16x16x32_bf16 a[108:111], a[176:179], a[12:15], a[108:111]
    v_fma_f32 v88, -v239, v86, v88
    s_waitcnt lgkmcnt(4)
    v_mfma_f32_16x16x32_bf16 a[124:127], a[160:163], a[12:15], a[124:127]
    ds_read_b64_tr_b16 a[176:177], v251 offset:43104
    v_fmac_f32 v90, v239, v84
    v_mfma_f32_16x16x32_bf16 a[124:127], a[164:167], a[28:31], a[124:127]
    v_fma_f32 v89, v237, v85, v29
    v_fma_f32 v91, v237, v87, v61
    v_mfma_f32_16x16x32_bf16 a[120:123], a[164:167], a[24:27], a[120:123]
    ds_read_b64_tr_b16 a[178:179], v251 offset:44896
    v_fma_f32 v89, -v239, v87, v89
    v_mfma_f32_16x16x32_bf16 a[120:123], a[160:163], a[8:11], a[120:123]
    v_fmac_f32 v91, v239, v85
    v_fma_f32 v84, v237, v88, v30
    v_mfma_f32_16x16x32_bf16 a[116:119], a[160:163], a[4:7], a[116:119]
    ds_read_b64_tr_b16 a[180:181], v251 offset:50272
    v_fma_f32 v86, v237, v90, v62
    v_mfma_f32_16x16x32_bf16 a[116:119], a[164:167], a[20:23], a[116:119]
    v_fma_f32 v84, -v239, v90, v84
    v_fmac_f32 v86, v239, v88
    v_mfma_f32_16x16x32_bf16 a[112:115], a[164:167], a[16:19], a[112:115]
    ds_read_b64_tr_b16 a[182:183], v251 offset:52064
    v_fma_f32 v85, v237, v89, v31
    v_mfma_f32_16x16x32_bf16 a[112:115], a[160:163], a[0:3], a[112:115]
    v_fma_f32 v87, v237, v91, v63
    s_waitcnt lgkmcnt(4)
    v_mfma_f32_16x16x32_bf16 a[96:99], a[168:171], a[128:131], a[96:99]
    ds_read_b64_tr_b16 a[160:161], v251 offset:128
    v_fma_f32 v85, -v239, v91, v85
    v_mfma_f32_16x16x32_bf16 a[96:99], a[172:175], a[144:147], a[96:99]
    v_fmac_f32 v87, v239, v89
    v_fma_f32 v88, v237, v84, v32
    v_mfma_f32_16x16x32_bf16 a[100:103], a[172:175], a[148:151], a[100:103]
    ds_read_b64_tr_b16 a[162:163], v251 offset:1920
    v_fma_f32 v90, v237, v86, v64
    v_mfma_f32_16x16x32_bf16 a[100:103], a[168:171], a[132:135], a[100:103]
    v_fma_f32 v88, -v239, v86, v88
    v_fmac_f32 v90, v239, v84
    v_mfma_f32_16x16x32_bf16 a[104:107], a[168:171], a[136:139], a[104:107]
    ds_read_b64_tr_b16 a[164:165], v251 offset:7296
    v_fma_f32 v89, v237, v85, v33
    v_mfma_f32_16x16x32_bf16 a[104:107], a[172:175], a[152:155], a[104:107]
    s_mov_b32 s67, 12288
    buffer_load_dwordx2 a[212:213], v254, s[36:39], s67 offen
    v_mfma_f32_16x16x32_bf16 a[108:111], a[172:175], a[156:159], a[108:111]
    ds_read_b64_tr_b16 a[166:167], v251 offset:9088
    v_fma_f32 v91, v237, v87, v65
    v_mfma_f32_16x16x32_bf16 a[108:111], a[168:171], a[140:143], a[108:111]
    v_fma_f32 v89, -v239, v87, v89
    s_waitcnt lgkmcnt(4)
    v_mfma_f32_16x16x32_bf16 a[124:127], a[176:179], a[140:143], a[124:127]
    ds_read_b64_tr_b16 a[168:169], v251 offset:14464
    v_fmac_f32 v91, v239, v85
    v_mfma_f32_16x16x32_bf16 a[124:127], a[180:183], a[156:159], a[124:127]
    v_fma_f32 v93, v237, v88, v34
    v_fma_f32 v95, v237, v90, v66
    v_mfma_f32_16x16x32_bf16 a[120:123], a[180:183], a[152:155], a[120:123]
    ds_read_b64_tr_b16 a[170:171], v251 offset:16256
    v_fma_f32 v93, -v239, v90, v93
    v_mfma_f32_16x16x32_bf16 a[120:123], a[176:179], a[136:139], a[120:123]
    v_fmac_f32 v95, v239, v88
    v_fma_f32 v97, v237, v89, v35
    v_mfma_f32_16x16x32_bf16 a[116:119], a[176:179], a[132:135], a[116:119]
    ds_read_b64_tr_b16 a[172:173], v251 offset:21632
    v_fma_f32 v99, v237, v91, v67
    v_mfma_f32_16x16x32_bf16 a[116:119], a[180:183], a[148:151], a[116:119]
    v_fma_f32 v97, -v239, v91, v97
    v_fmac_f32 v99, v239, v89
    v_mfma_f32_16x16x32_bf16 a[112:115], a[180:183], a[144:147], a[112:115]
    ds_read_b64_tr_b16 a[174:175], v251 offset:23424
    v_accvgpr_read_b32 v236, a232
    v_mfma_f32_16x16x32_bf16 a[112:115], a[176:179], a[128:131], a[112:115]
    v_accvgpr_read_b32 v237, a233
    s_nop 0
    v_accvgpr_read_b32 v100, a104
    v_accvgpr_read_b32 v101, a105
    v_accvgpr_read_b32 v102, a106
    v_accvgpr_read_b32 v103, a107
    v_accvgpr_read_b32 v104, a108
    v_accvgpr_read_b32 v105, a109
    v_accvgpr_read_b32 v106, a110
    v_accvgpr_read_b32 v107, a111
    v_accvgpr_read_b32 v108, a120
    v_accvgpr_read_b32 v109, a121
    v_accvgpr_read_b32 v110, a122
    v_accvgpr_read_b32 v111, a123
    v_accvgpr_read_b32 v112, a124
    v_accvgpr_read_b32 v113, a125
    v_accvgpr_read_b32 v114, a126
    v_accvgpr_read_b32 v115, a127
    v_pk_mul_f32 v[68:69], v[100:101], v[100:101]
    v_pk_mul_f32 v[70:71], v[102:103], v[102:103]
    v_pk_mul_f32 v[72:73], v[104:105], v[104:105]
    v_pk_mul_f32 v[74:75], v[106:107], v[106:107]
    v_pk_fma_f32 v[68:69], v[68:69], v[240:241], v[240:241] op_sel:[0,1,0] op_sel_hi:[1,1,0]
    v_pk_fma_f32 v[70:71], v[70:71], v[240:241], v[240:241] op_sel:[0,1,0] op_sel_hi:[1,1,0]
    v_pk_fma_f32 v[72:73], v[72:73], v[240:241], v[240:241] op_sel:[0,1,0] op_sel_hi:[1,1,0]
    v_pk_fma_f32 v[74:75], v[74:75], v[240:241], v[240:241] op_sel:[0,1,0] op_sel_hi:[1,1,0]
    v_pk_mul_f32 v[68:69], v[68:69], v[100:101]
    v_pk_mul_f32 v[70:71], v[70:71], v[102:103]
    v_pk_mul_f32 v[72:73], v[72:73], v[104:105]
    v_pk_mul_f32 v[74:75], v[74:75], v[106:107]
    v_exp_f32 v68, v68
    v_exp_f32 v69, v69
    v_exp_f32 v70, v70
    v_exp_f32 v71, v71
    v_exp_f32 v72, v72
    v_exp_f32 v73, v73
    v_exp_f32 v74, v74
    v_exp_f32 v75, v75
    v_pk_mul_f32 v[100:101], v[100:101], v[108:109]
    v_pk_mul_f32 v[102:103], v[102:103], v[110:111]
    v_pk_mul_f32 v[104:105], v[104:105], v[112:113]
    v_pk_mul_f32 v[106:107], v[106:107], v[114:115]
    v_pk_add_f32 v[68:69], v[68:69], 1.0 op_sel_hi:[1,0]
    v_pk_add_f32 v[70:71], v[70:71], 1.0 op_sel_hi:[1,0]
    v_pk_add_f32 v[72:73], v[72:73], 1.0 op_sel_hi:[1,0]
    v_pk_add_f32 v[74:75], v[74:75], 1.0 op_sel_hi:[1,0]
    v_rcp_f32 v68, v68
    v_rcp_f32 v69, v69
    v_rcp_f32 v70, v70
    v_rcp_f32 v71, v71
    v_rcp_f32 v72, v72
    v_rcp_f32 v73, v73
    v_rcp_f32 v74, v74
    v_rcp_f32 v75, v75
    v_pk_mul_f32 v[100:101], v[100:101], v[68:69]
    v_pk_mul_f32 v[102:103], v[102:103], v[70:71]
    v_pk_mul_f32 v[104:105], v[104:105], v[72:73]
    v_pk_mul_f32 v[106:107], v[106:107], v[74:75]
    v_cvt_pk_bf16_f32 v76, v100, v101
    v_cvt_pk_bf16_f32 v78, v104, v105
    v_cvt_pk_bf16_f32 v77, v102, v103
    v_cvt_pk_bf16_f32 v79, v106, v107
    v_permlane16_swap_b32 v76, v78
    s_nop 0
    v_permlane16_swap_b32 v77, v79
    s_nop 0
    buffer_store_dwordx4 v[76:79], v246, s[32:35], s65 offen offset:2560 sc0 sc1
    v_accvgpr_read_b32 v100, a96
    v_accvgpr_read_b32 v101, a97
    v_accvgpr_read_b32 v102, a98
    v_accvgpr_read_b32 v103, a99
    v_accvgpr_read_b32 v104, a100
    v_accvgpr_read_b32 v105, a101
    v_accvgpr_read_b32 v106, a102
    v_accvgpr_read_b32 v107, a103
    v_accvgpr_read_b32 v108, a112
    v_accvgpr_read_b32 v109, a113
    v_accvgpr_read_b32 v110, a114
    v_accvgpr_read_b32 v111, a115
    v_accvgpr_read_b32 v112, a116
    v_accvgpr_read_b32 v113, a117
    v_accvgpr_read_b32 v114, a118
    v_accvgpr_read_b32 v115, a119
    v_pk_mul_f32 v[68:69], v[100:101], v[100:101]
    v_pk_mul_f32 v[70:71], v[102:103], v[102:103]
    v_pk_mul_f32 v[72:73], v[104:105], v[104:105]
    v_pk_mul_f32 v[74:75], v[106:107], v[106:107]
    v_pk_fma_f32 v[68:69], v[68:69], v[240:241], v[240:241] op_sel:[0,1,0] op_sel_hi:[1,1,0]
    v_pk_fma_f32 v[70:71], v[70:71], v[240:241], v[240:241] op_sel:[0,1,0] op_sel_hi:[1,1,0]
    v_pk_fma_f32 v[72:73], v[72:73], v[240:241], v[240:241] op_sel:[0,1,0] op_sel_hi:[1,1,0]
    v_pk_fma_f32 v[74:75], v[74:75], v[240:241], v[240:241] op_sel:[0,1,0] op_sel_hi:[1,1,0]
    v_pk_mul_f32 v[68:69], v[68:69], v[100:101]
    v_pk_mul_f32 v[70:71], v[70:71], v[102:103]
    v_pk_mul_f32 v[72:73], v[72:73], v[104:105]
    v_pk_mul_f32 v[74:75], v[74:75], v[106:107]
    v_exp_f32 v68, v68
    v_exp_f32 v69, v69
    v_exp_f32 v70, v70
    v_exp_f32 v71, v71
    v_exp_f32 v72, v72
    v_exp_f32 v73, v73
    v_exp_f32 v74, v74
    v_exp_f32 v75, v75
    v_pk_mul_f32 v[100:101], v[100:101], v[108:109]
    v_pk_mul_f32 v[102:103], v[102:103], v[110:111]
    v_pk_mul_f32 v[104:105], v[104:105], v[112:113]
    v_pk_mul_f32 v[106:107], v[106:107], v[114:115]
    v_pk_add_f32 v[68:69], v[68:69], 1.0 op_sel_hi:[1,0]
    v_pk_add_f32 v[70:71], v[70:71], 1.0 op_sel_hi:[1,0]
    v_pk_add_f32 v[72:73], v[72:73], 1.0 op_sel_hi:[1,0]
    v_pk_add_f32 v[74:75], v[74:75], 1.0 op_sel_hi:[1,0]
    v_rcp_f32 v68, v68
    v_rcp_f32 v69, v69
    v_rcp_f32 v70, v70
    v_rcp_f32 v71, v71
    v_rcp_f32 v72, v72
    v_rcp_f32 v73, v73
    v_rcp_f32 v74, v74
    v_rcp_f32 v75, v75
    v_pk_mul_f32 v[100:101], v[100:101], v[68:69]
    v_pk_mul_f32 v[102:103], v[102:103], v[70:71]
    v_pk_mul_f32 v[104:105], v[104:105], v[72:73]
    v_pk_mul_f32 v[106:107], v[106:107], v[74:75]
    v_cvt_pk_bf16_f32 v80, v100, v101
    v_cvt_pk_bf16_f32 v82, v104, v105
    v_cvt_pk_bf16_f32 v81, v102, v103
    v_cvt_pk_bf16_f32 v83, v106, v107
    v_permlane16_swap_b32 v80, v82
    s_nop 0
    v_permlane16_swap_b32 v81, v83
    buffer_store_dwordx4 v[80:83], v246, s[32:35], s65 offen offset:512 sc0 sc1
    s_waitcnt vmcnt(28) lgkmcnt(4)
    s_barrier
    v_mfma_f32_16x16x32_bf16 v[132:135], a[160:163], a[0:3], v[132:135]
    ds_read_b64_tr_b16 a[176:177], v251 offset:28800
    v_accvgpr_read_b32 v238, a234
    v_mfma_f32_16x16x32_bf16 v[132:135], a[164:167], a[16:19], v[132:135]
    buffer_load_dword v252, v249, s[52:55], 0 offen sc0 sc1
    v_accvgpr_read_b32 v239, a235
    v_mfma_f32_16x16x32_bf16 v[136:139], a[164:167], a[20:23], v[136:139]
    ds_read_b64_tr_b16 a[178:179], v251 offset:30592
    v_fmac_f32 v96, v236, v92
    v_mfma_f32_16x16x32_bf16 v[136:139], a[160:163], a[4:7], v[136:139]
    v_fmac_f32 v98, v236, v94
    v_fma_f32 v96, -v238, v94, v96
    v_mfma_f32_16x16x32_bf16 v[140:143], a[160:163], a[8:11], v[140:143]
    ds_read_b64_tr_b16 a[180:181], v251 offset:35968
    v_fmac_f32 v98, v238, v92
    v_mfma_f32_16x16x32_bf16 v[140:143], a[164:167], a[24:27], v[140:143]
    s_mov_b32 s67, 77824
    buffer_load_dwordx2 a[214:215], v254, s[36:39], s67 offen
    v_mfma_f32_16x16x32_bf16 v[144:147], a[164:167], a[28:31], v[144:147]
    ds_read_b64_tr_b16 a[182:183], v251 offset:37760
    v_lshrrev_b32 v255, 1, v2
    v_mfma_f32_16x16x32_bf16 v[144:147], a[160:163], a[12:15], v[144:147]
    s_add_u32 s36, s22, 0x1c00000
    s_addc_u32 s37, s23, 0
    s_mov_b32 s38, 16384
    s_waitcnt lgkmcnt(4)
    v_mfma_f32_16x16x32_bf16 v[160:163], a[168:171], a[12:15], v[160:163]
    ds_read_b64_tr_b16 a[160:161], v251 offset:43136
    s_lshl_b32 s67, s69, 9
    v_mfma_f32_16x16x32_bf16 v[160:163], a[172:175], a[28:31], v[160:163]
    buffer_load_dwordx2 a[218:219], v255, s[36:39], s67 offen sc1
    v_fmac_f32 v97, v237, v93
    v_mfma_f32_16x16x32_bf16 v[156:159], a[172:175], a[24:27], v[156:159]
    ds_read_b64_tr_b16 a[162:163], v251 offset:44928
    v_fmac_f32 v99, v237, v95
    v_mfma_f32_16x16x32_bf16 v[156:159], a[168:171], a[8:11], v[156:159]
    v_fma_f32 v97, -v239, v95, v97
    v_fmac_f32 v99, v239, v93
    v_mfma_f32_16x16x32_bf16 v[152:155], a[168:171], a[4:7], v[152:155]
    ds_read_b64_tr_b16 a[164:165], v251 offset:50304
    v_mfma_f32_16x16x32_bf16 v[152:155], a[172:175], a[20:23], v[152:155]
    ds_write_b128 v247, v[96:99]
    v_mfma_f32_16x16x32_bf16 v[148:151], a[172:175], a[16:19], v[148:151]
    ds_read_b64_tr_b16 a[166:167], v251 offset:52096
    ds_read_b128 v[84:87], v248 offset:0
    v_mfma_f32_16x16x32_bf16 v[148:151], a[168:171], a[0:3], v[148:151]
    ds_read_b128 v[88:91], v248 offset:256
    s_waitcnt lgkmcnt(7)
    v_mfma_f32_16x16x32_bf16 v[132:135], a[176:179], a[128:131], v[132:135]
    ds_read_b64_tr_b16 a[168:169], v251 offset:160
    ds_read_b128 v[228:231], v248 offset:512
    v_mfma_f32_16x16x32_bf16 v[132:135], a[180:183], a[144:147], v[132:135]
    v_accvgpr_write_b32 a248, v92
    v_accvgpr_write_b32 a249, v93
    v_mfma_f32_16x16x32_bf16 v[136:139], a[180:183], a[148:151], v[136:139]
    ds_read_b64_tr_b16 a[170:171], v251 offset:1952
    v_accvgpr_write_b32 a250, v94
    v_mfma_f32_16x16x32_bf16 v[136:139], a[176:179], a[132:135], v[136:139]
    v_accvgpr_write_b32 a251, v95
    v_accvgpr_read_b32 v236, a236
    v_mfma_f32_16x16x32_bf16 v[140:143], a[176:179], a[136:139], v[140:143]
    ds_read_b64_tr_b16 a[172:173], v251 offset:7328
    v_accvgpr_read_b32 v237, a237
    v_mfma_f32_16x16x32_bf16 v[140:143], a[180:183], a[152:155], v[140:143]
    v_accvgpr_read_b32 v238, a238
    v_accvgpr_read_b32 v239, a239
    v_mfma_f32_16x16x32_bf16 v[144:147], a[180:183], a[156:159], v[144:147]
    ds_read_b64_tr_b16 a[174:175], v251 offset:9120
    s_waitcnt lgkmcnt(3)
    v_mfma_f32_16x16x32_bf16 v[144:147], a[176:179], a[140:143], v[144:147]
    v_fmac_f32 v88, v236, v84
    s_waitcnt lgkmcnt(7)
    v_mfma_f32_16x16x32_bf16 v[160:163], a[160:163], a[140:143], v[160:163]
    ds_read_b64_tr_b16 a[176:177], v251 offset:14496
    v_fmac_f32 v90, v236, v86
    v_mfma_f32_16x16x32_bf16 v[160:163], a[164:167], a[156:159], v[160:163]
    v_fma_f32 v88, -v238, v86, v88
    v_fmac_f32 v90, v238, v84
    v_mfma_f32_16x16x32_bf16 v[156:159], a[164:167], a[152:155], v[156:159]
    ds_read_b64_tr_b16 a[178:179], v251 offset:16288
    v_fmac_f32 v89, v237, v85
    v_mfma_f32_16x16x32_bf16 v[156:159], a[160:163], a[136:139], v[156:159]
    v_fmac_f32 v91, v237, v87
    v_fma_f32 v89, -v239, v87, v89
    v_mfma_f32_16x16x32_bf16 v[152:155], a[160:163], a[132:135], v[152:155]
    ds_read_b64_tr_b16 a[180:181], v251 offset:21664
    v_fmac_f32 v91, v239, v85
    v_mfma_f32_16x16x32_bf16 v[152:155], a[164:167], a[148:151], v[152:155]
    v_fmac_f32 v228, v236, v88
    v_fmac_f32 v230, v236, v90
    v_mfma_f32_16x16x32_bf16 v[148:151], a[164:167], a[144:147], v[148:151]
    ds_read_b64_tr_b16 a[182:183], v251 offset:23456
    v_fma_f32 v228, -v238, v90, v228
    v_mfma_f32_16x16x32_bf16 v[148:151], a[160:163], a[128:131], v[148:151]
    v_fmac_f32_e64 v230, v238, v88
    s_add_u32 s65, s65, 32768
    v_pk_mul_f32 v[68:69], v[140:141], v[140:141]
    v_pk_mul_f32 v[70:71], v[142:143], v[142:143]
    v_pk_mul_f32 v[72:73], v[144:145], v[144:145]
    v_pk_mul_f32 v[74:75], v[146:147], v[146:147]
    v_pk_fma_f32 v[68:69], v[68:69], v[240:241], v[240:241] op_sel:[0,1,0] op_sel_hi:[1,1,0]
    v_pk_fma_f32 v[70:71], v[70:71], v[240:241], v[240:241] op_sel:[0,1,0] op_sel_hi:[1,1,0]
    v_pk_fma_f32 v[72:73], v[72:73], v[240:241], v[240:241] op_sel:[0,1,0] op_sel_hi:[1,1,0]
    v_pk_fma_f32 v[74:75], v[74:75], v[240:241], v[240:241] op_sel:[0,1,0] op_sel_hi:[1,1,0]
    v_pk_mul_f32 v[68:69], v[68:69], v[140:141]
    v_pk_mul_f32 v[70:71], v[70:71], v[142:143]
    v_pk_mul_f32 v[72:73], v[72:73], v[144:145]
    v_pk_mul_f32 v[74:75], v[74:75], v[146:147]
    v_exp_f32 v68, v68
    v_exp_f32 v69, v69
    v_exp_f32 v70, v70
    v_exp_f32 v71, v71
    v_exp_f32 v72, v72
    v_exp_f32 v73, v73
    v_exp_f32 v74, v74
    v_exp_f32 v75, v75
    v_pk_mul_f32 v[140:141], v[140:141], v[156:157]
    v_pk_mul_f32 v[142:143], v[142:143], v[158:159]
    v_pk_mul_f32 v[144:145], v[144:145], v[160:161]
    v_pk_mul_f32 v[146:147], v[146:147], v[162:163]
    v_pk_add_f32 v[68:69], v[68:69], 1.0 op_sel_hi:[1,0]
    v_pk_add_f32 v[70:71], v[70:71], 1.0 op_sel_hi:[1,0]
    v_pk_add_f32 v[72:73], v[72:73], 1.0 op_sel_hi:[1,0]
    v_pk_add_f32 v[74:75], v[74:75], 1.0 op_sel_hi:[1,0]
    v_rcp_f32 v68, v68
    v_rcp_f32 v69, v69
    v_rcp_f32 v70, v70
    v_rcp_f32 v71, v71
    v_rcp_f32 v72, v72
    v_rcp_f32 v73, v73
    v_rcp_f32 v74, v74
    v_rcp_f32 v75, v75
    v_pk_mul_f32 v[140:141], v[140:141], v[68:69]
    v_pk_mul_f32 v[142:143], v[142:143], v[70:71]
    v_pk_mul_f32 v[144:145], v[144:145], v[72:73]
    v_pk_mul_f32 v[146:147], v[146:147], v[74:75]
    v_cvt_pk_bf16_f32 v76, v140, v141
    v_cvt_pk_bf16_f32 v78, v144, v145
    v_cvt_pk_bf16_f32 v77, v142, v143
    v_cvt_pk_bf16_f32 v79, v146, v147
    v_permlane16_swap_b32 v76, v78
    s_nop 0
    v_permlane16_swap_b32 v77, v79
    s_nop 0
    buffer_store_dwordx4 v[76:79], v246, s[32:35], s65 offen offset:2048 sc0 sc1
    v_pk_mul_f32 v[68:69], v[132:133], v[132:133]
    v_pk_mul_f32 v[70:71], v[134:135], v[134:135]
    v_pk_mul_f32 v[72:73], v[136:137], v[136:137]
    v_pk_mul_f32 v[74:75], v[138:139], v[138:139]
    v_pk_fma_f32 v[68:69], v[68:69], v[240:241], v[240:241] op_sel:[0,1,0] op_sel_hi:[1,1,0]
    v_pk_fma_f32 v[70:71], v[70:71], v[240:241], v[240:241] op_sel:[0,1,0] op_sel_hi:[1,1,0]
    v_pk_fma_f32 v[72:73], v[72:73], v[240:241], v[240:241] op_sel:[0,1,0] op_sel_hi:[1,1,0]
    v_pk_fma_f32 v[74:75], v[74:75], v[240:241], v[240:241] op_sel:[0,1,0] op_sel_hi:[1,1,0]
    v_pk_mul_f32 v[68:69], v[68:69], v[132:133]
    v_pk_mul_f32 v[70:71], v[70:71], v[134:135]
    v_pk_mul_f32 v[72:73], v[72:73], v[136:137]
    v_pk_mul_f32 v[74:75], v[74:75], v[138:139]
    v_exp_f32 v68, v68
    v_exp_f32 v69, v69
    v_exp_f32 v70, v70
    v_exp_f32 v71, v71
    v_exp_f32 v72, v72
    v_exp_f32 v73, v73
    v_exp_f32 v74, v74
    v_exp_f32 v75, v75
    v_pk_mul_f32 v[132:133], v[132:133], v[148:149]
    v_pk_mul_f32 v[134:135], v[134:135], v[150:151]
    v_pk_mul_f32 v[136:137], v[136:137], v[152:153]
    v_pk_mul_f32 v[138:139], v[138:139], v[154:155]
    v_pk_add_f32 v[68:69], v[68:69], 1.0 op_sel_hi:[1,0]
    v_pk_add_f32 v[70:71], v[70:71], 1.0 op_sel_hi:[1,0]
    v_pk_add_f32 v[72:73], v[72:73], 1.0 op_sel_hi:[1,0]
    v_pk_add_f32 v[74:75], v[74:75], 1.0 op_sel_hi:[1,0]
    v_rcp_f32 v68, v68
    v_rcp_f32 v69, v69
    v_rcp_f32 v70, v70
    v_rcp_f32 v71, v71
    v_rcp_f32 v72, v72
    v_rcp_f32 v73, v73
    v_rcp_f32 v74, v74
    v_rcp_f32 v75, v75
    v_pk_mul_f32 v[132:133], v[132:133], v[68:69]
    v_pk_mul_f32 v[134:135], v[134:135], v[70:71]
    v_pk_mul_f32 v[136:137], v[136:137], v[72:73]
    v_pk_mul_f32 v[138:139], v[138:139], v[74:75]
    v_cvt_pk_bf16_f32 v80, v132, v133
    v_cvt_pk_bf16_f32 v82, v136, v137
    v_cvt_pk_bf16_f32 v81, v134, v135
    v_cvt_pk_bf16_f32 v83, v138, v139
    v_permlane16_swap_b32 v80, v82
    s_nop 0
    v_permlane16_swap_b32 v81, v83
    buffer_store_dwordx4 v[80:83], v246, s[32:35], s65 offen sc0 sc1
    s_waitcnt lgkmcnt(4)
    v_mfma_f32_16x16x32_bf16 v[164:167], a[168:171], a[0:3], v[164:167]
    ds_read_b64_tr_b16 a[160:161], v251 offset:28832
    v_fmac_f32 v229, v237, v89
    v_mfma_f32_16x16x32_bf16 v[164:167], a[172:175], a[16:19], v[164:167]
    s_add_u32 s21, s3, 2
    s_waitcnt vmcnt(4)
    v_subrev_u32 v252, s21, v252
    v_cmp_lt_u32 vcc, 13, v252
    s_cbranch_vccnz fa_f1_slow
fa_f1_ok:
    v_mfma_f32_16x16x32_bf16 v[168:171], a[172:175], a[20:23], v[168:171]
    ds_read_b64_tr_b16 a[162:163], v251 offset:30624
    v_fmac_f32 v231, v237, v91
    v_mfma_f32_16x16x32_bf16 v[168:171], a[168:171], a[4:7], v[168:171]
    s_waitcnt vmcnt(5)
    v_or_b32_e64 v250, s3, 3
    s_mov_b64 exec, 1
    buffer_store_dword v250, v3, s[52:55], s20 offen sc0 sc1
    s_mov_b64 exec, -1
    v_mfma_f32_16x16x32_bf16 v[172:175], a[168:171], a[8:11], v[172:175]
    ds_read_b64_tr_b16 a[164:165], v251 offset:36000
    v_fma_f32 v229, -v239, v91, v229
    v_mfma_f32_16x16x32_bf16 v[172:175], a[172:175], a[24:27], v[172:175]
    buffer_load_dwordx4 a[32:35], v2, s[32:35], s60 offen sc1
    v_fmac_f32 v231, v239, v89
    v_mfma_f32_16x16x32_bf16 v[176:179], a[172:175], a[28:31], v[176:179]
    ds_read_b64_tr_b16 a[166:167], v251 offset:37792
    v_fmac_f32 v96, v236, v228
    v_mfma_f32_16x16x32_bf16 v[176:179], a[168:171], a[12:15], v[176:179]
    v_fmac_f32 v98, v236, v230
    s_waitcnt lgkmcnt(4)
    v_mfma_f32_16x16x32_bf16 v[192:195], a[176:179], a[12:15], v[192:195]
    ds_read_b64_tr_b16 a[168:169], v251 offset:43168
    v_fma_f32 v96, -v238, v230, v96
    v_mfma_f32_16x16x32_bf16 v[192:195], a[180:183], a[28:31], v[192:195]
    v_fmac_f32 v98, v238, v228
    v_fmac_f32 v97, v237, v229
    v_mfma_f32_16x16x32_bf16 v[188:191], a[180:183], a[24:27], v[188:191]
    ds_read_b64_tr_b16 a[170:171], v251 offset:44960
    v_fmac_f32 v99, v237, v231
    v_mfma_f32_16x16x32_bf16 v[188:191], a[176:179], a[8:11], v[188:191]
    buffer_load_dwordx4 a[36:39], v2, s[32:35], s60 offen offset:1024 sc1
    v_fma_f32 v97, -v239, v231, v97
    v_mfma_f32_16x16x32_bf16 v[184:187], a[176:179], a[4:7], v[184:187]
    ds_read_b64_tr_b16 a[172:173], v251 offset:50336
    v_fmac_f32 v99, v239, v229
    v_mfma_f32_16x16x32_bf16 v[184:187], a[180:183], a[20:23], v[184:187]
    buffer_load_dwordx4 a[40:43], v2, s[32:35], s60 offen offset:2048 sc1
    v_mfma_f32_16x16x32_bf16 v[180:183], a[180:183], a[16:19], v[180:183]
    ds_read_b64_tr_b16 a[174:175], v251 offset:52128
    v_mfma_f32_16x16x32_bf16 v[180:183], a[176:179], a[0:3], v[180:183]
    s_waitcnt lgkmcnt(4)
    v_mfma_f32_16x16x32_bf16 v[164:167], a[160:163], a[128:131], v[164:167]
    ds_read_b64_tr_b16 a[176:177], v251 offset:192
    v_mfma_f32_16x16x32_bf16 v[164:167], a[164:167], a[144:147], v[164:167]
    s_lshl_b32 s66, s69, 8
    s_mov_b32 exec_lo, 0
    s_mov_b32 exec_hi, 0xffff0000
    buffer_store_dwordx4 v[96:99], v3, s[40:43], s66 offen sc0 sc1
    s_mov_b64 exec, -1
    v_mfma_f32_16x16x32_bf16 v[168:171], a[164:167], a[148:151], v[168:171]
    ds_read_b64_tr_b16 a[178:179], v251 offset:1984
    v_accvgpr_read_b32 v228, a220
    v_mfma_f32_16x16x32_bf16 v[168:171], a[160:163], a[132:135], v[168:171]
    buffer_load_dwordx4 a[44:47], v2, s[32:35], s60 offen offset:3072 sc1
    s_add_u32 s60, s60, 0x1000
    v_mfma_f32_16x16x32_bf16 v[172:175], a[160:163], a[136:139], v[172:175]
    ds_read_b64_tr_b16 a[180:181], v251 offset:7360
    v_xor_b32 v229, 32, v228
    v_mfma_f32_16x16x32_bf16 v[172:175], a[164:167], a[152:155], v[172:175]
    buffer_load_dwordx4 a[48:51], v2, s[32:35], s60 offen sc1
    v_xor_b32 v230, 64, v228
    v_mfma_f32_16x16x32_bf16 v[176:179], a[164:167], a[156:159], v[176:179]
    ds_read_b64_tr_b16 a[182:183], v251 offset:9152
    v_xor_b32 v231, 96, v228
    v_mfma_f32_16x16x32_bf16 v[176:179], a[160:163], a[140:143], v[176:179]
    v_xor_b32 v232, 128, v228
    s_waitcnt lgkmcnt(4)
    v_mfma_f32_16x16x32_bf16 v[192:195], a[168:171], a[140:143], v[192:195]
    ds_read_b64_tr_b16 a[160:161], v251 offset:14528
    v_xor_b32 v233, 160, v228
    v_mfma_f32_16x16x32_bf16 v[192:195], a[172:175], a[156:159], v[192:195]
    v_xor_b32 v234, 192, v228
    v_xor_b32 v235, 224, v228
    v_mfma_f32_16x16x32_bf16 v[188:191], a[172:175], a[152:155], v[188:191]
    ds_read_b64_tr_b16 a[162:163], v251 offset:16320
    v_accvgpr_read_b32 v236, a228
    v_mfma_f32_16x16x32_bf16 v[188:191], a[168:171], a[136:139], v[188:191]
    v_accvgpr_read_b32 v237, a229
    v_accvgpr_read_b32 v238, a230
    v_mfma_f32_16x16x32_bf16 v[184:187], a[168:171], a[132:135], v[184:187]
    ds_read_b64_tr_b16 a[164:165], v251 offset:21696
    v_accvgpr_read_b32 v239, a231
    v_mfma_f32_16x16x32_bf16 v[184:187], a[172:175], a[148:151], v[184:187]
    buffer_load_dwordx4 a[52:55], v2, s[32:35], s60 offen offset:1024 sc1
    v_mul_f32 v253, v238, v36
    v_mfma_f32_16x16x32_bf16 v[180:183], a[172:175], a[144:147], v[180:183]
    ds_read_b64_tr_b16 a[166:167], v251 offset:23488
    v_mul_f32 v36, v236, v36
    v_mfma_f32_16x16x32_bf16 v[180:183], a[168:171], a[128:131], v[180:183]
    v_fma_f32 v36, -v238, v4, -v36
    s_nop 0
    v_pk_mul_f32 v[68:69], v[172:173], v[172:173]
    v_pk_mul_f32 v[70:71], v[174:175], v[174:175]
    v_pk_mul_f32 v[72:73], v[176:177], v[176:177]
    v_pk_mul_f32 v[74:75], v[178:179], v[178:179]
    v_pk_fma_f32 v[68:69], v[68:69], v[240:241], v[240:241] op_sel:[0,1,0] op_sel_hi:[1,1,0]
    v_pk_fma_f32 v[70:71], v[70:71], v[240:241], v[240:241] op_sel:[0,1,0] op_sel_hi:[1,1,0]
    v_pk_fma_f32 v[72:73], v[72:73], v[240:241], v[240:241] op_sel:[0,1,0] op_sel_hi:[1,1,0]
    v_pk_fma_f32 v[74:75], v[74:75], v[240:241], v[240:241] op_sel:[0,1,0] op_sel_hi:[1,1,0]
    buffer_load_dwordx4 a[56:59], v2, s[32:35], s60 offen offset:2048 sc1
    v_pk_mul_f32 v[68:69], v[68:69], v[172:173]
    v_pk_mul_f32 v[70:71], v[70:71], v[174:175]
    v_pk_mul_f32 v[72:73], v[72:73], v[176:177]
    v_pk_mul_f32 v[74:75], v[74:75], v[178:179]
    v_exp_f32 v68, v68
    v_exp_f32 v69, v69
    v_exp_f32 v70, v70
    v_exp_f32 v71, v71
    v_exp_f32 v72, v72
    v_exp_f32 v73, v73
    v_exp_f32 v74, v74
    v_exp_f32 v75, v75
    buffer_load_dwordx4 a[60:63], v2, s[32:35], s60 offen offset:3072 sc1
    s_add_u32 s60, s60, 0x1000
    v_pk_mul_f32 v[172:173], v[172:173], v[188:189]
    v_pk_mul_f32 v[174:175], v[174:175], v[190:191]
    v_pk_mul_f32 v[176:177], v[176:177], v[192:193]
    v_pk_mul_f32 v[178:179], v[178:179], v[194:195]
    v_pk_add_f32 v[68:69], v[68:69], 1.0 op_sel_hi:[1,0]
    v_pk_add_f32 v[70:71], v[70:71], 1.0 op_sel_hi:[1,0]
    v_pk_add_f32 v[72:73], v[72:73], 1.0 op_sel_hi:[1,0]
    v_pk_add_f32 v[74:75], v[74:75], 1.0 op_sel_hi:[1,0]
    v_rcp_f32 v68, v68
    v_rcp_f32 v69, v69
    v_rcp_f32 v70, v70
    v_rcp_f32 v71, v71
    v_rcp_f32 v72, v72
    v_rcp_f32 v73, v73
    v_rcp_f32 v74, v74
    v_rcp_f32 v75, v75
    v_pk_mul_f32 v[172:173], v[172:173], v[68:69]
    v_pk_mul_f32 v[174:175], v[174:175], v[70:71]
    v_pk_mul_f32 v[176:177], v[176:177], v[72:73]
    v_pk_mul_f32 v[178:179], v[178:179], v[74:75]
    v_cvt_pk_bf16_f32 v76, v172, v173
    v_cvt_pk_bf16_f32 v78, v176, v177
    v_cvt_pk_bf16_f32 v77, v174, v175
    v_cvt_pk_bf16_f32 v79, v178, v179
    v_permlane16_swap_b32 v76, v78
    s_nop 0
    v_permlane16_swap_b32 v77, v79
    s_nop 0
    buffer_store_dwordx4 v[76:79], v246, s[32:35], s65 offen offset:2560 sc0 sc1
    v_pk_mul_f32 v[68:69], v[164:165], v[164:165]
    v_pk_mul_f32 v[70:71], v[166:167], v[166:167]
    v_pk_mul_f32 v[72:73], v[168:169], v[168:169]
    v_pk_mul_f32 v[74:75], v[170:171], v[170:171]
    v_pk_fma_f32 v[68:69], v[68:69], v[240:241], v[240:241] op_sel:[0,1,0] op_sel_hi:[1,1,0]
    v_pk_fma_f32 v[70:71], v[70:71], v[240:241], v[240:241] op_sel:[0,1,0] op_sel_hi:[1,1,0]
    v_pk_fma_f32 v[72:73], v[72:73], v[240:241], v[240:241] op_sel:[0,1,0] op_sel_hi:[1,1,0]
    v_pk_fma_f32 v[74:75], v[74:75], v[240:241], v[240:241] op_sel:[0,1,0] op_sel_hi:[1,1,0]
    buffer_load_dwordx4 a[184:187], v2, s[32:35], s60 offen sc1
    v_pk_mul_f32 v[68:69], v[68:69], v[164:165]
    v_pk_mul_f32 v[70:71], v[70:71], v[166:167]
    v_pk_mul_f32 v[72:73], v[72:73], v[168:169]
    v_pk_mul_f32 v[74:75], v[74:75], v[170:171]
    v_exp_f32 v68, v68
    v_exp_f32 v69, v69
    v_exp_f32 v70, v70
    v_exp_f32 v71, v71
    v_exp_f32 v72, v72
    v_exp_f32 v73, v73
    v_exp_f32 v74, v74
    v_exp_f32 v75, v75
    buffer_load_dwordx4 a[188:191], v2, s[32:35], s60 offen offset:1024 sc1
    v_pk_mul_f32 v[164:165], v[164:165], v[180:181]
    v_pk_mul_f32 v[166:167], v[166:167], v[182:183]
    v_pk_mul_f32 v[168:169], v[168:169], v[184:185]
    v_pk_mul_f32 v[170:171], v[170:171], v[186:187]
    v_pk_add_f32 v[68:69], v[68:69], 1.0 op_sel_hi:[1,0]
    v_pk_add_f32 v[70:71], v[70:71], 1.0 op_sel_hi:[1,0]
    v_pk_add_f32 v[72:73], v[72:73], 1.0 op_sel_hi:[1,0]
    v_pk_add_f32 v[74:75], v[74:75], 1.0 op_sel_hi:[1,0]
    v_rcp_f32 v68, v68
    v_rcp_f32 v69, v69
    v_rcp_f32 v70, v70
    v_rcp_f32 v71, v71
    v_rcp_f32 v72, v72
    v_rcp_f32 v73, v73
    v_rcp_f32 v74, v74
    v_rcp_f32 v75, v75
    v_pk_mul_f32 v[164:165], v[164:165], v[68:69]
    v_pk_mul_f32 v[166:167], v[166:167], v[70:71]
    v_pk_mul_f32 v[168:169], v[168:169], v[72:73]
    v_pk_mul_f32 v[170:171], v[170:171], v[74:75]
    v_cvt_pk_bf16_f32 v80, v164, v165
    v_cvt_pk_bf16_f32 v82, v168, v169
    v_cvt_pk_bf16_f32 v81, v166, v167
    v_cvt_pk_bf16_f32 v83, v170, v171
    v_permlane16_swap_b32 v80, v82
    s_nop 0
    v_permlane16_swap_b32 v81, v83
    buffer_store_dwordx4 v[80:83], v246, s[32:35], s65 offen offset:512 sc0 sc1
    s_waitcnt lgkmcnt(4)
    v_mfma_f32_16x16x32_bf16 v[196:199], a[176:179], a[0:3], v[196:199]
    ds_read_b64_tr_b16 a[168:169], v251 offset:28864
    v_fma_f32 v4, v236, v4, -v253
    v_mfma_f32_16x16x32_bf16 v[196:199], a[180:183], a[16:19], v[196:199]
    buffer_load_dword v252, v249, s[52:55], 0 offen sc0 sc1
    v_mul_f32 v253, v238, v37
    v_mfma_f32_16x16x32_bf16 v[200:203], a[180:183], a[20:23], v[200:203]
    ds_read_b64_tr_b16 a[170:171], v251 offset:30656
    v_mul_f32 v37, v236, v37
    v_mfma_f32_16x16x32_bf16 v[200:203], a[176:179], a[4:7], v[200:203]
    buffer_load_dwordx4 a[192:195], v2, s[32:35], s60 offen offset:2048 sc1
    v_fma_f32 v37, -v238, v5, -v37
    v_mfma_f32_16x16x32_bf16 v[204:207], a[176:179], a[8:11], v[204:207]
    ds_read_b64_tr_b16 a[172:173], v251 offset:36032
    v_fma_f32 v5, v236, v5, -v253
    v_mfma_f32_16x16x32_bf16 v[204:207], a[180:183], a[24:27], v[204:207]
    buffer_load_dwordx4 a[196:199], v2, s[32:35], s60 offen offset:3072 sc1
    v_mul_f32 v253, v238, v38
    v_mfma_f32_16x16x32_bf16 v[208:211], a[180:183], a[28:31], v[208:211]
    ds_read_b64_tr_b16 a[174:175], v251 offset:37824
    v_mul_f32 v38, v236, v38
    v_mfma_f32_16x16x32_bf16 v[208:211], a[176:179], a[12:15], v[208:211]
    s_add_u32 s60, s60, 0x1000
    v_fma_f32 v38, -v238, v6, -v38
    s_waitcnt lgkmcnt(4)
    v_mfma_f32_16x16x32_bf16 v[224:227], a[160:163], a[12:15], v[224:227]
    ds_read_b64_tr_b16 a[176:177], v251 offset:43200
    v_fma_f32 v6, v236, v6, -v253
    v_mfma_f32_16x16x32_bf16 v[224:227], a[164:167], a[28:31], v[224:227]
    v_mul_f32 v253, v238, v39
    v_mul_f32 v39, v236, v39
    v_mfma_f32_16x16x32_bf16 v[220:223], a[164:167], a[24:27], v[220:223]
    ds_read_b64_tr_b16 a[178:179], v251 offset:44992
    v_fma_f32 v39, -v238, v7, -v39
    v_mfma_f32_16x16x32_bf16 v[220:223], a[160:163], a[8:11], v[220:223]
    buffer_load_dwordx4 a[64:67], v2, s[32:35], s60 offen sc1
    v_fma_f32 v7, v236, v7, -v253
    v_mfma_f32_16x16x32_bf16 v[216:219], a[160:163], a[4:7], v[216:219]
    ds_read_b64_tr_b16 a[180:181], v251 offset:50368
    v_mul_f32 v253, v238, v40
    v_mfma_f32_16x16x32_bf16 v[216:219], a[164:167], a[20:23], v[216:219]
    v_mul_f32 v40, v236, v40
    v_fma_f32 v40, -v238, v8, -v40
    v_mfma_f32_16x16x32_bf16 v[212:215], a[164:167], a[16:19], v[212:215]
    ds_read_b64_tr_b16 a[182:183], v251 offset:52160
    v_fma_f32 v8, v236, v8, -v253
    v_mfma_f32_16x16x32_bf16 v[212:215], a[160:163], a[0:3], v[212:215]
    v_mul_f32 v253, v238, v41
    s_waitcnt lgkmcnt(4)
    v_mfma_f32_16x16x32_bf16 v[196:199], a[168:171], a[128:131], v[196:199]
    ds_read_b64_tr_b16 a[160:161], v228 offset:0
    v_mul_f32 v41, v236, v41
    v_mfma_f32_16x16x32_bf16 v[196:199], a[172:175], a[144:147], v[196:199]
    v_fma_f32 v41, -v238, v9, -v41
    v_fma_f32 v9, v236, v9, -v253
    v_mfma_f32_16x16x32_bf16 v[200:203], a[172:175], a[148:151], v[200:203]
    ds_read_b64_tr_b16 a[162:163], v228 offset:2048
    v_mul_f32 v253, v238, v42
    v_mfma_f32_16x16x32_bf16 v[200:203], a[168:171], a[132:135], v[200:203]
    buffer_load_dwordx4 a[68:71], v2, s[32:35], s60 offen offset:1024 sc1
    v_mul_f32 v42, v236, v42
    v_mfma_f32_16x16x32_bf16 v[204:207], a[168:171], a[136:139], v[204:207]
    ds_read_b64_tr_b16 a[164:165], v228 offset:8192
    v_fma_f32 v42, -v238, v10, -v42
    v_mfma_f32_16x16x32_bf16 v[204:207], a[172:175], a[152:155], v[204:207]
    buffer_load_dwordx4 a[72:75], v2, s[32:35], s60 offen offset:2048 sc1
    v_fma_f32 v10, v236, v10, -v253
    v_mfma_f32_16x16x32_bf16 v[208:211], a[172:175], a[156:159], v[208:211]
    ds_read_b64_tr_b16 a[166:167], v228 offset:10240
    v_mul_f32 v253, v238, v43
    v_mfma_f32_16x16x32_bf16 v[208:211], a[168:171], a[140:143], v[208:211]
    v_mul_f32 v43, v236, v43
    s_waitcnt vmcnt(41) lgkmcnt(4)
    s_barrier
    v_mfma_f32_16x16x32_bf16 v[224:227], a[176:179], a[140:143], v[224:227]
    ds_read_b64_tr_b16 a[168:169], v229 offset:0
    v_fma_f32 v43, -v238, v11, -v43
    v_mfma_f32_16x16x32_bf16 v[224:227], a[180:183], a[156:159], v[224:227]
    v_fma_f32 v11, v236, v11, -v253
    v_mul_f32 v253, v238, v44
    v_mfma_f32_16x16x32_bf16 v[220:223], a[180:183], a[152:155], v[220:223]
    ds_read_b64_tr_b16 a[170:171], v229 offset:2048
    v_mul_f32 v44, v236, v44
    v_mfma_f32_16x16x32_bf16 v[220:223], a[176:179], a[136:139], v[220:223]
    buffer_load_dwordx4 a[76:79], v2, s[32:35], s60 offen offset:3072 sc1
    s_add_u32 s60, s60, 0x1000
    v_mfma_f32_16x16x32_bf16 v[216:219], a[176:179], a[132:135], v[216:219]
    ds_read_b64_tr_b16 a[172:173], v229 offset:8192
    v_fma_f32 v44, -v238, v12, -v44
    v_mfma_f32_16x16x32_bf16 v[216:219], a[180:183], a[148:151], v[216:219]
    buffer_load_dwordx4 a[80:83], v2, s[32:35], s60 offen sc1
    v_fma_f32 v12, v236, v12, -v253
    v_mfma_f32_16x16x32_bf16 v[212:215], a[180:183], a[144:147], v[212:215]
    ds_read_b64_tr_b16 a[174:175], v229 offset:10240
    v_mul_f32 v253, v238, v45
    v_mfma_f32_16x16x32_bf16 v[212:215], a[176:179], a[128:131], v[212:215]
    v_mul_f32 v45, v236, v45
    v_pk_mul_f32 v[68:69], v[204:205], v[204:205]
    v_pk_mul_f32 v[70:71], v[206:207], v[206:207]
    v_pk_mul_f32 v[72:73], v[208:209], v[208:209]
    v_pk_mul_f32 v[74:75], v[210:211], v[210:211]
    v_pk_fma_f32 v[68:69], v[68:69], v[240:241], v[240:241] op_sel:[0,1,0] op_sel_hi:[1,1,0]
    v_pk_fma_f32 v[70:71], v[70:71], v[240:241], v[240:241] op_sel:[0,1,0] op_sel_hi:[1,1,0]
    v_pk_fma_f32 v[72:73], v[72:73], v[240:241], v[240:241] op_sel:[0,1,0] op_sel_hi:[1,1,0]
    v_pk_fma_f32 v[74:75], v[74:75], v[240:241], v[240:241] op_sel:[0,1,0] op_sel_hi:[1,1,0]
    buffer_load_dwordx4 a[84:87], v2, s[32:35], s60 offen offset:1024 sc1
    v_pk_mul_f32 v[68:69], v[68:69], v[204:205]
    v_pk_mul_f32 v[70:71], v[70:71], v[206:207]
    v_pk_mul_f32 v[72:73], v[72:73], v[208:209]
    v_pk_mul_f32 v[74:75], v[74:75], v[210:211]
    v_exp_f32 v68, v68
    v_exp_f32 v69, v69
    v_exp_f32 v70, v70
    v_exp_f32 v71, v71
    v_exp_f32 v72, v72
    v_exp_f32 v73, v73
    v_exp_f32 v74, v74
    v_exp_f32 v75, v75
    buffer_load_dwordx4 a[88:91], v2, s[32:35], s60 offen offset:2048 sc1
    v_pk_mul_f32 v[204:205], v[204:205], v[220:221]
    v_pk_mul_f32 v[206:207], v[206:207], v[222:223]
    v_pk_mul_f32 v[208:209], v[208:209], v[224:225]
    v_pk_mul_f32 v[210:211], v[210:211], v[226:227]
    v_pk_add_f32 v[68:69], v[68:69], 1.0 op_sel_hi:[1,0]
    v_pk_add_f32 v[70:71], v[70:71], 1.0 op_sel_hi:[1,0]
    v_pk_add_f32 v[72:73], v[72:73], 1.0 op_sel_hi:[1,0]
    v_pk_add_f32 v[74:75], v[74:75], 1.0 op_sel_hi:[1,0]
    v_rcp_f32 v68, v68
    v_rcp_f32 v69, v69
    v_rcp_f32 v70, v70
    v_rcp_f32 v71, v71
    v_rcp_f32 v72, v72
    v_rcp_f32 v73, v73
    v_rcp_f32 v74, v74
    v_rcp_f32 v75, v75
    v_pk_mul_f32 v[204:205], v[204:205], v[68:69]
    v_pk_mul_f32 v[206:207], v[206:207], v[70:71]
    v_pk_mul_f32 v[208:209], v[208:209], v[72:73]
    v_pk_mul_f32 v[210:211], v[210:211], v[74:75]
    v_cvt_pk_bf16_f32 v76, v204, v205
    v_cvt_pk_bf16_f32 v78, v208, v209
    v_cvt_pk_bf16_f32 v77, v206, v207
    v_cvt_pk_bf16_f32 v79, v210, v211
    v_permlane16_swap_b32 v76, v78
    s_nop 0
    v_permlane16_swap_b32 v77, v79
    s_nop 0
    buffer_store_dwordx4 v[76:79], v246, s[32:35], s6 offen offset:2048 sc0 sc1
    v_pk_mul_f32 v[68:69], v[196:197], v[196:197]
    v_pk_mul_f32 v[70:71], v[198:199], v[198:199]
    v_pk_mul_f32 v[72:73], v[200:201], v[200:201]
    v_pk_mul_f32 v[74:75], v[202:203], v[202:203]
    v_pk_fma_f32 v[68:69], v[68:69], v[240:241], v[240:241] op_sel:[0,1,0] op_sel_hi:[1,1,0]
    v_pk_fma_f32 v[70:71], v[70:71], v[240:241], v[240:241] op_sel:[0,1,0] op_sel_hi:[1,1,0]
    v_pk_fma_f32 v[72:73], v[72:73], v[240:241], v[240:241] op_sel:[0,1,0] op_sel_hi:[1,1,0]
    v_pk_fma_f32 v[74:75], v[74:75], v[240:241], v[240:241] op_sel:[0,1,0] op_sel_hi:[1,1,0]
    buffer_load_dwordx4 a[92:95], v2, s[32:35], s60 offen offset:3072 sc1
    s_add_u32 s60, s60, 0x1000
    v_pk_mul_f32 v[68:69], v[68:69], v[196:197]
    v_pk_mul_f32 v[70:71], v[70:71], v[198:199]
    v_pk_mul_f32 v[72:73], v[72:73], v[200:201]
    v_pk_mul_f32 v[74:75], v[74:75], v[202:203]
    v_exp_f32 v68, v68
    v_exp_f32 v69, v69
    v_exp_f32 v70, v70
    v_exp_f32 v71, v71
    v_exp_f32 v72, v72
    v_exp_f32 v73, v73
    v_exp_f32 v74, v74
    v_exp_f32 v75, v75
    buffer_load_dwordx4 a[0:3], v2, s[32:35], s60 offen sc1
    v_pk_mul_f32 v[196:197], v[196:197], v[212:213]
    v_pk_mul_f32 v[198:199], v[198:199], v[214:215]
    v_pk_mul_f32 v[200:201], v[200:201], v[216:217]
    v_pk_mul_f32 v[202:203], v[202:203], v[218:219]
    v_pk_add_f32 v[68:69], v[68:69], 1.0 op_sel_hi:[1,0]
    v_pk_add_f32 v[70:71], v[70:71], 1.0 op_sel_hi:[1,0]
    v_pk_add_f32 v[72:73], v[72:73], 1.0 op_sel_hi:[1,0]
    v_pk_add_f32 v[74:75], v[74:75], 1.0 op_sel_hi:[1,0]
    v_rcp_f32 v68, v68
    v_rcp_f32 v69, v69
    v_rcp_f32 v70, v70
    v_rcp_f32 v71, v71
    v_rcp_f32 v72, v72
    v_rcp_f32 v73, v73
    v_rcp_f32 v74, v74
    v_rcp_f32 v75, v75
    v_pk_mul_f32 v[196:197], v[196:197], v[68:69]
    v_pk_mul_f32 v[198:199], v[198:199], v[70:71]
    v_pk_mul_f32 v[200:201], v[200:201], v[72:73]
    v_pk_mul_f32 v[202:203], v[202:203], v[74:75]
    v_cvt_pk_bf16_f32 v80, v196, v197
    v_cvt_pk_bf16_f32 v82, v200, v201
    v_cvt_pk_bf16_f32 v81, v198, v199
    v_cvt_pk_bf16_f32 v83, v202, v203
    v_permlane16_swap_b32 v80, v82
    s_nop 0
    v_permlane16_swap_b32 v81, v83
    buffer_store_dwordx4 v[80:83], v246, s[32:35], s6 offen sc0 sc1
    s_nop 1
    s_waitcnt vmcnt(18) lgkmcnt(4)
    v_mfma_f32_16x16x32_bf16 v[68:71], a[160:163], a[32:35], 0
    ds_read_b64_tr_b16 a[176:177], v230 offset:0
    v_fma_f32 v45, -v238, v13, -v45
    v_mfma_f32_16x16x32_bf16 v[68:71], a[164:167], a[48:51], v[68:71]
    v_fma_f32 v13, v236, v13, -v253
    s_sub_u32 s66, s69, 32
    s_lshl_b32 s66, s66, 8
    v_mfma_f32_16x16x32_bf16 v[72:75], a[164:167], a[52:55], 0
    ds_read_b64_tr_b16 a[178:179], v230 offset:2048
    v_lshrrev_b32 v240, 4, v1
    v_mfma_f32_16x16x32_bf16 v[72:75], a[160:163], a[36:39], v[72:75]
    v_lshl_add_u32 v240, v240, 11, v3
    v_add_u32 v240, s66, v240
    v_mfma_f32_16x16x32_bf16 v[76:79], a[160:163], a[40:43], 0
    ds_read_b64_tr_b16 a[180:181], v230 offset:8192
    v_mfma_f32_16x16x32_bf16 v[76:79], a[164:167], a[56:59], v[76:79]
    buffer_load_dwordx4 a[4:7], v2, s[32:35], s60 offen offset:1024 sc1
    v_mfma_f32_16x16x32_bf16 v[80:83], a[164:167], a[60:63], 0
    ds_read_b64_tr_b16 a[182:183], v230 offset:10240
    v_mfma_f32_16x16x32_bf16 v[80:83], a[160:163], a[44:47], v[80:83]
    s_waitcnt lgkmcnt(4)
    v_mfma_f32_16x16x32_bf16 v[96:99], a[168:171], a[44:47], 0
    ds_read_b64_tr_b16 a[160:161], v231 offset:0
    v_mfma_f32_16x16x32_bf16 v[96:99], a[172:175], a[60:63], v[96:99]
    s_add_u32 s21, s3, 3
    s_waitcnt vmcnt(14)
    v_subrev_u32 v252, s21, v252
    v_cmp_lt_u32 vcc, 12, v252
    s_cbranch_vccnz fa_f2_slow
fa_f2_ok:
    v_mfma_f32_16x16x32_bf16 v[92:95], a[172:175], a[56:59], 0
    ds_read_b64_tr_b16 a[162:163], v231 offset:2048
    v_mfma_f32_16x16x32_bf16 v[92:95], a[168:171], a[40:43], v[92:95]
    buffer_load_dwordx4 a[8:11], v2, s[32:35], s60 offen offset:2048 sc1
    v_mfma_f32_16x16x32_bf16 v[88:91], a[168:171], a[36:39], 0
    ds_read_b64_tr_b16 a[164:165], v231 offset:8192
    v_mfma_f32_16x16x32_bf16 v[88:91], a[172:175], a[52:55], v[88:91]
    buffer_load_dwordx4 a[12:15], v2, s[32:35], s60 offen offset:3072 sc1
    v_mfma_f32_16x16x32_bf16 v[84:87], a[172:175], a[48:51], 0
    ds_read_b64_tr_b16 a[166:167], v231 offset:10240
    v_mfma_f32_16x16x32_bf16 v[84:87], a[168:171], a[32:35], v[84:87]
    s_add_u32 s60, s60, 0x1000
    s_waitcnt lgkmcnt(4)
    v_mfma_f32_16x16x32_bf16 v[100:103], a[176:179], a[32:35], 0
    ds_read_b64_tr_b16 a[168:169], v232 offset:0
    v_mfma_f32_16x16x32_bf16 v[100:103], a[180:183], a[48:51], v[100:103]
    v_mfma_f32_16x16x32_bf16 v[104:107], a[180:183], a[52:55], 0
    ds_read_b64_tr_b16 a[170:171], v232 offset:2048
    v_mfma_f32_16x16x32_bf16 v[104:107], a[176:179], a[36:39], v[104:107]
    buffer_load_dwordx4 a[16:19], v2, s[32:35], s60 offen sc1
    v_mfma_f32_16x16x32_bf16 v[108:111], a[176:179], a[40:43], 0
    ds_read_b64_tr_b16 a[172:173], v232 offset:8192
    v_mfma_f32_16x16x32_bf16 v[108:111], a[180:183], a[56:59], v[108:111]
    v_mfma_f32_16x16x32_bf16 v[112:115], a[180:183], a[60:63], 0
    ds_read_b64_tr_b16 a[174:175], v232 offset:10240
    v_mfma_f32_16x16x32_bf16 v[112:115], a[176:179], a[44:47], v[112:115]
    s_waitcnt lgkmcnt(4)
    v_mfma_f32_16x16x32_bf16 v[128:131], a[160:163], a[44:47], 0
    ds_read_b64_tr_b16 a[176:177], v233 offset:0
    v_mfma_f32_16x16x32_bf16 v[128:131], a[164:167], a[60:63], v[128:131]
    buffer_load_dwordx4 v[196:199], v240, s[40:43], 0 offen sc0 sc1
    v_add_u32 v240, 256, v240
    v_mfma_f32_16x16x32_bf16 v[124:127], a[164:167], a[56:59], 0
    ds_read_b64_tr_b16 a[178:179], v233 offset:2048
    v_mul_f32 v253, v238, v46
    v_mfma_f32_16x16x32_bf16 v[124:127], a[160:163], a[40:43], v[124:127]
    buffer_load_dwordx4 a[20:23], v2, s[32:35], s60 offen offset:1024 sc1
    v_mul_f32 v46, v236, v46
    v_mfma_f32_16x16x32_bf16 v[120:123], a[160:163], a[36:39], 0
    ds_read_b64_tr_b16 a[180:181], v233 offset:8192
    v_fma_f32 v46, -v238, v14, -v46
    v_mfma_f32_16x16x32_bf16 v[120:123], a[164:167], a[52:55], v[120:123]
    buffer_load_dwordx4 a[24:27], v2, s[32:35], s60 offen offset:2048 sc1
    v_fma_f32 v14, v236, v14, -v253
    v_mfma_f32_16x16x32_bf16 v[116:119], a[164:167], a[48:51], 0
    ds_read_b64_tr_b16 a[182:183], v233 offset:10240
    v_mfma_f32_16x16x32_bf16 v[116:119], a[160:163], a[32:35], v[116:119]
    buffer_load_dwordx4 v[200:203], v240, s[40:43], 0 offen sc0 sc1
    s_waitcnt lgkmcnt(4)
    v_mfma_f32_16x16x32_bf16 v[132:135], a[168:171], a[32:35], 0
    ds_read_b64_tr_b16 a[160:161], v234 offset:0
    v_add_u32 v240, 256, v240
    v_mfma_f32_16x16x32_bf16 v[132:135], a[172:175], a[48:51], v[132:135]
    v_mul_f32 v253, v238, v47
    v_mul_f32 v47, v236, v47
    v_mfma_f32_16x16x32_bf16 v[136:139], a[172:175], a[52:55], 0
    ds_read_b64_tr_b16 a[162:163], v234 offset:2048
    v_fma_f32 v47, -v238, v15, -v47
    v_mfma_f32_16x16x32_bf16 v[136:139], a[168:171], a[36:39], v[136:139]
    v_fma_f32 v15, v236, v15, -v253
    v_mfma_f32_16x16x32_bf16 v[140:143], a[168:171], a[40:43], 0
    ds_read_b64_tr_b16 a[164:165], v234 offset:8192
    v_mfma_f32_16x16x32_bf16 v[140:143], a[172:175], a[56:59], v[140:143]
    buffer_load_dwordx4 a[28:31], v2, s[32:35], s60 offen offset:3072 sc1
    buffer_load_dwordx4 v[204:207], v240, s[40:43], 0 offen sc0 sc1
    v_mfma_f32_16x16x32_bf16 v[144:147], a[172:175], a[60:63], 0
    ds_read_b64_tr_b16 a[166:167], v234 offset:10240
    v_add_u32 v240, 256, v240
    v_mfma_f32_16x16x32_bf16 v[144:147], a[168:171], a[44:47], v[144:147]
    s_add_u32 s60, s60, 0x1000
    v_mul_f32 v253, v238, v48
    s_waitcnt lgkmcnt(4)
    v_mfma_f32_16x16x32_bf16 v[160:163], a[176:179], a[44:47], 0
    ds_read_b64_tr_b16 a[168:169], v235 offset:0
    v_mul_f32 v48, v236, v48
    v_mfma_f32_16x16x32_bf16 v[160:163], a[180:183], a[60:63], v[160:163]
    v_fma_f32 v48, -v238, v16, -v48
    v_fma_f32 v16, v236, v16, -v253
    v_mfma_f32_16x16x32_bf16 v[156:159], a[180:183], a[56:59], 0
    ds_read_b64_tr_b16 a[170:171], v235 offset:2048
    v_mfma_f32_16x16x32_bf16 v[156:159], a[176:179], a[40:43], v[156:159]
    buffer_load_dwordx4 v[208:211], v240, s[40:43], 0 offen sc0 sc1
    v_add_u32 v240, 256, v240
    v_mfma_f32_16x16x32_bf16 v[152:155], a[176:179], a[36:39], 0
    ds_read_b64_tr_b16 a[172:173], v235 offset:8192
    v_mul_f32 v253, v238, v49
    v_mfma_f32_16x16x32_bf16 v[152:155], a[180:183], a[52:55], v[152:155]
    v_mul_f32 v49, v236, v49
    v_fma_f32 v49, -v238, v17, -v49
    v_mfma_f32_16x16x32_bf16 v[148:151], a[180:183], a[48:51], 0
    ds_read_b64_tr_b16 a[174:175], v235 offset:10240
    v_fma_f32 v17, v236, v17, -v253
    v_mfma_f32_16x16x32_bf16 v[148:151], a[176:179], a[32:35], v[148:151]
    buffer_load_dwordx4 v[212:215], v240, s[40:43], 0 offen sc0 sc1
    s_waitcnt lgkmcnt(4)
    v_mfma_f32_16x16x32_bf16 v[164:167], a[160:163], a[32:35], 0
    ds_read_b64_tr_b16 a[176:177], v228 offset:16384
    v_add_u32 v240, 256, v240
    v_mfma_f32_16x16x32_bf16 v[164:167], a[164:167], a[48:51], v[164:167]
    s_waitcnt vmcnt(12)
    v_or_b32_e64 v250, s3, 4
    s_mov_b64 exec, 1
    buffer_store_dword v250, v3, s[52:55], s20 offen sc0 sc1
    s_mov_b64 exec, -1
    v_mfma_f32_16x16x32_bf16 v[168:171], a[164:167], a[52:55], 0
    ds_read_b64_tr_b16 a[178:179], v228 offset:18432
    v_mul_f32 v253, v238, v50
    v_mfma_f32_16x16x32_bf16 v[168:171], a[160:163], a[36:39], v[168:171]
    buffer_load_dwordx4 a[128:131], v2, s[32:35], s60 offen sc1
    v_mul_f32 v50, v236, v50
    v_mfma_f32_16x16x32_bf16 v[172:175], a[160:163], a[40:43], 0
    ds_read_b64_tr_b16 a[180:181], v228 offset:24576
    v_fma_f32 v50, -v238, v18, -v50
    v_mfma_f32_16x16x32_bf16 v[172:175], a[164:167], a[56:59], v[172:175]
    v_fma_f32 v18, v236, v18, -v253
    v_mfma_f32_16x16x32_bf16 v[176:179], a[164:167], a[60:63], 0
    ds_read_b64_tr_b16 a[182:183], v228 offset:26624
    v_mfma_f32_16x16x32_bf16 v[176:179], a[160:163], a[44:47], v[176:179]
    buffer_load_dwordx4 v[216:219], v240, s[40:43], 0 offen sc0 sc1
    s_waitcnt lgkmcnt(4)
    v_mfma_f32_16x16x32_bf16 v[192:195], a[168:171], a[44:47], 0
    ds_read_b64_tr_b16 a[160:161], v229 offset:16384
    v_add_u32 v240, 256, v240
    v_mfma_f32_16x16x32_bf16 v[192:195], a[172:175], a[60:63], v[192:195]
    v_mul_f32 v253, v238, v51
    v_mul_f32 v51, v236, v51
    v_mfma_f32_16x16x32_bf16 v[188:191], a[172:175], a[56:59], 0
    ds_read_b64_tr_b16 a[162:163], v229 offset:18432
    v_fma_f32 v51, -v238, v19, -v51
    v_mfma_f32_16x16x32_bf16 v[188:191], a[168:171], a[40:43], v[188:191]
    buffer_load_dwordx4 a[132:135], v2, s[32:35], s60 offen offset:1024 sc1
    v_fma_f32 v19, v236, v19, -v253
    v_mfma_f32_16x16x32_bf16 v[184:187], a[168:171], a[36:39], 0
    ds_read_b64_tr_b16 a[164:165], v229 offset:24576
    v_mfma_f32_16x16x32_bf16 v[184:187], a[172:175], a[52:55], v[184:187]
    buffer_load_dwordx4 v[220:223], v240, s[40:43], 0 offen sc0 sc1
    v_add_u32 v240, 256, v240
    v_mfma_f32_16x16x32_bf16 v[180:183], a[172:175], a[48:51], 0
    ds_read_b64_tr_b16 a[166:167], v229 offset:26624
    v_mul_f32 v253, v239, v52
    v_mfma_f32_16x16x32_bf16 v[180:183], a[168:171], a[32:35], v[180:183]
    v_mul_f32 v52, v237, v52
    s_waitcnt vmcnt(24) lgkmcnt(4)
    v_mfma_f32_16x16x32_bf16 v[68:71], a[176:179], a[184:187], v[68:71]
    ds_read_b64_tr_b16 a[168:169], v230 offset:16384
    v_fma_f32 v52, -v239, v20, -v52
    v_mfma_f32_16x16x32_bf16 v[68:71], a[180:183], a[64:67], v[68:71]
    v_fma_f32 v20, v237, v20, -v253
    v_mfma_f32_16x16x32_bf16 v[72:75], a[180:183], a[68:71], v[72:75]
    ds_read_b64_tr_b16 a[170:171], v230 offset:18432
    v_mfma_f32_16x16x32_bf16 v[72:75], a[176:179], a[188:191], v[72:75]
    buffer_load_dwordx4 a[136:139], v2, s[32:35], s60 offen offset:2048 sc1
    buffer_load_dwordx4 v[224:227], v240, s[40:43], 0 offen sc0 sc1
    v_mfma_f32_16x16x32_bf16 v[76:79], a[176:179], a[192:195], v[76:79]
    ds_read_b64_tr_b16 a[172:173], v230 offset:24576
    v_add_u32 v240, 256, v240
    v_mfma_f32_16x16x32_bf16 v[76:79], a[180:183], a[72:75], v[76:79]
    v_mul_f32 v253, v239, v53
    v_mul_f32 v53, v237, v53
    v_mfma_f32_16x16x32_bf16 v[80:83], a[180:183], a[76:79], v[80:83]
    ds_read_b64_tr_b16 a[174:175], v230 offset:26624
    v_fma_f32 v53, -v239, v21, -v53
    v_mfma_f32_16x16x32_bf16 v[80:83], a[176:179], a[196:199], v[80:83]
    v_fma_f32 v21, v237, v21, -v253
    s_waitcnt lgkmcnt(4)
    v_mfma_f32_16x16x32_bf16 v[96:99], a[160:163], a[196:199], v[96:99]
    ds_read_b64_tr_b16 a[176:177], v231 offset:16384
    v_mul_f32 v253, v239, v54
    v_mfma_f32_16x16x32_bf16 v[96:99], a[164:167], a[76:79], v[96:99]
    v_mul_f32 v54, v237, v54
    v_fma_f32 v54, -v239, v22, -v54
    v_mfma_f32_16x16x32_bf16 v[92:95], a[164:167], a[72:75], v[92:95]
    ds_read_b64_tr_b16 a[178:179], v231 offset:18432
    v_fma_f32 v22, v237, v22, -v253
    v_mfma_f32_16x16x32_bf16 v[92:95], a[160:163], a[192:195], v[92:95]
    buffer_load_dwordx4 a[140:143], v2, s[32:35], s60 offen offset:3072 sc1
    s_add_u32 s60, s60, 0x1000
    v_mfma_f32_16x16x32_bf16 v[88:91], a[160:163], a[188:191], v[88:91]
    ds_read_b64_tr_b16 a[180:181], v231 offset:24576
    v_mul_f32 v253, v239, v55
    v_mfma_f32_16x16x32_bf16 v[88:91], a[164:167], a[68:71], v[88:91]
    s_add_u32 s61, s4, 65536
    s_add_u32 m0, s64, 65536
    v_mul_f32 v55, v237, v55
    v_mfma_f32_16x16x32_bf16 v[84:87], a[164:167], a[64:67], v[84:87]
    ds_read_b64_tr_b16 a[182:183], v231 offset:26624
    v_fma_f32 v55, -v239, v23, -v55
    v_mfma_f32_16x16x32_bf16 v[84:87], a[160:163], a[184:187], v[84:87]
    buffer_load_dwordx4 v242, s[48:51], s61 offen lds
    s_waitcnt lgkmcnt(4)
    v_mfma_f32_16x16x32_bf16 v[100:103], a[168:171], a[184:187], v[100:103]
    ds_read_b64_tr_b16 a[160:161], v232 offset:16384
    v_fma_f32 v23, v237, v23, -v253
    v_mfma_f32_16x16x32_bf16 v[100:103], a[172:175], a[64:67], v[100:103]
    v_mul_f32 v253, v239, v56
    v_mul_f32 v56, v237, v56
    v_mfma_f32_16x16x32_bf16 v[104:107], a[172:175], a[68:71], v[104:107]
    ds_read_b64_tr_b16 a[162:163], v232 offset:18432
    v_fma_f32 v56, -v239, v24, -v56
    v_mfma_f32_16x16x32_bf16 v[104:107], a[168:171], a[188:191], v[104:107]
    buffer_load_dwordx4 v243, s[48:51], s61 offen offset:1024 lds
    v_fma_f32 v24, v237, v24, -v253
    v_mfma_f32_16x16x32_bf16 v[108:111], a[168:171], a[192:195], v[108:111]
    ds_read_b64_tr_b16 a[164:165], v232 offset:24576
    v_mul_f32 v253, v239, v57
    v_mfma_f32_16x16x32_bf16 v[108:111], a[172:175], a[72:75], v[108:111]
    v_mul_f32 v57, v237, v57
    v_fma_f32 v57, -v239, v25, -v57
    v_mfma_f32_16x16x32_bf16 v[112:115], a[172:175], a[76:79], v[112:115]
    ds_read_b64_tr_b16 a[166:167], v232 offset:26624
    v_fma_f32 v25, v237, v25, -v253
    v_mfma_f32_16x16x32_bf16 v[112:115], a[168:171], a[196:199], v[112:115]
    v_mul_f32 v253, v239, v58
    s_waitcnt lgkmcnt(4)
    v_mfma_f32_16x16x32_bf16 v[128:131], a[176:179], a[196:199], v[128:131]
    ds_read_b64_tr_b16 a[168:169], v233 offset:16384
    v_mul_f32 v58, v237, v58
    v_mfma_f32_16x16x32_bf16 v[128:131], a[180:183], a[76:79], v[128:131]
    v_fma_f32 v58, -v239, v26, -v58
    v_fma_f32 v26, v237, v26, -v253
    v_mfma_f32_16x16x32_bf16 v[124:127], a[180:183], a[72:75], v[124:127]
    ds_read_b64_tr_b16 a[170:171], v233 offset:18432
    v_mul_f32 v253, v239, v59
    v_mfma_f32_16x16x32_bf16 v[124:127], a[176:179], a[192:195], v[124:127]
    buffer_load_dwordx4 v244, s[48:51], s61 offen offset:2048 lds
    v_mul_f32 v59, v237, v59
    v_mfma_f32_16x16x32_bf16 v[120:123], a[176:179], a[188:191], v[120:123]
    ds_read_b64_tr_b16 a[172:173], v233 offset:24576
    v_fma_f32 v59, -v239, v27, -v59
    v_mfma_f32_16x16x32_bf16 v[120:123], a[180:183], a[68:71], v[120:123]
    buffer_load_dwordx4 v245, s[48:51], s61 offen offset:3072 lds
    v_fma_f32 v27, v237, v27, -v253
    v_mfma_f32_16x16x32_bf16 v[116:119], a[180:183], a[64:67], v[116:119]
    ds_read_b64_tr_b16 a[174:175], v233 offset:26624
    v_mul_f32 v253, v239, v60
    v_mfma_f32_16x16x32_bf16 v[116:119], a[176:179], a[184:187], v[116:119]
    v_mul_f32 v60, v237, v60
    s_waitcnt lgkmcnt(4)
    v_mfma_f32_16x16x32_bf16 v[132:135], a[160:163], a[184:187], v[132:135]
    ds_read_b64_tr_b16 a[176:177], v234 offset:16384
    v_fma_f32 v60, -v239, v28, -v60
    v_mfma_f32_16x16x32_bf16 v[132:135], a[164:167], a[64:67], v[132:135]
    s_add_u32 s61, s4, 524288
    s_add_u32 m0, s64, 81920
    v_fma_f32 v28, v237, v28, -v253
    v_mfma_f32_16x16x32_bf16 v[136:139], a[164:167], a[68:71], v[136:139]
    ds_read_b64_tr_b16 a[178:179], v234 offset:18432
    v_mul_f32 v253, v239, v61
    v_mfma_f32_16x16x32_bf16 v[136:139], a[160:163], a[188:191], v[136:139]
    buffer_load_dwordx4 v242, s[48:51], s61 offen lds
    v_mul_f32 v61, v237, v61
    v_mfma_f32_16x16x32_bf16 v[140:143], a[160:163], a[192:195], v[140:143]
    ds_read_b64_tr_b16 a[180:181], v234 offset:24576
    v_fma_f32 v61, -v239, v29, -v61
    v_mfma_f32_16x16x32_bf16 v[140:143], a[164:167], a[72:75], v[140:143]
    buffer_load_dwordx4 v243, s[48:51], s61 offen offset:1024 lds
    v_fma_f32 v29, v237, v29, -v253
    v_mfma_f32_16x16x32_bf16 v[144:147], a[164:167], a[76:79], v[144:147]
    ds_read_b64_tr_b16 a[182:183], v234 offset:26624
    v_mul_f32 v253, v239, v62
    v_mfma_f32_16x16x32_bf16 v[144:147], a[160:163], a[196:199], v[144:147]
    v_mul_f32 v62, v237, v62
    s_waitcnt lgkmcnt(4)
    v_mfma_f32_16x16x32_bf16 v[160:163], a[168:171], a[196:199], v[160:163]
    ds_read_b64_tr_b16 a[160:161], v235 offset:16384
    v_fma_f32 v62, -v239, v30, -v62
    v_mfma_f32_16x16x32_bf16 v[160:163], a[172:175], a[76:79], v[160:163]
    v_fma_f32 v30, v237, v30, -v253
    v_mul_f32 v253, v239, v63
    v_mfma_f32_16x16x32_bf16 v[156:159], a[172:175], a[72:75], v[156:159]
    ds_read_b64_tr_b16 a[162:163], v235 offset:18432
    v_mul_f32 v63, v237, v63
    v_mfma_f32_16x16x32_bf16 v[156:159], a[168:171], a[192:195], v[156:159]
    v_fma_f32 v63, -v239, v31, -v63
    v_fma_f32 v31, v237, v31, -v253
    v_mfma_f32_16x16x32_bf16 v[152:155], a[168:171], a[188:191], v[152:155]
    ds_read_b64_tr_b16 a[164:165], v235 offset:24576
    v_mul_f32 v253, v239, v64
    v_mfma_f32_16x16x32_bf16 v[152:155], a[172:175], a[68:71], v[152:155]
    buffer_load_dwordx4 v244, s[48:51], s61 offen offset:2048 lds
    v_mul_f32 v64, v237, v64
    v_mfma_f32_16x16x32_bf16 v[148:151], a[172:175], a[64:67], v[148:151]
    ds_read_b64_tr_b16 a[166:167], v235 offset:26624
    v_fma_f32 v64, -v239, v32, -v64
    v_mfma_f32_16x16x32_bf16 v[148:151], a[168:171], a[184:187], v[148:151]
    v_fma_f32 v32, v237, v32, -v253
    s_waitcnt lgkmcnt(4)
    v_mfma_f32_16x16x32_bf16 v[164:167], a[176:179], a[184:187], v[164:167]
    ds_read_b64_tr_b16 a[168:169], v228 offset:32768
    v_mul_f32 v253, v239, v65
    v_mfma_f32_16x16x32_bf16 v[164:167], a[180:183], a[64:67], v[164:167]
    v_mul_f32 v65, v237, v65
    v_fma_f32 v65, -v239, v33, -v65
    v_mfma_f32_16x16x32_bf16 v[168:171], a[180:183], a[68:71], v[168:171]
    ds_read_b64_tr_b16 a[170:171], v228 offset:34816
    v_fma_f32 v33, v237, v33, -v253
    v_mfma_f32_16x16x32_bf16 v[168:171], a[176:179], a[188:191], v[168:171]
    buffer_load_dwordx4 v245, s[48:51], s61 offen offset:3072 lds
    v_mul_f32 v253, v239, v66
    v_mfma_f32_16x16x32_bf16 v[172:175], a[176:179], a[192:195], v[172:175]
    ds_read_b64_tr_b16 a[172:173], v228 offset:40960
    v_mul_f32 v66, v237, v66
    v_mfma_f32_16x16x32_bf16 v[172:175], a[180:183], a[72:75], v[172:175]
    s_add_u32 s61, s4, 983040
    s_add_u32 m0, s64, 98304
    v_fma_f32 v66, -v239, v34, -v66
    v_mfma_f32_16x16x32_bf16 v[176:179], a[180:183], a[76:79], v[176:179]
    ds_read_b64_tr_b16 a[174:175], v228 offset:43008
    v_fma_f32 v34, v237, v34, -v253
    v_mfma_f32_16x16x32_bf16 v[176:179], a[176:179], a[196:199], v[176:179]
    buffer_load_dwordx4 v242, s[48:51], s61 offen lds
    s_waitcnt lgkmcnt(4)
    v_mfma_f32_16x16x32_bf16 v[192:195], a[160:163], a[196:199], v[192:195]
    ds_read_b64_tr_b16 a[176:177], v229 offset:32768
    v_mul_f32 v253, v239, v67
    v_mfma_f32_16x16x32_bf16 v[192:195], a[164:167], a[76:79], v[192:195]
    v_mul_f32 v67, v237, v67
    v_fma_f32 v67, -v239, v35, -v67
    v_mfma_f32_16x16x32_bf16 v[188:191], a[164:167], a[72:75], v[188:191]
    ds_read_b64_tr_b16 a[178:179], v229 offset:34816
    v_fma_f32 v35, v237, v35, -v253
    v_mfma_f32_16x16x32_bf16 v[188:191], a[160:163], a[192:195], v[188:191]
    buffer_load_dwordx4 v243, s[48:51], s61 offen offset:1024 lds
    s_waitcnt vmcnt(11)
    v_mfma_f32_16x16x32_bf16 v[184:187], a[160:163], a[188:191], v[184:187]
    ds_read_b64_tr_b16 a[180:181], v229 offset:40960
    v_max3_u32 v240, v196, v197, v198
    v_mfma_f32_16x16x32_bf16 v[184:187], a[164:167], a[68:71], v[184:187]
    v_max3_u32 v240, v240, v199, v200
    v_max3_u32 v240, v240, v201, v202
    v_mfma_f32_16x16x32_bf16 v[180:183], a[164:167], a[64:67], v[180:183]
    ds_read_b64_tr_b16 a[182:183], v229 offset:43008
    v_max3_u32 v240, v240, v203, v204
    v_mfma_f32_16x16x32_bf16 v[180:183], a[160:163], a[184:187], v[180:183]
    v_max3_u32 v240, v240, v205, v206
    s_waitcnt vmcnt(27) lgkmcnt(4)
    v_mfma_f32_16x16x32_bf16 v[68:71], a[168:171], a[80:83], v[68:71]
    ds_read_b64_tr_b16 a[160:161], v230 offset:32768
    v_max3_u32 v240, v240, v207, v208
    v_mfma_f32_16x16x32_bf16 v[68:71], a[172:175], a[0:3], v[68:71]
    buffer_load_dword v252, v249, s[52:55], 0 offen sc0 sc1
    v_max3_u32 v240, v240, v209, v210
    v_mfma_f32_16x16x32_bf16 v[72:75], a[172:175], a[4:7], v[72:75]
    ds_read_b64_tr_b16 a[162:163], v230 offset:34816
    v_max3_u32 v240, v240, v211, v212
    v_mfma_f32_16x16x32_bf16 v[72:75], a[168:171], a[84:87], v[72:75]
    buffer_load_dwordx4 v244, s[48:51], s61 offen offset:2048 lds
    v_max3_u32 v240, v240, v213, v214
    v_mfma_f32_16x16x32_bf16 v[76:79], a[168:171], a[88:91], v[76:79]
    ds_read_b64_tr_b16 a[164:165], v230 offset:40960
    v_max3_u32 v240, v240, v215, v216
    v_mfma_f32_16x16x32_bf16 v[76:79], a[172:175], a[8:11], v[76:79]
    buffer_load_dwordx4 v245, s[48:51], s61 offen offset:3072 lds
    v_max3_u32 v240, v240, v217, v218
    v_mfma_f32_16x16x32_bf16 v[80:83], a[172:175], a[12:15], v[80:83]
    ds_read_b64_tr_b16 a[166:167], v230 offset:43008
    v_max3_u32 v240, v240, v219, v220
    v_mfma_f32_16x16x32_bf16 v[80:83], a[168:171], a[92:95], v[80:83]
    v_max3_u32 v240, v240, v221, v222
    s_waitcnt lgkmcnt(4)
    v_mfma_f32_16x16x32_bf16 v[96:99], a[176:179], a[92:95], v[96:99]
    ds_read_b64_tr_b16 a[168:169], v231 offset:32768
    v_max3_u32 v240, v240, v223, v224
    v_mfma_f32_16x16x32_bf16 v[96:99], a[180:183], a[12:15], v[96:99]
    v_max3_u32 v240, v240, v225, v226
    v_max_u32 v240, v240, v227
    v_mfma_f32_16x16x32_bf16 v[92:95], a[180:183], a[8:11], v[92:95]
    ds_read_b64_tr_b16 a[170:171], v231 offset:34816
    v_accvgpr_read_b32 v236, a240
    v_mfma_f32_16x16x32_bf16 v[92:95], a[176:179], a[88:91], v[92:95]
    buffer_load_dwordx4 a[144:147], v2, s[32:35], s60 offen sc1
    v_accvgpr_read_b32 v237, a241
    v_mfma_f32_16x16x32_bf16 v[88:91], a[176:179], a[84:87], v[88:91]
    ds_read_b64_tr_b16 a[172:173], v231 offset:40960
    v_accvgpr_read_b32 v238, a242
    v_mfma_f32_16x16x32_bf16 v[88:91], a[180:183], a[4:7], v[88:91]
    buffer_load_dwordx4 a[148:151], v2, s[32:35], s60 offen offset:1024 sc1
    v_accvgpr_read_b32 v239, a243
    v_mfma_f32_16x16x32_bf16 v[84:87], a[180:183], a[0:3], v[84:87]
    ds_read_b64_tr_b16 a[174:175], v231 offset:43008
    v_cmp_eq_u32 vcc, -1, v240
    s_cbranch_vccnz fa_c_slow
fa_c_ok:
    v_mfma_f32_16x16x32_bf16 v[84:87], a[176:179], a[80:83], v[84:87]
    v_fmac_f32 v200, v236, v196
    s_waitcnt lgkmcnt(4)
    v_mfma_f32_16x16x32_bf16 v[100:103], a[160:163], a[80:83], v[100:103]
    ds_read_b64_tr_b16 a[176:177], v232 offset:32768
    v_fmac_f32 v202, v236, v198
    v_mfma_f32_16x16x32_bf16 v[100:103], a[164:167], a[0:3], v[100:103]
    v_fma_f32 v200, -v238, v198, v200
    v_fmac_f32 v202, v238, v196
    v_mfma_f32_16x16x32_bf16 v[104:107], a[164:167], a[4:7], v[104:107]
    ds_read_b64_tr_b16 a[178:179], v232 offset:34816
    v_fmac_f32 v201, v237, v197
    v_mfma_f32_16x16x32_bf16 v[104:107], a[160:163], a[84:87], v[104:107]
    v_fmac_f32 v203, v237, v199
    v_fma_f32 v201, -v239, v199, v201
    v_mfma_f32_16x16x32_bf16 v[108:111], a[160:163], a[88:91], v[108:111]
    ds_read_b64_tr_b16 a[180:181], v232 offset:40960
    v_fmac_f32 v203, v239, v197
    v_mfma_f32_16x16x32_bf16 v[108:111], a[164:167], a[8:11], v[108:111]
    buffer_load_dwordx4 a[152:155], v2, s[32:35], s60 offen offset:2048 sc1
    v_fmac_f32 v204, v236, v200
    v_mfma_f32_16x16x32_bf16 v[112:115], a[164:167], a[12:15], v[112:115]
    ds_read_b64_tr_b16 a[182:183], v232 offset:43008
    v_fmac_f32 v206, v236, v202
    v_mfma_f32_16x16x32_bf16 v[112:115], a[160:163], a[92:95], v[112:115]
    v_fma_f32 v204, -v238, v202, v204
    s_waitcnt lgkmcnt(4)
    v_mfma_f32_16x16x32_bf16 v[128:131], a[168:171], a[92:95], v[128:131]
    ds_read_b64_tr_b16 a[160:161], v233 offset:32768
    v_fmac_f32 v206, v238, v200
    v_mfma_f32_16x16x32_bf16 v[128:131], a[172:175], a[12:15], v[128:131]
    v_fmac_f32 v205, v237, v201
    v_fmac_f32 v207, v237, v203
    v_mfma_f32_16x16x32_bf16 v[124:127], a[172:175], a[8:11], v[124:127]
    ds_read_b64_tr_b16 a[162:163], v233 offset:34816
    v_fma_f32 v205, -v239, v203, v205
    v_mfma_f32_16x16x32_bf16 v[124:127], a[168:171], a[88:91], v[124:127]
    buffer_load_dwordx4 a[156:159], v2, s[32:35], s60 offen offset:3072 sc1
    s_add_u32 s60, s60, 0x1000
    v_mfma_f32_16x16x32_bf16 v[120:123], a[168:171], a[84:87], v[120:123]
    ds_read_b64_tr_b16 a[164:165], v233 offset:40960
    v_fmac_f32 v207, v239, v201
    v_mfma_f32_16x16x32_bf16 v[120:123], a[172:175], a[4:7], v[120:123]
    buffer_load_dwordx4 a[96:99], v2, s[32:35], s60 offen sc1
    v_fmac_f32 v208, v236, v204
    v_mfma_f32_16x16x32_bf16 v[116:119], a[172:175], a[0:3], v[116:119]
    ds_read_b64_tr_b16 a[166:167], v233 offset:43008
    v_fmac_f32 v210, v236, v206
    v_mfma_f32_16x16x32_bf16 v[116:119], a[168:171], a[80:83], v[116:119]
    v_fma_f32 v208, -v238, v206, v208
    s_waitcnt lgkmcnt(4)
    v_mfma_f32_16x16x32_bf16 v[132:135], a[176:179], a[80:83], v[132:135]
    ds_read_b64_tr_b16 a[168:169], v234 offset:32768
    v_fmac_f32 v210, v238, v204
    v_mfma_f32_16x16x32_bf16 v[132:135], a[180:183], a[0:3], v[132:135]
    v_fmac_f32 v209, v237, v205
    v_fmac_f32 v211, v237, v207
    v_mfma_f32_16x16x32_bf16 v[136:139], a[180:183], a[4:7], v[136:139]
    ds_read_b64_tr_b16 a[170:171], v234 offset:34816
    v_fma_f32 v209, -v239, v207, v209
    v_mfma_f32_16x16x32_bf16 v[136:139], a[176:179], a[84:87], v[136:139]
    buffer_load_dwordx4 a[100:103], v2, s[32:35], s60 offen offset:1024 sc1
    v_fmac_f32 v211, v239, v205
    v_mfma_f32_16x16x32_bf16 v[140:143], a[176:179], a[88:91], v[140:143]
    ds_read_b64_tr_b16 a[172:173], v234 offset:40960
    v_fmac_f32 v212, v236, v208
    v_mfma_f32_16x16x32_bf16 v[140:143], a[180:183], a[8:11], v[140:143]
    v_fmac_f32 v214, v236, v210
    v_fma_f32 v212, -v238, v210, v212
    v_mfma_f32_16x16x32_bf16 v[144:147], a[180:183], a[12:15], v[144:147]
    ds_read_b64_tr_b16 a[174:175], v234 offset:43008
    v_fmac_f32 v214, v238, v208
    v_mfma_f32_16x16x32_bf16 v[144:147], a[176:179], a[92:95], v[144:147]
    v_fmac_f32 v213, v237, v209
    s_waitcnt lgkmcnt(4)
    v_mfma_f32_16x16x32_bf16 v[160:163], a[160:163], a[92:95], v[160:163]
    ds_read_b64_tr_b16 a[176:177], v235 offset:32768
    v_fmac_f32 v215, v237, v211
    v_mfma_f32_16x16x32_bf16 v[160:163], a[164:167], a[12:15], v[160:163]
    v_fma_f32 v213, -v239, v211, v213
    v_fmac_f32 v215, v239, v209
    v_mfma_f32_16x16x32_bf16 v[156:159], a[164:167], a[8:11], v[156:159]
    ds_read_b64_tr_b16 a[178:179], v235 offset:34816
    v_fmac_f32 v216, v236, v212
    v_mfma_f32_16x16x32_bf16 v[156:159], a[160:163], a[88:91], v[156:159]
    buffer_load_dwordx4 a[104:107], v2, s[32:35], s60 offen offset:2048 sc1
    v_fmac_f32 v218, v236, v214
    v_mfma_f32_16x16x32_bf16 v[152:155], a[160:163], a[84:87], v[152:155]
    ds_read_b64_tr_b16 a[180:181], v235 offset:40960
    v_fma_f32 v216, -v238, v214, v216
    v_mfma_f32_16x16x32_bf16 v[152:155], a[164:167], a[4:7], v[152:155]
    buffer_load_dwordx4 a[108:111], v2, s[32:35], s60 offen offset:3072 sc1
    v_fmac_f32 v218, v238, v212
    v_mfma_f32_16x16x32_bf16 v[148:151], a[164:167], a[0:3], v[148:151]
    ds_read_b64_tr_b16 a[182:183], v235 offset:43008
    v_fmac_f32 v217, v237, v213
    v_mfma_f32_16x16x32_bf16 v[148:151], a[160:163], a[80:83], v[148:151]
    s_add_u32 s60, s60, 0x1000
    v_fmac_f32 v219, v237, v215
    s_waitcnt lgkmcnt(4)
    v_mfma_f32_16x16x32_bf16 v[164:167], a[168:171], a[80:83], v[164:167]
    ds_read_b64_tr_b16 a[160:161], v228 offset:49152
    v_fma_f32 v217, -v239, v215, v217
    v_mfma_f32_16x16x32_bf16 v[164:167], a[172:175], a[0:3], v[164:167]
    s_add_u32 s21, s3, 4
    s_waitcnt vmcnt(10)
    v_subrev_u32 v252, s21, v252
    v_cmp_lt_u32 vcc, 11, v252
    s_cbranch_vccnz fa_f3_slow
fa_f3_ok:
    v_mfma_f32_16x16x32_bf16 v[168:171], a[172:175], a[4:7], v[168:171]
    ds_read_b64_tr_b16 a[162:163], v228 offset:51200
    v_fmac_f32 v219, v239, v213
    v_mfma_f32_16x16x32_bf16 v[168:171], a[168:171], a[84:87], v[168:171]
    buffer_load_dwordx4 a[112:115], v2, s[32:35], s60 offen sc1
    v_fmac_f32 v220, v236, v216
    v_mfma_f32_16x16x32_bf16 v[172:175], a[168:171], a[88:91], v[172:175]
    ds_read_b64_tr_b16 a[164:165], v228 offset:57344
    v_fmac_f32 v222, v236, v218
    v_mfma_f32_16x16x32_bf16 v[172:175], a[172:175], a[8:11], v[172:175]
    buffer_load_dwordx4 a[116:119], v2, s[32:35], s60 offen offset:1024 sc1
    v_fma_f32 v220, -v238, v218, v220
    v_mfma_f32_16x16x32_bf16 v[176:179], a[172:175], a[12:15], v[176:179]
    ds_read_b64_tr_b16 a[166:167], v228 offset:59392
    v_xor_b32 v228, 0x10000, v228
    v_mfma_f32_16x16x32_bf16 v[176:179], a[168:171], a[92:95], v[176:179]
    v_fmac_f32 v222, v238, v216
    s_waitcnt lgkmcnt(4)
    v_mfma_f32_16x16x32_bf16 v[192:195], a[176:179], a[92:95], v[192:195]
    ds_read_b64_tr_b16 a[168:169], v229 offset:49152
    v_fmac_f32 v221, v237, v217
    v_mfma_f32_16x16x32_bf16 v[192:195], a[180:183], a[12:15], v[192:195]
    v_fmac_f32 v223, v237, v219
    v_fma_f32 v221, -v239, v219, v221
    v_mfma_f32_16x16x32_bf16 v[188:191], a[180:183], a[8:11], v[188:191]
    ds_read_b64_tr_b16 a[170:171], v229 offset:51200
    v_fmac_f32 v223, v239, v217
    v_mfma_f32_16x16x32_bf16 v[188:191], a[176:179], a[88:91], v[188:191]
    buffer_load_dwordx4 a[120:123], v2, s[32:35], s60 offen offset:2048 sc1
    v_fmac_f32 v224, v236, v220
    v_mfma_f32_16x16x32_bf16 v[184:187], a[176:179], a[84:87], v[184:187]
    ds_read_b64_tr_b16 a[172:173], v229 offset:57344
    v_fmac_f32 v226, v236, v222
    v_mfma_f32_16x16x32_bf16 v[184:187], a[180:183], a[4:7], v[184:187]
    v_fma_f32 v224, -v238, v222, v224
    v_fmac_f32 v226, v238, v220
    v_mfma_f32_16x16x32_bf16 v[180:183], a[180:183], a[0:3], v[180:183]
    ds_read_b64_tr_b16 a[174:175], v229 offset:59392
    v_xor_b32 v229, 0x10000, v229
    v_mfma_f32_16x16x32_bf16 v[180:183], a[176:179], a[80:83], v[180:183]
    v_fmac_f32 v225, v237, v221
    s_waitcnt vmcnt(24) lgkmcnt(4)
    v_mfma_f32_16x16x32_bf16 v[68:71], a[160:163], a[16:19], v[68:71]
    ds_read_b64_tr_b16 a[176:177], v230 offset:49152
    v_fmac_f32 v227, v237, v223
    v_mfma_f32_16x16x32_bf16 v[68:71], a[164:167], a[128:131], v[68:71]
    v_fma_f32 v225, -v239, v223, v225
    v_fmac_f32 v227, v239, v221
    v_mfma_f32_16x16x32_bf16 v[72:75], a[164:167], a[132:135], v[72:75]
    ds_read_b64_tr_b16 a[178:179], v230 offset:51200
    v_mfma_f32_16x16x32_bf16 v[72:75], a[160:163], a[20:23], v[72:75]
    buffer_load_dwordx4 a[124:127], v2, s[32:35], s60 offen offset:3072 sc1
    s_add_u32 s60, s60, 0x1000
    v_mfma_f32_16x16x32_bf16 v[76:79], a[160:163], a[24:27], v[76:79]
    ds_read_b64_tr_b16 a[180:181], v230 offset:57344
    v_mfma_f32_16x16x32_bf16 v[76:79], a[164:167], a[136:139], v[76:79]
    ds_write_b128 v247, v[224:227] offset:1024
    v_mfma_f32_16x16x32_bf16 v[80:83], a[164:167], a[140:143], v[80:83]
    ds_read_b64_tr_b16 a[182:183], v230 offset:59392
    v_xor_b32 v230, 0x10000, v230
    v_mfma_f32_16x16x32_bf16 v[80:83], a[160:163], a[28:31], v[80:83]
    buffer_load_dwordx4 a[32:35], v2, s[32:35], s60 offen sc1
    s_waitcnt lgkmcnt(5)
    v_mfma_f32_16x16x32_bf16 v[96:99], a[168:171], a[28:31], v[96:99]
    ds_read_b64_tr_b16 a[160:161], v231 offset:49152
    v_accvgpr_read_b32 v236, a244
    v_mfma_f32_16x16x32_bf16 v[96:99], a[172:175], a[140:143], v[96:99]
    v_accvgpr_read_b32 v237, a245
    v_accvgpr_read_b32 v238, a246
    v_mfma_f32_16x16x32_bf16 v[92:95], a[172:175], a[136:139], v[92:95]
    ds_read_b64_tr_b16 a[162:163], v231 offset:51200
    v_accvgpr_read_b32 v239, a247
    v_mfma_f32_16x16x32_bf16 v[92:95], a[168:171], a[24:27], v[92:95]
    buffer_load_dwordx4 a[36:39], v2, s[32:35], s60 offen offset:1024 sc1
    ds_read_b128 v[196:199], v248 offset:1024
    v_mfma_f32_16x16x32_bf16 v[88:91], a[168:171], a[20:23], v[88:91]
    ds_read_b64_tr_b16 a[164:165], v231 offset:57344
    ds_read_b128 v[200:203], v248 offset:1280
    v_mfma_f32_16x16x32_bf16 v[88:91], a[172:175], a[132:135], v[88:91]
    buffer_load_dwordx4 a[40:43], v2, s[32:35], s60 offen offset:2048 sc1
    ds_read_b128 v[204:207], v248 offset:1536
    v_mfma_f32_16x16x32_bf16 v[84:87], a[172:175], a[128:131], v[84:87]
    ds_read_b64_tr_b16 a[166:167], v231 offset:59392
    v_xor_b32 v231, 0x10000, v231
    v_mfma_f32_16x16x32_bf16 v[84:87], a[168:171], a[16:19], v[84:87]
    ds_read_b128 v[208:211], v248 offset:1792
    s_waitcnt lgkmcnt(8)
    v_mfma_f32_16x16x32_bf16 v[100:103], a[176:179], a[16:19], v[100:103]
    ds_read_b64_tr_b16 a[168:169], v232 offset:49152
    ds_read_b128 v[212:215], v248 offset:0
    v_mfma_f32_16x16x32_bf16 v[100:103], a[180:183], a[128:131], v[100:103]
    ds_read_b128 v[216:219], v248 offset:256
    ds_read_b128 v[220:223], v248 offset:512
    v_mfma_f32_16x16x32_bf16 v[104:107], a[180:183], a[132:135], v[104:107]
    ds_read_b64_tr_b16 a[170:171], v232 offset:51200
    v_accvgpr_read_b32 v224, a236
    v_mfma_f32_16x16x32_bf16 v[104:107], a[176:179], a[20:23], v[104:107]
    v_accvgpr_read_b32 v225, a237
    v_accvgpr_read_b32 v226, a238
    v_mfma_f32_16x16x32_bf16 v[108:111], a[176:179], a[24:27], v[108:111]
    ds_read_b64_tr_b16 a[172:173], v232 offset:57344
    v_accvgpr_read_b32 v227, a239
    v_mfma_f32_16x16x32_bf16 v[108:111], a[180:183], a[136:139], v[108:111]
    buffer_load_dwordx4 a[44:47], v2, s[32:35], s60 offen offset:3072 sc1
    v_and_b32 v253, 15, v1
    v_mfma_f32_16x16x32_bf16 v[112:115], a[180:183], a[140:143], v[112:115]
    ds_read_b64_tr_b16 a[174:175], v232 offset:59392
    v_xor_b32 v232, 0x10000, v232
    v_mfma_f32_16x16x32_bf16 v[112:115], a[176:179], a[28:31], v[112:115]
    s_add_u32 s60, s60, 0x1000
    v_lshrrev_b32 v241, 2, v1
    s_waitcnt lgkmcnt(8)
    v_mfma_f32_16x16x32_bf16 v[128:131], a[160:163], a[28:31], v[128:131]
    ds_read_b64_tr_b16 a[176:177], v233 offset:49152
    v_and_b32 v254, 3, v241
    v_mfma_f32_16x16x32_bf16 v[128:131], a[164:167], a[140:143], v[128:131]
    v_and_b32 v241, 4, v241
    v_xor_b32 v253, v253, v241
    v_mfma_f32_16x16x32_bf16 v[124:127], a[164:167], a[136:139], v[124:127]
    ds_read_b64_tr_b16 a[178:179], v233 offset:51200
    v_lshl_add_u32 v254, v241, 1, v254
    v_mfma_f32_16x16x32_bf16 v[124:127], a[160:163], a[24:27], v[124:127]
    buffer_load_dwordx4 a[48:51], v2, s[32:35], s60 offen sc1
    v_lshrrev_b32 v241, 5, v1
    v_mfma_f32_16x16x32_bf16 v[120:123], a[160:163], a[20:23], v[120:123]
    ds_read_b64_tr_b16 a[180:181], v233 offset:57344
    v_lshl_add_u32 v253, v241, 4, v253
    v_mfma_f32_16x16x32_bf16 v[120:123], a[164:167], a[132:135], v[120:123]
    buffer_load_dwordx4 a[52:55], v2, s[32:35], s60 offen offset:1024 sc1
    v_lshl_add_u32 v254, v241, 6, v254
    v_mfma_f32_16x16x32_bf16 v[116:119], a[164:167], a[128:131], v[116:119]
    ds_read_b64_tr_b16 a[182:183], v233 offset:59392
    v_xor_b32 v233, 0x10000, v233
    v_mfma_f32_16x16x32_bf16 v[116:119], a[160:163], a[16:19], v[116:119]
    v_and_b32 v241, 4, v1
    s_waitcnt lgkmcnt(4)
    v_mfma_f32_16x16x32_bf16 v[132:135], a[168:171], a[16:19], v[132:135]
    ds_read_b64_tr_b16 a[160:161], v234 offset:49152
    v_lshl_add_u32 v253, v241, 3, v253
    v_mfma_f32_16x16x32_bf16 v[132:135], a[172:175], a[128:131], v[132:135]
    v_lshl_add_u32 v253, v253, 3, s63
    v_and_b32 v241, 1, v1
    v_mfma_f32_16x16x32_bf16 v[136:139], a[172:175], a[132:135], v[136:139]
    ds_read_b64_tr_b16 a[162:163], v234 offset:51200
    v_lshl_add_u32 v254, v241, 2, v254
    v_mfma_f32_16x16x32_bf16 v[136:139], a[168:171], a[20:23], v[136:139]
    buffer_load_dwordx4 a[56:59], v2, s[32:35], s60 offen offset:2048 sc1
    v_and_b32 v241, 2, v1
    v_mfma_f32_16x16x32_bf16 v[140:143], a[168:171], a[24:27], v[140:143]
    ds_read_b64_tr_b16 a[164:165], v234 offset:57344
    v_lshl_add_u32 v254, v241, 3, v254
    v_mfma_f32_16x16x32_bf16 v[140:143], a[172:175], a[136:139], v[140:143]
    v_lshl_add_u32 v254, v254, 3, s63
    v_xor_b32 v255, 288, v254
    v_mfma_f32_16x16x32_bf16 v[144:147], a[172:175], a[140:143], v[144:147]
    ds_read_b64_tr_b16 a[166:167], v234 offset:59392
    v_xor_b32 v234, 0x10000, v234
    v_mfma_f32_16x16x32_bf16 v[144:147], a[168:171], a[28:31], v[144:147]
    s_waitcnt lgkmcnt(11)
    s_waitcnt lgkmcnt(4)
    v_mfma_f32_16x16x32_bf16 v[160:163], a[176:179], a[28:31], v[160:163]
    ds_read_b64_tr_b16 a[168:169], v235 offset:49152
    v_fmac_f32 v200, v236, v196
    v_mfma_f32_16x16x32_bf16 v[160:163], a[180:183], a[140:143], v[160:163]
    v_fmac_f32 v202, v236, v198
    v_fma_f32 v200, -v238, v198, v200
    v_mfma_f32_16x16x32_bf16 v[156:159], a[180:183], a[136:139], v[156:159]
    ds_read_b64_tr_b16 a[170:171], v235 offset:51200
    v_fmac_f32 v202, v238, v196
    v_mfma_f32_16x16x32_bf16 v[156:159], a[176:179], a[24:27], v[156:159]
    buffer_load_dwordx4 a[60:63], v2, s[32:35], s60 offen offset:3072 sc1
    s_add_u32 s60, s60, 0x1000
    v_mfma_f32_16x16x32_bf16 v[152:155], a[176:179], a[20:23], v[152:155]
    ds_read_b64_tr_b16 a[172:173], v235 offset:57344
    v_fmac_f32 v201, v237, v197
    v_mfma_f32_16x16x32_bf16 v[152:155], a[180:183], a[132:135], v[152:155]
    buffer_load_dwordx4 a[184:187], v2, s[32:35], s60 offen sc1
    v_fmac_f32 v203, v237, v199
    v_mfma_f32_16x16x32_bf16 v[148:151], a[180:183], a[128:131], v[148:151]
    ds_read_b64_tr_b16 a[174:175], v235 offset:59392
    v_xor_b32 v235, 0x10000, v235
    v_mfma_f32_16x16x32_bf16 v[148:151], a[176:179], a[16:19], v[148:151]
    v_fma_f32 v201, -v239, v199, v201
    s_waitcnt vmcnt(21) lgkmcnt(4)
    s_barrier
    v_mfma_f32_16x16x32_bf16 v[164:167], a[160:163], a[16:19], v[164:167]
    ds_read_b64_tr_b16 a[176:177], v228 offset:0
    v_fmac_f32 v203, v239, v197
    v_mfma_f32_16x16x32_bf16 v[164:167], a[164:167], a[128:131], v[164:167]
    v_fmac_f32 v204, v236, v200
    v_fmac_f32 v206, v236, v202
    v_mfma_f32_16x16x32_bf16 v[168:171], a[164:167], a[132:135], v[168:171]
    ds_read_b64_tr_b16 a[178:179], v228 offset:2048
    v_fma_f32 v204, -v238, v202, v204
    v_mfma_f32_16x16x32_bf16 v[168:171], a[160:163], a[20:23], v[168:171]
    buffer_load_dwordx4 a[188:191], v2, s[32:35], s60 offen offset:1024 sc1
    v_fmac_f32 v206, v238, v200
    v_mfma_f32_16x16x32_bf16 v[172:175], a[160:163], a[24:27], v[172:175]
    ds_read_b64_tr_b16 a[180:181], v228 offset:8192
    v_fmac_f32 v205, v237, v201
    v_mfma_f32_16x16x32_bf16 v[172:175], a[164:167], a[136:139], v[172:175]
    buffer_load_dwordx4 a[192:195], v2, s[32:35], s60 offen offset:2048 sc1
    v_fmac_f32 v207, v237, v203
    v_mfma_f32_16x16x32_bf16 v[176:179], a[164:167], a[140:143], v[176:179]
    ds_read_b64_tr_b16 a[182:183], v228 offset:10240
    v_fma_f32 v205, -v239, v203, v205
    v_mfma_f32_16x16x32_bf16 v[176:179], a[160:163], a[28:31], v[176:179]
    v_fmac_f32 v207, v239, v201
    s_waitcnt lgkmcnt(4)
    v_mfma_f32_16x16x32_bf16 v[192:195], a[168:171], a[28:31], v[192:195]
    ds_read_b64_tr_b16 a[160:161], v229 offset:0
    v_fmac_f32 v208, v236, v204
    v_mfma_f32_16x16x32_bf16 v[192:195], a[172:175], a[140:143], v[192:195]
    v_fmac_f32 v210, v236, v206
    v_fma_f32 v208, -v238, v206, v208
    v_mfma_f32_16x16x32_bf16 v[188:191], a[172:175], a[136:139], v[188:191]
    ds_read_b64_tr_b16 a[162:163], v229 offset:2048
    v_fmac_f32 v210, v238, v204
    v_mfma_f32_16x16x32_bf16 v[188:191], a[168:171], a[24:27], v[188:191]
    buffer_load_dwordx4 a[196:199], v2, s[32:35], s60 offen offset:3072 sc1
    s_add_u32 s60, s60, 0x1000
    v_mfma_f32_16x16x32_bf16 v[184:187], a[168:171], a[20:23], v[184:187]
    ds_read_b64_tr_b16 a[164:165], v229 offset:8192
    v_fmac_f32 v209, v237, v205
    v_mfma_f32_16x16x32_bf16 v[184:187], a[172:175], a[132:135], v[184:187]
    v_fmac_f32 v211, v237, v207
    v_fma_f32 v209, -v239, v207, v209
    v_mfma_f32_16x16x32_bf16 v[180:183], a[172:175], a[128:131], v[180:183]
    ds_read_b64_tr_b16 a[166:167], v229 offset:10240
    v_fmac_f32 v211, v239, v205
    v_mfma_f32_16x16x32_bf16 v[180:183], a[168:171], a[16:19], v[180:183]
    v_fmac_f32 v212, v224, v208
    s_waitcnt vmcnt(16) lgkmcnt(4)
    v_mfma_f32_16x16x32_bf16 v[68:71], a[176:179], a[144:147], v[68:71]
    ds_read_b64_tr_b16 a[168:169], v230 offset:0
    v_fmac_f32 v214, v224, v210
    v_mfma_f32_16x16x32_bf16 v[68:71], a[180:183], a[96:99], v[68:71]
    s_add_u32 s61, s4, 1441792
    s_add_u32 m0, s64, 114688
    v_fma_f32 v212, -v226, v210, v212
    v_mfma_f32_16x16x32_bf16 v[72:75], a[180:183], a[100:103], v[72:75]
    ds_read_b64_tr_b16 a[170:171], v230 offset:2048
    v_fmac_f32 v214, v226, v208
    v_mfma_f32_16x16x32_bf16 v[72:75], a[176:179], a[148:151], v[72:75]
    buffer_load_dwordx4 v242, s[48:51], s61 offen lds
    v_fmac_f32 v213, v225, v209
    v_mfma_f32_16x16x32_bf16 v[76:79], a[176:179], a[152:155], v[76:79]
    ds_read_b64_tr_b16 a[172:173], v230 offset:8192
    v_fmac_f32 v215, v225, v211
    v_mfma_f32_16x16x32_bf16 v[76:79], a[180:183], a[104:107], v[76:79]
    buffer_load_dwordx4 v243, s[48:51], s61 offen offset:1024 lds
    v_fma_f32 v213, -v227, v211, v213
    v_mfma_f32_16x16x32_bf16 v[80:83], a[180:183], a[108:111], v[80:83]
    ds_read_b64_tr_b16 a[174:175], v230 offset:10240
    v_fmac_f32 v215, v227, v209
    v_mfma_f32_16x16x32_bf16 v[80:83], a[176:179], a[156:159], v[80:83]
    v_fmac_f32 v216, v224, v212
    s_waitcnt lgkmcnt(4)
    v_mfma_f32_16x16x32_bf16 v[96:99], a[160:163], a[156:159], v[96:99]
    ds_read_b64_tr_b16 a[176:177], v231 offset:0
    v_fmac_f32 v218, v224, v214
    v_mfma_f32_16x16x32_bf16 v[96:99], a[164:167], a[108:111], v[96:99]
    v_fma_f32 v216, -v226, v214, v216
    v_fmac_f32 v218, v226, v212
    v_mfma_f32_16x16x32_bf16 v[92:95], a[164:167], a[104:107], v[92:95]
    ds_read_b64_tr_b16 a[178:179], v231 offset:2048
    v_fmac_f32 v217, v225, v213
    v_mfma_f32_16x16x32_bf16 v[92:95], a[160:163], a[152:155], v[92:95]
    buffer_load_dwordx4 v244, s[48:51], s61 offen offset:2048 lds
    v_fmac_f32 v219, v225, v215
    v_mfma_f32_16x16x32_bf16 v[88:91], a[160:163], a[148:151], v[88:91]
    ds_read_b64_tr_b16 a[180:181], v231 offset:8192
    v_fma_f32 v217, -v227, v215, v217
    v_mfma_f32_16x16x32_bf16 v[88:91], a[164:167], a[100:103], v[88:91]
    buffer_load_dwordx4 v245, s[48:51], s61 offen offset:3072 lds
    v_fmac_f32 v219, v227, v213
    v_mfma_f32_16x16x32_bf16 v[84:87], a[164:167], a[96:99], v[84:87]
    ds_read_b64_tr_b16 a[182:183], v231 offset:10240
    v_fmac_f32 v220, v224, v216
    v_mfma_f32_16x16x32_bf16 v[84:87], a[160:163], a[144:147], v[84:87]
    v_fmac_f32 v222, v224, v218
    s_waitcnt lgkmcnt(4)
    v_mfma_f32_16x16x32_bf16 v[100:103], a[168:171], a[144:147], v[100:103]
    ds_read_b64_tr_b16 a[160:161], v232 offset:0
    v_fma_f32 v220, -v226, v218, v220
    v_mfma_f32_16x16x32_bf16 v[100:103], a[172:175], a[96:99], v[100:103]
    v_fmac_f32 v222, v226, v216
    v_fmac_f32 v221, v225, v217
    v_mfma_f32_16x16x32_bf16 v[104:107], a[172:175], a[100:103], v[104:107]
    ds_read_b64_tr_b16 a[162:163], v232 offset:2048
    v_fmac_f32 v223, v225, v219
    v_mfma_f32_16x16x32_bf16 v[104:107], a[168:171], a[148:151], v[104:107]
    v_fma_f32 v221, -v227, v219, v221
    v_fmac_f32 v223, v227, v217
    v_mfma_f32_16x16x32_bf16 v[108:111], a[168:171], a[152:155], v[108:111]
    ds_read_b64_tr_b16 a[164:165], v232 offset:8192
    v_cmp_le_u32 s[72:73], 16, v1
    v_mfma_f32_16x16x32_bf16 v[108:111], a[172:175], a[104:107], v[108:111]
    s_add_u32 s61, s4, 131072
    s_add_u32 m0, s64, 0
    v_accvgpr_read_b32 v236, a232
    v_mfma_f32_16x16x32_bf16 v[112:115], a[172:175], a[108:111], v[112:115]
    ds_read_b64_tr_b16 a[166:167], v232 offset:10240
    v_accvgpr_read_b32 v237, a233
    v_mfma_f32_16x16x32_bf16 v[112:115], a[168:171], a[156:159], v[112:115]
    buffer_load_dwordx4 v242, s[48:51], s61 offen lds
    s_waitcnt lgkmcnt(4)
    v_mfma_f32_16x16x32_bf16 v[128:131], a[176:179], a[156:159], v[128:131]
    ds_read_b64_tr_b16 a[168:169], v233 offset:0
    v_accvgpr_read_b32 v238, a234
    v_mfma_f32_16x16x32_bf16 v[128:131], a[180:183], a[108:111], v[128:131]
    v_accvgpr_read_b32 v239, a235
    v_cndmask_b32 v208, v208, v212, s[72:73]
    v_mfma_f32_16x16x32_bf16 v[124:127], a[180:183], a[104:107], v[124:127]
    ds_read_b64_tr_b16 a[170:171], v233 offset:2048
    v_cndmask_b32 v209, v209, v213, s[72:73]
    v_mfma_f32_16x16x32_bf16 v[124:127], a[176:179], a[152:155], v[124:127]
    buffer_load_dwordx4 v243, s[48:51], s61 offen offset:1024 lds
    v_cndmask_b32 v210, v210, v214, s[72:73]
    v_mfma_f32_16x16x32_bf16 v[120:123], a[176:179], a[148:151], v[120:123]
    ds_read_b64_tr_b16 a[172:173], v233 offset:8192
    v_cndmask_b32 v211, v211, v215, s[72:73]
    v_mfma_f32_16x16x32_bf16 v[120:123], a[180:183], a[100:103], v[120:123]
    buffer_load_dwordx4 v244, s[48:51], s61 offen offset:2048 lds
    v_cmp_le_u32 s[72:73], 32, v1
    v_mfma_f32_16x16x32_bf16 v[116:119], a[180:183], a[96:99], v[116:119]
    ds_read_b64_tr_b16 a[174:175], v233 offset:10240
    v_accvgpr_read_b32 v196, a248
    v_mfma_f32_16x16x32_bf16 v[116:119], a[176:179], a[144:147], v[116:119]
    v_accvgpr_read_b32 v197, a249
    s_waitcnt lgkmcnt(4)
    v_mfma_f32_16x16x32_bf16 v[132:135], a[160:163], a[144:147], v[132:135]
    ds_read_b64_tr_b16 a[176:177], v234 offset:0
    v_accvgpr_read_b32 v198, a250
    v_mfma_f32_16x16x32_bf16 v[132:135], a[164:167], a[96:99], v[132:135]
    v_accvgpr_read_b32 v199, a251
    v_cndmask_b32 v208, v208, v216, s[72:73]
    v_mfma_f32_16x16x32_bf16 v[136:139], a[164:167], a[100:103], v[136:139]
    ds_read_b64_tr_b16 a[178:179], v234 offset:2048
    v_cndmask_b32 v209, v209, v217, s[72:73]
    v_mfma_f32_16x16x32_bf16 v[136:139], a[160:163], a[148:151], v[136:139]
    buffer_load_dwordx4 v245, s[48:51], s61 offen offset:3072 lds
    v_cndmask_b32 v210, v210, v218, s[72:73]
    v_mfma_f32_16x16x32_bf16 v[140:143], a[160:163], a[152:155], v[140:143]
    ds_read_b64_tr_b16 a[180:181], v234 offset:8192
    v_cndmask_b32 v211, v211, v219, s[72:73]
    v_mfma_f32_16x16x32_bf16 v[140:143], a[164:167], a[104:107], v[140:143]
    v_cmp_le_u32 s[72:73], 48, v1
    v_accvgpr_read_b32 v200, a224
    v_mfma_f32_16x16x32_bf16 v[144:147], a[164:167], a[108:111], v[144:147]
    ds_read_b64_tr_b16 a[182:183], v234 offset:10240
    v_accvgpr_read_b32 v201, a225
    v_mfma_f32_16x16x32_bf16 v[144:147], a[160:163], a[156:159], v[144:147]
    v_accvgpr_read_b32 v202, a226
    s_waitcnt lgkmcnt(4)
    v_mfma_f32_16x16x32_bf16 v[160:163], a[168:171], a[156:159], v[160:163]
    ds_read_b64_tr_b16 a[160:161], v235 offset:0
    v_accvgpr_read_b32 v203, a227
    v_mfma_f32_16x16x32_bf16 v[160:163], a[172:175], a[108:111], v[160:163]
    s_add_u32 s61, s4, 589824
    s_add_u32 m0, s64, 16384
    v_cndmask_b32 v208, v208, v220, s[72:73]
    v_mfma_f32_16x16x32_bf16 v[156:159], a[172:175], a[104:107], v[156:159]
    ds_read_b64_tr_b16 a[162:163], v235 offset:2048
    v_cndmask_b32 v209, v209, v221, s[72:73]
    v_mfma_f32_16x16x32_bf16 v[156:159], a[168:171], a[152:155], v[156:159]
    buffer_load_dwordx4 v242, s[48:51], s61 offen lds
    v_cndmask_b32 v210, v210, v222, s[72:73]
    v_mfma_f32_16x16x32_bf16 v[152:155], a[168:171], a[148:151], v[152:155]
    ds_read_b64_tr_b16 a[164:165], v235 offset:8192
    v_cndmask_b32 v211, v211, v223, s[72:73]
    v_mfma_f32_16x16x32_bf16 v[152:155], a[172:175], a[100:103], v[152:155]
    buffer_load_dwordx4 v243, s[48:51], s61 offen offset:1024 lds
    v_fmac_f32 v196, v236, v208
    v_mfma_f32_16x16x32_bf16 v[148:151], a[172:175], a[96:99], v[148:151]
    ds_read_b64_tr_b16 a[166:167], v235 offset:10240
    v_fmac_f32 v198, v236, v210
    v_mfma_f32_16x16x32_bf16 v[148:151], a[168:171], a[144:147], v[148:151]
    v_fma_f32 v196, -v238, v210, v196
    s_waitcnt lgkmcnt(4)
    v_mfma_f32_16x16x32_bf16 v[164:167], a[176:179], a[144:147], v[164:167]
    ds_read_b64_tr_b16 a[168:169], v228 offset:16384
    v_fmac_f32 v198, v238, v208
    v_mfma_f32_16x16x32_bf16 v[164:167], a[180:183], a[96:99], v[164:167]
    v_fmac_f32 v197, v237, v209
    v_fmac_f32 v199, v237, v211
    v_mfma_f32_16x16x32_bf16 v[168:171], a[180:183], a[100:103], v[168:171]
    ds_read_b64_tr_b16 a[170:171], v228 offset:18432
    v_fma_f32 v197, -v239, v211, v197
    v_mfma_f32_16x16x32_bf16 v[168:171], a[176:179], a[148:151], v[168:171]
    buffer_load_dwordx4 v244, s[48:51], s61 offen offset:2048 lds
    v_fmac_f32 v199, v239, v209
    v_mfma_f32_16x16x32_bf16 v[172:175], a[176:179], a[152:155], v[172:175]
    ds_read_b64_tr_b16 a[172:173], v228 offset:24576
    v_accvgpr_read_b32 v236, a228
    v_mfma_f32_16x16x32_bf16 v[172:175], a[180:183], a[104:107], v[172:175]
    buffer_load_dwordx4 v245, s[48:51], s61 offen offset:3072 lds
    v_accvgpr_read_b32 v237, a229
    v_mfma_f32_16x16x32_bf16 v[176:179], a[180:183], a[108:111], v[176:179]
    ds_read_b64_tr_b16 a[174:175], v228 offset:26624
    v_accvgpr_read_b32 v238, a230
    v_mfma_f32_16x16x32_bf16 v[176:179], a[176:179], a[156:159], v[176:179]
    v_accvgpr_read_b32 v239, a231
    s_waitcnt lgkmcnt(4)
    v_mfma_f32_16x16x32_bf16 v[192:195], a[160:163], a[156:159], v[192:195]
    ds_read_b64_tr_b16 a[176:177], v229 offset:16384
    v_mul_f32 v241, v238, v210
    v_mfma_f32_16x16x32_bf16 v[192:195], a[164:167], a[108:111], v[192:195]
    v_mul_f32 v210, v236, v210
    v_fma_f32 v210, -v238, v208, -v210
    v_mfma_f32_16x16x32_bf16 v[188:191], a[164:167], a[104:107], v[188:191]
    ds_read_b64_tr_b16 a[178:179], v229 offset:18432
    v_fma_f32 v208, v236, v208, -v241
    v_mfma_f32_16x16x32_bf16 v[188:191], a[160:163], a[152:155], v[188:191]
    buffer_load_dwordx4 a[64:67], v2, s[32:35], s60 offen sc1
    v_mul_f32 v241, v239, v211
    v_mfma_f32_16x16x32_bf16 v[184:187], a[160:163], a[148:151], v[184:187]
    ds_read_b64_tr_b16 a[180:181], v229 offset:24576
    v_mul_f32 v211, v237, v211
    v_mfma_f32_16x16x32_bf16 v[184:187], a[164:167], a[100:103], v[184:187]
    v_fma_f32 v211, -v239, v209, -v211
    v_fma_f32 v209, v237, v209, -v241
    v_mfma_f32_16x16x32_bf16 v[180:183], a[164:167], a[96:99], v[180:183]
    ds_read_b64_tr_b16 a[182:183], v229 offset:26624
    v_mul_f32 v241, v238, v198
    v_mfma_f32_16x16x32_bf16 v[180:183], a[160:163], a[144:147], v[180:183]
    v_mul_f32 v198, v236, v198
    s_waitcnt vmcnt(21) lgkmcnt(4)
    v_mfma_f32_16x16x32_bf16 v[68:71], a[168:171], a[112:115], v[68:71]
    ds_read_b64_tr_b16 a[160:161], v230 offset:16384
    v_fma_f32 v198, -v238, v196, -v198
    v_mfma_f32_16x16x32_bf16 v[68:71], a[172:175], a[32:35], v[68:71]
    v_fma_f32 v196, v236, v196, -v241
    v_mul_f32 v241, v239, v199
    v_mfma_f32_16x16x32_bf16 v[72:75], a[172:175], a[36:39], v[72:75]
    ds_read_b64_tr_b16 a[162:163], v230 offset:18432
    v_mul_f32 v199, v237, v199
    v_mfma_f32_16x16x32_bf16 v[72:75], a[168:171], a[116:119], v[72:75]
    buffer_load_dwordx4 a[68:71], v2, s[32:35], s60 offen offset:1024 sc1
    v_fma_f32 v199, -v239, v197, -v199
    v_mfma_f32_16x16x32_bf16 v[76:79], a[168:171], a[120:123], v[76:79]
    ds_read_b64_tr_b16 a[164:165], v230 offset:24576
    v_fma_f32 v197, v237, v197, -v241
    v_mfma_f32_16x16x32_bf16 v[76:79], a[172:175], a[40:43], v[76:79]
    buffer_load_dwordx4 a[72:75], v2, s[32:35], s60 offen offset:2048 sc1
    v_xor_b32 v202, 0x80000000, v202
    v_mfma_f32_16x16x32_bf16 v[80:83], a[172:175], a[44:47], v[80:83]
    ds_read_b64_tr_b16 a[166:167], v230 offset:26624
    v_xor_b32 v203, 0x80000000, v203
    v_mfma_f32_16x16x32_bf16 v[80:83], a[168:171], a[124:127], v[80:83]
    v_fmac_f32 v4, v200, v208
    s_waitcnt lgkmcnt(4)
    v_mfma_f32_16x16x32_bf16 v[96:99], a[176:179], a[124:127], v[96:99]
    ds_read_b64_tr_b16 a[168:169], v231 offset:16384
    v_fmac_f32 v36, v200, v210
    v_mfma_f32_16x16x32_bf16 v[96:99], a[180:183], a[44:47], v[96:99]
    v_fma_f32 v4, -v202, v210, v4
    v_fmac_f32 v36, v202, v208
    v_mfma_f32_16x16x32_bf16 v[92:95], a[180:183], a[40:43], v[92:95]
    ds_read_b64_tr_b16 a[170:171], v231 offset:18432
    v_fmac_f32 v5, v200, v196
    v_mfma_f32_16x16x32_bf16 v[92:95], a[176:179], a[120:123], v[92:95]
    buffer_load_dwordx4 a[76:79], v2, s[32:35], s60 offen offset:3072 sc1
    s_add_u32 s60, s60, 0x1000
    v_mfma_f32_16x16x32_bf16 v[88:91], a[176:179], a[116:119], v[88:91]
    ds_read_b64_tr_b16 a[172:173], v231 offset:24576
    v_fmac_f32 v37, v200, v198
    v_mfma_f32_16x16x32_bf16 v[88:91], a[180:183], a[36:39], v[88:91]
    buffer_load_dwordx4 a[80:83], v2, s[32:35], s60 offen sc1
    v_fma_f32 v5, -v202, v198, v5
    v_mfma_f32_16x16x32_bf16 v[84:87], a[180:183], a[32:35], v[84:87]
    ds_read_b64_tr_b16 a[174:175], v231 offset:26624
    v_fmac_f32 v37, v202, v196
    v_mfma_f32_16x16x32_bf16 v[84:87], a[176:179], a[112:115], v[84:87]
    v_fmac_f32 v20, v201, v209
    s_waitcnt lgkmcnt(4)
    v_mfma_f32_16x16x32_bf16 v[100:103], a[160:163], a[112:115], v[100:103]
    ds_read_b64_tr_b16 a[176:177], v232 offset:16384
    v_fmac_f32 v52, v201, v211
    v_mfma_f32_16x16x32_bf16 v[100:103], a[164:167], a[32:35], v[100:103]
    v_fma_f32 v20, -v203, v211, v20
    v_fmac_f32 v52, v203, v209
    v_mfma_f32_16x16x32_bf16 v[104:107], a[164:167], a[36:39], v[104:107]
    ds_read_b64_tr_b16 a[178:179], v232 offset:18432
    v_fmac_f32 v21, v201, v197
    v_mfma_f32_16x16x32_bf16 v[104:107], a[160:163], a[116:119], v[104:107]
    v_fmac_f32 v53, v201, v199
    v_fma_f32 v21, -v203, v199, v21
    v_mfma_f32_16x16x32_bf16 v[108:111], a[160:163], a[120:123], v[108:111]
    ds_read_b64_tr_b16 a[180:181], v232 offset:24576
    v_fmac_f32 v53, v203, v197
    v_mfma_f32_16x16x32_bf16 v[108:111], a[164:167], a[40:43], v[108:111]
    buffer_load_dwordx4 a[84:87], v2, s[32:35], s60 offen offset:1024 sc1
    v_fmac_f32 v6, v200, v4
    v_mfma_f32_16x16x32_bf16 v[112:115], a[164:167], a[44:47], v[112:115]
    ds_read_b64_tr_b16 a[182:183], v232 offset:26624
    v_fmac_f32 v38, v200, v36
    v_mfma_f32_16x16x32_bf16 v[112:115], a[160:163], a[124:127], v[112:115]
    v_fma_f32 v6, -v202, v36, v6
    s_waitcnt lgkmcnt(4)
    v_mfma_f32_16x16x32_bf16 v[128:131], a[168:171], a[124:127], v[128:131]
    ds_read_b64_tr_b16 a[160:161], v233 offset:16384
    v_fmac_f32 v38, v202, v4
    v_mfma_f32_16x16x32_bf16 v[128:131], a[172:175], a[44:47], v[128:131]
    v_fmac_f32 v7, v200, v5
    v_fmac_f32 v39, v200, v37
    v_mfma_f32_16x16x32_bf16 v[124:127], a[172:175], a[40:43], v[124:127]
    ds_read_b64_tr_b16 a[162:163], v233 offset:18432
    v_fma_f32 v7, -v202, v37, v7
    v_mfma_f32_16x16x32_bf16 v[124:127], a[168:171], a[120:123], v[124:127]
    buffer_load_dwordx4 a[88:91], v2, s[32:35], s60 offen offset:2048 sc1
    v_fmac_f32 v39, v202, v5
    v_mfma_f32_16x16x32_bf16 v[120:123], a[168:171], a[116:119], v[120:123]
    ds_read_b64_tr_b16 a[164:165], v233 offset:24576
    v_fmac_f32 v22, v201, v20
    v_mfma_f32_16x16x32_bf16 v[120:123], a[172:175], a[36:39], v[120:123]
    buffer_load_dwordx4 a[92:95], v2, s[32:35], s60 offen offset:3072 sc1
    v_fmac_f32 v54, v201, v52
    v_mfma_f32_16x16x32_bf16 v[116:119], a[172:175], a[32:35], v[116:119]
    ds_read_b64_tr_b16 a[166:167], v233 offset:26624
    v_fma_f32 v22, -v203, v52, v22
    v_mfma_f32_16x16x32_bf16 v[116:119], a[168:171], a[112:115], v[116:119]
    s_add_u32 s60, s60, 0x1000
    v_fmac_f32 v54, v203, v20
    s_waitcnt lgkmcnt(4)
    v_mfma_f32_16x16x32_bf16 v[132:135], a[176:179], a[112:115], v[132:135]
    ds_read_b64_tr_b16 a[168:169], v234 offset:16384
    v_fmac_f32 v23, v201, v21
    v_mfma_f32_16x16x32_bf16 v[132:135], a[180:183], a[32:35], v[132:135]
    v_fmac_f32 v55, v201, v53
    v_fma_f32 v23, -v203, v53, v23
    v_mfma_f32_16x16x32_bf16 v[136:139], a[180:183], a[36:39], v[136:139]
    ds_read_b64_tr_b16 a[170:171], v234 offset:18432
    v_fmac_f32 v55, v203, v21
    v_mfma_f32_16x16x32_bf16 v[136:139], a[176:179], a[116:119], v[136:139]
    buffer_load_dwordx4 a[0:3], v2, s[32:35], s60 offen sc1
    v_cvt_pk_bf16_f32 v220, v4, v5
    v_mfma_f32_16x16x32_bf16 v[140:143], a[176:179], a[120:123], v[140:143]
    ds_read_b64_tr_b16 a[172:173], v234 offset:24576
    v_cvt_pk_bf16_f32 v221, v6, v7
    v_mfma_f32_16x16x32_bf16 v[140:143], a[180:183], a[40:43], v[140:143]
    v_cvt_pk_bf16_f32 v222, v36, v37
    v_cvt_pk_bf16_f32 v223, v38, v39
    v_mfma_f32_16x16x32_bf16 v[144:147], a[180:183], a[44:47], v[144:147]
    ds_read_b64_tr_b16 a[174:175], v234 offset:26624
    v_mfma_f32_16x16x32_bf16 v[144:147], a[176:179], a[124:127], v[144:147]
    s_waitcnt lgkmcnt(4)
    v_mfma_f32_16x16x32_bf16 v[160:163], a[160:163], a[124:127], v[160:163]
    ds_read_b64_tr_b16 a[176:177], v235 offset:16384
    v_mfma_f32_16x16x32_bf16 v[160:163], a[164:167], a[44:47], v[160:163]
    ds_write_b64 v253, v[220:221] offset:0
    v_mfma_f32_16x16x32_bf16 v[156:159], a[164:167], a[40:43], v[156:159]
    ds_read_b64_tr_b16 a[178:179], v235 offset:18432
    v_mfma_f32_16x16x32_bf16 v[156:159], a[160:163], a[120:123], v[156:159]
    buffer_load_dwordx4 a[4:7], v2, s[32:35], s60 offen offset:1024 sc1
    v_mfma_f32_16x16x32_bf16 v[152:155], a[160:163], a[116:119], v[152:155]
    ds_read_b64_tr_b16 a[180:181], v235 offset:24576
    v_mfma_f32_16x16x32_bf16 v[152:155], a[164:167], a[36:39], v[152:155]
    ds_write_b64 v253, v[222:223] offset:1024
    v_mfma_f32_16x16x32_bf16 v[148:151], a[164:167], a[32:35], v[148:151]
    ds_read_b64_tr_b16 a[182:183], v235 offset:26624
    v_cvt_pk_bf16_f32 v224, v20, v21
    v_mfma_f32_16x16x32_bf16 v[148:151], a[160:163], a[112:115], v[148:151]
    buffer_load_dwordx4 a[8:11], v2, s[32:35], s60 offen offset:2048 sc1
    s_waitcnt lgkmcnt(6)
    v_mfma_f32_16x16x32_bf16 v[164:167], a[168:171], a[112:115], v[164:167]
    ds_read_b64_tr_b16 a[160:161], v228 offset:32768
    v_cvt_pk_bf16_f32 v225, v22, v23
    v_mfma_f32_16x16x32_bf16 v[164:167], a[172:175], a[32:35], v[164:167]
    v_cvt_pk_bf16_f32 v226, v52, v53
    v_cvt_pk_bf16_f32 v227, v54, v55
    v_mfma_f32_16x16x32_bf16 v[168:171], a[172:175], a[36:39], v[168:171]
    ds_read_b64_tr_b16 a[162:163], v228 offset:34816
    v_mfma_f32_16x16x32_bf16 v[168:171], a[168:171], a[116:119], v[168:171]
    buffer_load_dwordx4 a[12:15], v2, s[32:35], s60 offen offset:3072 sc1
    s_add_u32 s60, s60, 0x1000
    v_mfma_f32_16x16x32_bf16 v[172:175], a[168:171], a[120:123], v[172:175]
    ds_read_b64_tr_b16 a[164:165], v228 offset:40960
    v_mfma_f32_16x16x32_bf16 v[172:175], a[172:175], a[40:43], v[172:175]
    ds_write_b64 v253, v[224:225] offset:512
    v_mfma_f32_16x16x32_bf16 v[176:179], a[172:175], a[44:47], v[176:179]
    ds_read_b64_tr_b16 a[166:167], v228 offset:43008
    v_mfma_f32_16x16x32_bf16 v[176:179], a[168:171], a[124:127], v[176:179]
    buffer_load_dwordx4 a[16:19], v2, s[32:35], s60 offen sc1
    s_waitcnt lgkmcnt(5)
    v_mfma_f32_16x16x32_bf16 v[192:195], a[176:179], a[124:127], v[192:195]
    ds_read_b64_tr_b16 a[168:169], v229 offset:32768
    v_mfma_f32_16x16x32_bf16 v[192:195], a[180:183], a[44:47], v[192:195]
    ds_write_b64 v253, v[226:227] offset:1536
    v_mfma_f32_16x16x32_bf16 v[188:191], a[180:183], a[40:43], v[188:191]
    ds_read_b64_tr_b16 a[170:171], v229 offset:34816
    ds_read_b64_tr_b16 a[224:225], v254 offset:0
    v_mfma_f32_16x16x32_bf16 v[188:191], a[176:179], a[120:123], v[188:191]
    buffer_load_dwordx4 a[20:23], v2, s[32:35], s60 offen offset:1024 sc1
    ds_read_b64_tr_b16 a[226:227], v255 offset:0
    v_mfma_f32_16x16x32_bf16 v[184:187], a[176:179], a[116:119], v[184:187]
    ds_read_b64_tr_b16 a[172:173], v229 offset:40960
    ds_read_b64_tr_b16 a[240:241], v254 offset:1024
    v_mfma_f32_16x16x32_bf16 v[184:187], a[180:183], a[36:39], v[184:187]
    ds_read_b64_tr_b16 a[242:243], v255 offset:1024
    v_fmac_f32 v8, v200, v6
    v_mfma_f32_16x16x32_bf16 v[180:183], a[180:183], a[32:35], v[180:183]
    ds_read_b64_tr_b16 a[174:175], v229 offset:43008
    v_fmac_f32 v40, v200, v38
    v_mfma_f32_16x16x32_bf16 v[180:183], a[176:179], a[112:115], v[180:183]
    v_fma_f32 v8, -v202, v38, v8
    s_waitcnt vmcnt(26) lgkmcnt(9)
    v_mfma_f32_16x16x32_bf16 v[68:71], a[160:163], a[48:51], v[68:71]
    ds_read_b64_tr_b16 a[176:177], v230 offset:32768
    v_fmac_f32 v40, v202, v6
    v_mfma_f32_16x16x32_bf16 v[68:71], a[164:167], a[184:187], v[68:71]
    v_fmac_f32 v9, v200, v7
    v_fmac_f32 v41, v200, v39
    v_mfma_f32_16x16x32_bf16 v[72:75], a[164:167], a[188:191], v[72:75]
    ds_read_b64_tr_b16 a[178:179], v230 offset:34816
    v_fma_f32 v9, -v202, v39, v9
    v_mfma_f32_16x16x32_bf16 v[72:75], a[160:163], a[52:55], v[72:75]
    buffer_load_dwordx4 a[24:27], v2, s[32:35], s60 offen offset:2048 sc1
    v_fmac_f32 v41, v202, v7
    v_mfma_f32_16x16x32_bf16 v[76:79], a[160:163], a[56:59], v[76:79]
    ds_read_b64_tr_b16 a[180:181], v230 offset:40960
    v_mfma_f32_16x16x32_bf16 v[76:79], a[164:167], a[192:195], v[76:79]
    s_waitcnt lgkmcnt(7)
    buffer_store_dwordx4 a[224:227], v2, s[32:35], s7 offen sc0 sc1
    v_mfma_f32_16x16x32_bf16 v[80:83], a[164:167], a[196:199], v[80:83]
    ds_read_b64_tr_b16 a[182:183], v230 offset:43008
    v_fmac_f32 v24, v201, v22
    v_mfma_f32_16x16x32_bf16 v[80:83], a[160:163], a[60:63], v[80:83]
    buffer_load_dwordx4 a[28:31], v2, s[32:35], s60 offen offset:3072 sc1
    s_add_u32 s60, s60, 0x1000
    s_waitcnt lgkmcnt(4)
    v_mfma_f32_16x16x32_bf16 v[96:99], a[168:171], a[60:63], v[96:99]
    ds_read_b64_tr_b16 a[160:161], v231 offset:32768
    v_fmac_f32 v56, v201, v54
    v_mfma_f32_16x16x32_bf16 v[96:99], a[172:175], a[196:199], v[96:99]
    v_fma_f32 v24, -v203, v54, v24
    v_fmac_f32 v56, v203, v22
    v_mfma_f32_16x16x32_bf16 v[92:95], a[172:175], a[192:195], v[92:95]
    ds_read_b64_tr_b16 a[162:163], v231 offset:34816
    v_fmac_f32 v25, v201, v23
    v_mfma_f32_16x16x32_bf16 v[92:95], a[168:171], a[56:59], v[92:95]
    v_fmac_f32 v57, v201, v55
    v_fma_f32 v25, -v203, v55, v25
    v_mfma_f32_16x16x32_bf16 v[88:91], a[168:171], a[52:55], v[88:91]
    ds_read_b64_tr_b16 a[164:165], v231 offset:40960
    v_fmac_f32 v57, v203, v23
    v_mfma_f32_16x16x32_bf16 v[88:91], a[172:175], a[188:191], v[88:91]
    buffer_load_dwordx4 a[128:131], v2, s[32:35], s60 offen sc1
    v_fmac_f32 v10, v200, v8
    v_mfma_f32_16x16x32_bf16 v[84:87], a[172:175], a[184:187], v[84:87]
    ds_read_b64_tr_b16 a[166:167], v231 offset:43008
    v_fmac_f32 v42, v200, v40
    v_mfma_f32_16x16x32_bf16 v[84:87], a[168:171], a[48:51], v[84:87]
    v_fma_f32 v10, -v202, v40, v10
    s_waitcnt lgkmcnt(4)
    v_mfma_f32_16x16x32_bf16 v[100:103], a[176:179], a[48:51], v[100:103]
    ds_read_b64_tr_b16 a[168:169], v232 offset:32768
    v_fmac_f32 v42, v202, v8
    v_mfma_f32_16x16x32_bf16 v[100:103], a[180:183], a[184:187], v[100:103]
    v_fmac_f32 v11, v200, v9
    v_fmac_f32 v43, v200, v41
    v_mfma_f32_16x16x32_bf16 v[104:107], a[180:183], a[188:191], v[104:107]
    ds_read_b64_tr_b16 a[170:171], v232 offset:34816
    v_fma_f32 v11, -v202, v41, v11
    v_mfma_f32_16x16x32_bf16 v[104:107], a[176:179], a[52:55], v[104:107]
    v_fmac_f32 v43, v202, v9
    v_mfma_f32_16x16x32_bf16 v[108:111], a[176:179], a[56:59], v[108:111]
    ds_read_b64_tr_b16 a[172:173], v232 offset:40960
    v_mfma_f32_16x16x32_bf16 v[108:111], a[180:183], a[192:195], v[108:111]
    s_waitcnt lgkmcnt(12)
    buffer_store_dwordx4 a[240:243], v2, s[32:35], s27 offen sc0 sc1
    v_mfma_f32_16x16x32_bf16 v[112:115], a[180:183], a[196:199], v[112:115]
    ds_read_b64_tr_b16 a[174:175], v232 offset:43008
    v_fmac_f32 v26, v201, v24
    v_mfma_f32_16x16x32_bf16 v[112:115], a[176:179], a[60:63], v[112:115]
    buffer_load_dwordx4 a[132:135], v2, s[32:35], s60 offen offset:1024 sc1
    s_waitcnt lgkmcnt(4)
    v_mfma_f32_16x16x32_bf16 v[128:131], a[160:163], a[60:63], v[128:131]
    ds_read_b64_tr_b16 a[176:177], v233 offset:32768
    v_fmac_f32 v58, v201, v56
    v_mfma_f32_16x16x32_bf16 v[128:131], a[164:167], a[196:199], v[128:131]
    v_fma_f32 v26, -v203, v56, v26
    v_fmac_f32 v58, v203, v24
    v_mfma_f32_16x16x32_bf16 v[124:127], a[164:167], a[192:195], v[124:127]
    ds_read_b64_tr_b16 a[178:179], v233 offset:34816
    v_fmac_f32 v27, v201, v25
    v_mfma_f32_16x16x32_bf16 v[124:127], a[160:163], a[56:59], v[124:127]
    v_fmac_f32 v59, v201, v57
    v_fma_f32 v27, -v203, v57, v27
    v_mfma_f32_16x16x32_bf16 v[120:123], a[160:163], a[52:55], v[120:123]
    ds_read_b64_tr_b16 a[180:181], v233 offset:40960
    v_fmac_f32 v59, v203, v25
    v_mfma_f32_16x16x32_bf16 v[120:123], a[164:167], a[188:191], v[120:123]
    buffer_load_dwordx4 a[136:139], v2, s[32:35], s60 offen offset:2048 sc1
    v_cvt_pk_bf16_f32 v220, v8, v9
    v_mfma_f32_16x16x32_bf16 v[116:119], a[164:167], a[184:187], v[116:119]
    ds_read_b64_tr_b16 a[182:183], v233 offset:43008
    v_cvt_pk_bf16_f32 v221, v10, v11
    v_mfma_f32_16x16x32_bf16 v[116:119], a[160:163], a[48:51], v[116:119]
    v_cvt_pk_bf16_f32 v222, v40, v41
    s_waitcnt lgkmcnt(4)
    v_mfma_f32_16x16x32_bf16 v[132:135], a[168:171], a[48:51], v[132:135]
    ds_read_b64_tr_b16 a[160:161], v234 offset:32768
    v_cvt_pk_bf16_f32 v223, v42, v43
    v_mfma_f32_16x16x32_bf16 v[132:135], a[172:175], a[184:187], v[132:135]
    ds_write_b64 v253, v[220:221] offset:2048
    v_mfma_f32_16x16x32_bf16 v[136:139], a[172:175], a[188:191], v[136:139]
    ds_read_b64_tr_b16 a[162:163], v234 offset:34816
    v_mfma_f32_16x16x32_bf16 v[136:139], a[168:171], a[52:55], v[136:139]
    buffer_load_dwordx4 a[140:143], v2, s[32:35], s60 offen offset:3072 sc1
    s_add_u32 s60, s60, 0x1000
    v_mfma_f32_16x16x32_bf16 v[140:143], a[168:171], a[56:59], v[140:143]
    ds_read_b64_tr_b16 a[164:165], v234 offset:40960
    v_mfma_f32_16x16x32_bf16 v[140:143], a[172:175], a[192:195], v[140:143]
    ds_write_b64 v253, v[222:223] offset:3072
    v_mfma_f32_16x16x32_bf16 v[144:147], a[172:175], a[196:199], v[144:147]
    ds_read_b64_tr_b16 a[166:167], v234 offset:43008
    v_cvt_pk_bf16_f32 v224, v24, v25
    v_mfma_f32_16x16x32_bf16 v[144:147], a[168:171], a[60:63], v[144:147]
    v_cvt_pk_bf16_f32 v225, v26, v27
    s_waitcnt lgkmcnt(6)
    v_mfma_f32_16x16x32_bf16 v[160:163], a[176:179], a[60:63], v[160:163]
    ds_read_b64_tr_b16 a[168:169], v235 offset:32768
    v_cvt_pk_bf16_f32 v226, v56, v57
    v_mfma_f32_16x16x32_bf16 v[160:163], a[180:183], a[196:199], v[160:163]
    v_cvt_pk_bf16_f32 v227, v58, v59
    v_mfma_f32_16x16x32_bf16 v[156:159], a[180:183], a[192:195], v[156:159]
    ds_read_b64_tr_b16 a[170:171], v235 offset:34816
    v_mfma_f32_16x16x32_bf16 v[156:159], a[176:179], a[56:59], v[156:159]
    buffer_load_dwordx4 a[144:147], v2, s[32:35], s60 offen sc1
    v_mfma_f32_16x16x32_bf16 v[152:155], a[176:179], a[52:55], v[152:155]
    ds_read_b64_tr_b16 a[172:173], v235 offset:40960
    v_mfma_f32_16x16x32_bf16 v[152:155], a[180:183], a[188:191], v[152:155]
    ds_write_b64 v253, v[224:225] offset:2560
    v_mfma_f32_16x16x32_bf16 v[148:151], a[180:183], a[184:187], v[148:151]
    ds_read_b64_tr_b16 a[174:175], v235 offset:43008
    v_mfma_f32_16x16x32_bf16 v[148:151], a[176:179], a[48:51], v[148:151]
    buffer_load_dwordx4 a[148:151], v2, s[32:35], s60 offen offset:1024 sc1
    s_waitcnt vmcnt(24) lgkmcnt(5)
    s_barrier
    v_mfma_f32_16x16x32_bf16 v[164:167], a[160:163], a[48:51], v[164:167]
    ds_read_b64_tr_b16 a[176:177], v228 offset:49152
    v_mfma_f32_16x16x32_bf16 v[164:167], a[164:167], a[184:187], v[164:167]
    ds_write_b64 v253, v[226:227] offset:3584
    v_mfma_f32_16x16x32_bf16 v[168:171], a[164:167], a[188:191], v[168:171]
    ds_read_b64_tr_b16 a[178:179], v228 offset:51200
    ds_read_b64_tr_b16 a[228:229], v254 offset:2048
    v_mfma_f32_16x16x32_bf16 v[168:171], a[160:163], a[52:55], v[168:171]
    buffer_load_dwordx4 a[152:155], v2, s[32:35], s60 offen offset:2048 sc1
    ds_read_b64_tr_b16 a[230:231], v255 offset:2048
    v_mfma_f32_16x16x32_bf16 v[172:175], a[160:163], a[56:59], v[172:175]
    ds_read_b64_tr_b16 a[180:181], v228 offset:57344
    ds_read_b64_tr_b16 a[244:245], v254 offset:3072
    v_mfma_f32_16x16x32_bf16 v[172:175], a[164:167], a[192:195], v[172:175]
    buffer_load_dwordx4 a[156:159], v2, s[32:35], s60 offen offset:3072 sc1
    ds_read_b64_tr_b16 a[246:247], v255 offset:3072
    v_mfma_f32_16x16x32_bf16 v[176:179], a[164:167], a[196:199], v[176:179]
    ds_read_b64_tr_b16 a[182:183], v228 offset:59392
    v_xor_b32 v228, 0x10000, v228
    v_mfma_f32_16x16x32_bf16 v[176:179], a[160:163], a[60:63], v[176:179]
    s_add_u32 s60, s60, 0x1000
    v_fmac_f32 v12, v200, v10
    s_waitcnt lgkmcnt(9)
    v_mfma_f32_16x16x32_bf16 v[192:195], a[168:171], a[60:63], v[192:195]
    ds_read_b64_tr_b16 a[160:161], v229 offset:49152
    v_fmac_f32 v44, v200, v42
    v_mfma_f32_16x16x32_bf16 v[192:195], a[172:175], a[196:199], v[192:195]
    s_add_u32 s61, s4, 1048576
    s_add_u32 m0, s64, 32768
    v_fma_f32 v12, -v202, v42, v12
    v_mfma_f32_16x16x32_bf16 v[188:191], a[172:175], a[192:195], v[188:191]
    ds_read_b64_tr_b16 a[162:163], v229 offset:51200
    v_fmac_f32 v44, v202, v10
    v_mfma_f32_16x16x32_bf16 v[188:191], a[168:171], a[56:59], v[188:191]
    buffer_load_dwordx4 v242, s[48:51], s61 offen lds
    v_fmac_f32 v13, v200, v11
    v_mfma_f32_16x16x32_bf16 v[184:187], a[168:171], a[52:55], v[184:187]
    ds_read_b64_tr_b16 a[164:165], v229 offset:57344
    v_fmac_f32 v45, v200, v43
    v_mfma_f32_16x16x32_bf16 v[184:187], a[172:175], a[188:191], v[184:187]
    v_fma_f32 v13, -v202, v43, v13
    v_fmac_f32 v45, v202, v11
    v_mfma_f32_16x16x32_bf16 v[180:183], a[172:175], a[184:187], v[180:183]
    ds_read_b64_tr_b16 a[166:167], v229 offset:59392
    v_xor_b32 v229, 0x10000, v229
    v_mfma_f32_16x16x32_bf16 v[180:183], a[168:171], a[48:51], v[180:183]
    s_waitcnt vmcnt(19) lgkmcnt(4)
    v_mfma_f32_16x16x32_bf16 v[68:71], a[176:179], a[64:67], v[68:71]
    ds_read_b64_tr_b16 a[168:169], v230 offset:49152
    v_mfma_f32_16x16x32_bf16 v[68:71], a[180:183], a[80:83], v[68:71]
    s_waitcnt lgkmcnt(9)
    buffer_store_dwordx4 a[228:231], v2, s[32:35], s7 offen offset:1024 sc0 sc1
    v_mfma_f32_16x16x32_bf16 v[72:75], a[180:183], a[84:87], v[72:75]
    ds_read_b64_tr_b16 a[170:171], v230 offset:51200
    v_fmac_f32 v28, v201, v26
    v_mfma_f32_16x16x32_bf16 v[72:75], a[176:179], a[68:71], v[72:75]
    buffer_load_dwordx4 v243, s[48:51], s61 offen offset:1024 lds
    v_fmac_f32 v60, v201, v58
    v_mfma_f32_16x16x32_bf16 v[76:79], a[176:179], a[72:75], v[76:79]
    ds_read_b64_tr_b16 a[172:173], v230 offset:57344
    v_fma_f32 v28, -v203, v58, v28
    v_mfma_f32_16x16x32_bf16 v[76:79], a[180:183], a[88:91], v[76:79]
    v_fmac_f32 v60, v203, v26
    v_fmac_f32 v29, v201, v27
    v_mfma_f32_16x16x32_bf16 v[80:83], a[180:183], a[92:95], v[80:83]
    ds_read_b64_tr_b16 a[174:175], v230 offset:59392
    v_xor_b32 v230, 0x10000, v230
    v_mfma_f32_16x16x32_bf16 v[80:83], a[176:179], a[76:79], v[80:83]
    v_fmac_f32 v61, v201, v59
    s_waitcnt lgkmcnt(4)
    v_mfma_f32_16x16x32_bf16 v[96:99], a[160:163], a[76:79], v[96:99]
    ds_read_b64_tr_b16 a[176:177], v231 offset:49152
    v_fma_f32 v29, -v203, v59, v29
    v_mfma_f32_16x16x32_bf16 v[96:99], a[164:167], a[92:95], v[96:99]
    v_fmac_f32 v61, v203, v27
    v_fmac_f32 v14, v200, v12
    v_mfma_f32_16x16x32_bf16 v[92:95], a[164:167], a[88:91], v[92:95]
    ds_read_b64_tr_b16 a[178:179], v231 offset:51200
    v_fmac_f32 v46, v200, v44
    v_mfma_f32_16x16x32_bf16 v[92:95], a[160:163], a[72:75], v[92:95]
    buffer_load_dwordx4 v244, s[48:51], s61 offen offset:2048 lds
    v_fma_f32 v14, -v202, v44, v14
    v_mfma_f32_16x16x32_bf16 v[88:91], a[160:163], a[68:71], v[88:91]
    ds_read_b64_tr_b16 a[180:181], v231 offset:57344
    v_fmac_f32 v46, v202, v12
    v_mfma_f32_16x16x32_bf16 v[88:91], a[164:167], a[84:87], v[88:91]
    buffer_load_dwordx4 v245, s[48:51], s61 offen offset:3072 lds
    v_fmac_f32 v15, v200, v13
    v_mfma_f32_16x16x32_bf16 v[84:87], a[164:167], a[80:83], v[84:87]
    ds_read_b64_tr_b16 a[182:183], v231 offset:59392
    v_xor_b32 v231, 0x10000, v231
    v_mfma_f32_16x16x32_bf16 v[84:87], a[160:163], a[64:67], v[84:87]
    v_fmac_f32 v47, v200, v45
    s_waitcnt lgkmcnt(4)
    v_mfma_f32_16x16x32_bf16 v[100:103], a[168:171], a[64:67], v[100:103]
    ds_read_b64_tr_b16 a[160:161], v232 offset:49152
    v_fma_f32 v15, -v202, v45, v15
    v_mfma_f32_16x16x32_bf16 v[100:103], a[172:175], a[80:83], v[100:103]
    v_fmac_f32 v47, v202, v13
    v_mfma_f32_16x16x32_bf16 v[104:107], a[172:175], a[84:87], v[104:107]
    ds_read_b64_tr_b16 a[162:163], v232 offset:51200
    v_mfma_f32_16x16x32_bf16 v[104:107], a[168:171], a[68:71], v[104:107]
    s_waitcnt lgkmcnt(15)
    buffer_store_dwordx4 a[244:247], v2, s[32:35], s27 offen offset:1024 sc0 sc1
    v_mfma_f32_16x16x32_bf16 v[108:111], a[168:171], a[72:75], v[108:111]
    ds_read_b64_tr_b16 a[164:165], v232 offset:57344
    v_fmac_f32 v30, v201, v28
    v_mfma_f32_16x16x32_bf16 v[108:111], a[172:175], a[88:91], v[108:111]
    v_fmac_f32 v62, v201, v60
    v_fma_f32 v30, -v203, v60, v30
    v_mfma_f32_16x16x32_bf16 v[112:115], a[172:175], a[92:95], v[112:115]
    ds_read_b64_tr_b16 a[166:167], v232 offset:59392
    v_xor_b32 v232, 0x10000, v232
    v_mfma_f32_16x16x32_bf16 v[112:115], a[168:171], a[76:79], v[112:115]
    v_fmac_f32 v62, v203, v28
    s_waitcnt lgkmcnt(4)
    v_mfma_f32_16x16x32_bf16 v[128:131], a[176:179], a[76:79], v[128:131]
    ds_read_b64_tr_b16 a[168:169], v233 offset:49152
    v_fmac_f32 v31, v201, v29
    v_mfma_f32_16x16x32_bf16 v[128:131], a[180:183], a[92:95], v[128:131]
    s_add_u32 s61, s4, 1507328
    s_add_u32 m0, s64, 49152
    v_fmac_f32 v63, v201, v61
    v_mfma_f32_16x16x32_bf16 v[124:127], a[180:183], a[88:91], v[124:127]
    ds_read_b64_tr_b16 a[170:171], v233 offset:51200
    v_fma_f32 v31, -v203, v61, v31
    v_mfma_f32_16x16x32_bf16 v[124:127], a[176:179], a[72:75], v[124:127]
    buffer_load_dwordx4 v242, s[48:51], s61 offen lds
    v_fmac_f32 v63, v203, v29
    v_mfma_f32_16x16x32_bf16 v[120:123], a[176:179], a[68:71], v[120:123]
    ds_read_b64_tr_b16 a[172:173], v233 offset:57344
    v_cvt_pk_bf16_f32 v220, v12, v13
    v_mfma_f32_16x16x32_bf16 v[120:123], a[180:183], a[84:87], v[120:123]
    buffer_load_dwordx4 v243, s[48:51], s61 offen offset:1024 lds
    v_cvt_pk_bf16_f32 v221, v14, v15
    v_mfma_f32_16x16x32_bf16 v[116:119], a[180:183], a[80:83], v[116:119]
    ds_read_b64_tr_b16 a[174:175], v233 offset:59392
    v_xor_b32 v233, 0x10000, v233
    v_mfma_f32_16x16x32_bf16 v[116:119], a[176:179], a[64:67], v[116:119]
    v_cvt_pk_bf16_f32 v222, v44, v45
    s_waitcnt lgkmcnt(4)
    v_mfma_f32_16x16x32_bf16 v[132:135], a[160:163], a[64:67], v[132:135]
    ds_read_b64_tr_b16 a[176:177], v234 offset:49152
    v_cvt_pk_bf16_f32 v223, v46, v47
    v_mfma_f32_16x16x32_bf16 v[132:135], a[164:167], a[80:83], v[132:135]
    ds_write_b64 v253, v[220:221] offset:4096
    v_mfma_f32_16x16x32_bf16 v[136:139], a[164:167], a[84:87], v[136:139]
    ds_read_b64_tr_b16 a[178:179], v234 offset:51200
    v_mfma_f32_16x16x32_bf16 v[136:139], a[160:163], a[68:71], v[136:139]
    buffer_load_dwordx4 v244, s[48:51], s61 offen offset:2048 lds
    v_mfma_f32_16x16x32_bf16 v[140:143], a[160:163], a[72:75], v[140:143]
    ds_read_b64_tr_b16 a[180:181], v234 offset:57344
    v_mfma_f32_16x16x32_bf16 v[140:143], a[164:167], a[88:91], v[140:143]
    ds_write_b64 v253, v[222:223] offset:5120
    v_mfma_f32_16x16x32_bf16 v[144:147], a[164:167], a[92:95], v[144:147]
    ds_read_b64_tr_b16 a[182:183], v234 offset:59392
    v_xor_b32 v234, 0x10000, v234
    v_mfma_f32_16x16x32_bf16 v[144:147], a[160:163], a[76:79], v[144:147]
    v_cvt_pk_bf16_f32 v224, v28, v29
    s_waitcnt lgkmcnt(6)
    v_mfma_f32_16x16x32_bf16 v[160:163], a[168:171], a[76:79], v[160:163]
    ds_read_b64_tr_b16 a[160:161], v235 offset:49152
    v_cvt_pk_bf16_f32 v225, v30, v31
    v_mfma_f32_16x16x32_bf16 v[160:163], a[172:175], a[92:95], v[160:163]
    v_cvt_pk_bf16_f32 v226, v60, v61
    v_cvt_pk_bf16_f32 v227, v62, v63
    v_mfma_f32_16x16x32_bf16 v[156:159], a[172:175], a[88:91], v[156:159]
    ds_read_b64_tr_b16 a[162:163], v235 offset:51200
    v_mfma_f32_16x16x32_bf16 v[156:159], a[168:171], a[72:75], v[156:159]
    buffer_load_dwordx4 v245, s[48:51], s61 offen offset:3072 lds
    v_mfma_f32_16x16x32_bf16 v[152:155], a[168:171], a[68:71], v[152:155]
    ds_read_b64_tr_b16 a[164:165], v235 offset:57344
    v_mfma_f32_16x16x32_bf16 v[152:155], a[172:175], a[84:87], v[152:155]
    s_add_u32 s61, s5, 0
    s_add_u32 m0, s64, 65536
    v_mfma_f32_16x16x32_bf16 v[148:151], a[172:175], a[80:83], v[148:151]
    ds_read_b64_tr_b16 a[166:167], v235 offset:59392
    v_xor_b32 v235, 0x10000, v235
    v_mfma_f32_16x16x32_bf16 v[148:151], a[168:171], a[64:67], v[148:151]
    buffer_load_dwordx4 v242, s[48:51], s61 offen lds
    s_waitcnt lgkmcnt(4)
    v_mfma_f32_16x16x32_bf16 v[164:167], a[176:179], a[64:67], v[164:167]
    ds_read_b64_tr_b16 a[168:169], v228 offset:0
    v_mfma_f32_16x16x32_bf16 v[164:167], a[180:183], a[80:83], v[164:167]
    ds_write_b64 v253, v[224:225] offset:4608
    v_mfma_f32_16x16x32_bf16 v[168:171], a[180:183], a[84:87], v[168:171]
    ds_read_b64_tr_b16 a[170:171], v228 offset:2048
    v_mfma_f32_16x16x32_bf16 v[168:171], a[176:179], a[68:71], v[168:171]
    buffer_load_dwordx4 v243, s[48:51], s61 offen offset:1024 lds
    v_mfma_f32_16x16x32_bf16 v[172:175], a[176:179], a[72:75], v[172:175]
    ds_read_b64_tr_b16 a[172:173], v228 offset:8192
    v_mfma_f32_16x16x32_bf16 v[172:175], a[180:183], a[88:91], v[172:175]
    ds_write_b64 v253, v[226:227] offset:5632
    v_mfma_f32_16x16x32_bf16 v[176:179], a[180:183], a[92:95], v[176:179]
    ds_read_b64_tr_b16 a[174:175], v228 offset:10240
    ds_read_b64_tr_b16 a[232:233], v254 offset:4096
    v_mfma_f32_16x16x32_bf16 v[176:179], a[176:179], a[76:79], v[176:179]
    buffer_load_dwordx4 v244, s[48:51], s61 offen offset:2048 lds
    s_waitcnt lgkmcnt(7)
    v_mfma_f32_16x16x32_bf16 v[192:195], a[160:163], a[76:79], v[192:195]
    ds_read_b64_tr_b16 a[176:177], v229 offset:0
    ds_read_b64_tr_b16 a[234:235], v255 offset:4096
    v_mfma_f32_16x16x32_bf16 v[192:195], a[164:167], a[92:95], v[192:195]
    ds_read_b64_tr_b16 a[248:249], v254 offset:5120
    ds_read_b64_tr_b16 a[250:251], v255 offset:5120
    v_mfma_f32_16x16x32_bf16 v[188:191], a[164:167], a[88:91], v[188:191]
    ds_read_b64_tr_b16 a[178:179], v229 offset:2048
    v_fmac_f32 v16, v200, v14
    v_mfma_f32_16x16x32_bf16 v[188:191], a[160:163], a[72:75], v[188:191]
    buffer_load_dwordx4 v245, s[48:51], s61 offen offset:3072 lds
    v_fmac_f32 v48, v200, v46
    v_mfma_f32_16x16x32_bf16 v[184:187], a[160:163], a[68:71], v[184:187]
    ds_read_b64_tr_b16 a[180:181], v229 offset:8192
    v_fma_f32 v16, -v202, v46, v16
    v_mfma_f32_16x16x32_bf16 v[184:187], a[164:167], a[84:87], v[184:187]
    v_fmac_f32 v48, v202, v14
    v_fmac_f32 v17, v200, v15
    v_mfma_f32_16x16x32_bf16 v[180:183], a[164:167], a[80:83], v[180:183]
    ds_read_b64_tr_b16 a[182:183], v229 offset:10240
    v_fmac_f32 v49, v200, v47
    v_mfma_f32_16x16x32_bf16 v[180:183], a[160:163], a[64:67], v[180:183]
    v_fma_f32 v17, -v202, v47, v17
    s_waitcnt vmcnt(23) lgkmcnt(8)
    v_mfma_f32_16x16x32_bf16 v[68:71], a[168:171], a[0:3], v[68:71]
    ds_read_b64_tr_b16 a[160:161], v230 offset:0
    v_fmac_f32 v49, v202, v15
    v_mfma_f32_16x16x32_bf16 v[68:71], a[172:175], a[16:19], v[68:71]
    s_waitcnt lgkmcnt(6)
    buffer_store_dwordx4 a[232:235], v2, s[32:35], s7 offen offset:2048 sc0 sc1
    v_mfma_f32_16x16x32_bf16 v[72:75], a[172:175], a[20:23], v[72:75]
    ds_read_b64_tr_b16 a[162:163], v230 offset:2048
    v_fmac_f32 v32, v201, v30
    v_mfma_f32_16x16x32_bf16 v[72:75], a[168:171], a[4:7], v[72:75]
    buffer_load_dwordx4 a[96:99], v2, s[32:35], s60 offen sc1
    v_fmac_f32 v64, v201, v62
    v_mfma_f32_16x16x32_bf16 v[76:79], a[168:171], a[8:11], v[76:79]
    ds_read_b64_tr_b16 a[164:165], v230 offset:8192
    v_fma_f32 v32, -v203, v62, v32
    v_mfma_f32_16x16x32_bf16 v[76:79], a[172:175], a[24:27], v[76:79]
    v_fmac_f32 v64, v203, v30
    v_fmac_f32 v33, v201, v31
    v_mfma_f32_16x16x32_bf16 v[80:83], a[172:175], a[28:31], v[80:83]
    ds_read_b64_tr_b16 a[166:167], v230 offset:10240
    v_fmac_f32 v65, v201, v63
    v_mfma_f32_16x16x32_bf16 v[80:83], a[168:171], a[12:15], v[80:83]
    v_fma_f32 v33, -v203, v63, v33
    s_waitcnt lgkmcnt(4)
    v_mfma_f32_16x16x32_bf16 v[96:99], a[176:179], a[12:15], v[96:99]
    ds_read_b64_tr_b16 a[168:169], v231 offset:0
    v_fmac_f32 v65, v203, v31
    v_mfma_f32_16x16x32_bf16 v[96:99], a[180:183], a[28:31], v[96:99]
    v_fmac_f32 v18, v200, v16
    v_fmac_f32 v50, v200, v48
    v_mfma_f32_16x16x32_bf16 v[92:95], a[180:183], a[24:27], v[92:95]
    ds_read_b64_tr_b16 a[170:171], v231 offset:2048
    v_fma_f32 v18, -v202, v48, v18
    v_mfma_f32_16x16x32_bf16 v[92:95], a[176:179], a[8:11], v[92:95]
    buffer_load_dwordx4 a[100:103], v2, s[32:35], s60 offen offset:1024 sc1
    v_fmac_f32 v50, v202, v16
    v_mfma_f32_16x16x32_bf16 v[88:91], a[176:179], a[4:7], v[88:91]
    ds_read_b64_tr_b16 a[172:173], v231 offset:8192
    v_fmac_f32 v19, v200, v17
    v_mfma_f32_16x16x32_bf16 v[88:91], a[180:183], a[20:23], v[88:91]
    buffer_load_dwordx4 a[104:107], v2, s[32:35], s60 offen offset:2048 sc1
    v_fmac_f32 v51, v200, v49
    v_mfma_f32_16x16x32_bf16 v[84:87], a[180:183], a[16:19], v[84:87]
    ds_read_b64_tr_b16 a[174:175], v231 offset:10240
    v_fma_f32 v19, -v202, v49, v19
    v_mfma_f32_16x16x32_bf16 v[84:87], a[176:179], a[0:3], v[84:87]
    v_fmac_f32 v51, v202, v17
    s_waitcnt lgkmcnt(4)
    v_mfma_f32_16x16x32_bf16 v[100:103], a[160:163], a[0:3], v[100:103]
    ds_read_b64_tr_b16 a[176:177], v232 offset:0
    v_mfma_f32_16x16x32_bf16 v[100:103], a[164:167], a[16:19], v[100:103]
    s_waitcnt lgkmcnt(12)
    buffer_store_dwordx4 a[248:251], v2, s[32:35], s27 offen offset:2048 sc0 sc1
    v_mfma_f32_16x16x32_bf16 v[104:107], a[164:167], a[20:23], v[104:107]
    ds_read_b64_tr_b16 a[178:179], v232 offset:2048
    v_fmac_f32 v34, v201, v32
    v_mfma_f32_16x16x32_bf16 v[104:107], a[160:163], a[4:7], v[104:107]
    v_fmac_f32 v66, v201, v64
    v_fma_f32 v34, -v203, v64, v34
    v_mfma_f32_16x16x32_bf16 v[108:111], a[160:163], a[8:11], v[108:111]
    ds_read_b64_tr_b16 a[180:181], v232 offset:8192
    v_fmac_f32 v66, v203, v32
    v_mfma_f32_16x16x32_bf16 v[108:111], a[164:167], a[24:27], v[108:111]
    v_fmac_f32 v35, v201, v33
    v_fmac_f32 v67, v201, v65
    v_mfma_f32_16x16x32_bf16 v[112:115], a[164:167], a[28:31], v[112:115]
    ds_read_b64_tr_b16 a[182:183], v232 offset:10240
    v_fma_f32 v35, -v203, v65, v35
    v_mfma_f32_16x16x32_bf16 v[112:115], a[160:163], a[12:15], v[112:115]
    v_fmac_f32 v67, v203, v33
    s_waitcnt lgkmcnt(4)
    v_mfma_f32_16x16x32_bf16 v[128:131], a[168:171], a[12:15], v[128:131]
    ds_read_b64_tr_b16 a[160:161], v233 offset:0
    v_cvt_pk_bf16_f32 v220, v16, v17
    v_mfma_f32_16x16x32_bf16 v[128:131], a[172:175], a[28:31], v[128:131]
    v_cvt_pk_bf16_f32 v221, v18, v19
    v_cvt_pk_bf16_f32 v222, v48, v49
    v_mfma_f32_16x16x32_bf16 v[124:127], a[172:175], a[24:27], v[124:127]
    ds_read_b64_tr_b16 a[162:163], v233 offset:2048
    v_cvt_pk_bf16_f32 v223, v50, v51
    v_mfma_f32_16x16x32_bf16 v[124:127], a[168:171], a[8:11], v[124:127]
    buffer_load_dwordx4 a[108:111], v2, s[32:35], s60 offen offset:3072 sc1
    s_add_u32 s60, s60, 0x1000
    v_mfma_f32_16x16x32_bf16 v[120:123], a[168:171], a[4:7], v[120:123]
    ds_read_b64_tr_b16 a[164:165], v233 offset:8192
    v_mfma_f32_16x16x32_bf16 v[120:123], a[172:175], a[20:23], v[120:123]
    ds_write_b64 v253, v[220:221] offset:6144
    v_mfma_f32_16x16x32_bf16 v[116:119], a[172:175], a[16:19], v[116:119]
    ds_read_b64_tr_b16 a[166:167], v233 offset:10240
    v_mfma_f32_16x16x32_bf16 v[116:119], a[168:171], a[0:3], v[116:119]
    buffer_load_dwordx4 a[112:115], v2, s[32:35], s60 offen sc1
    s_waitcnt lgkmcnt(5)
    v_mfma_f32_16x16x32_bf16 v[132:135], a[176:179], a[0:3], v[132:135]
    ds_read_b64_tr_b16 a[168:169], v234 offset:0
    v_mfma_f32_16x16x32_bf16 v[132:135], a[180:183], a[16:19], v[132:135]
    ds_write_b64 v253, v[222:223] offset:7168
    v_mfma_f32_16x16x32_bf16 v[136:139], a[180:183], a[20:23], v[136:139]
    ds_read_b64_tr_b16 a[170:171], v234 offset:2048
    v_cvt_pk_bf16_f32 v224, v32, v33
    v_mfma_f32_16x16x32_bf16 v[136:139], a[176:179], a[4:7], v[136:139]
    buffer_load_dwordx4 a[116:119], v2, s[32:35], s60 offen offset:1024 sc1
    v_cvt_pk_bf16_f32 v225, v34, v35
    v_mfma_f32_16x16x32_bf16 v[140:143], a[176:179], a[8:11], v[140:143]
    ds_read_b64_tr_b16 a[172:173], v234 offset:8192
    v_cvt_pk_bf16_f32 v226, v64, v65
    v_mfma_f32_16x16x32_bf16 v[140:143], a[180:183], a[24:27], v[140:143]
    v_cvt_pk_bf16_f32 v227, v66, v67
    v_mfma_f32_16x16x32_bf16 v[144:147], a[180:183], a[28:31], v[144:147]
    ds_read_b64_tr_b16 a[174:175], v234 offset:10240
    v_mfma_f32_16x16x32_bf16 v[144:147], a[176:179], a[12:15], v[144:147]
    s_waitcnt lgkmcnt(5)
    v_mfma_f32_16x16x32_bf16 v[160:163], a[160:163], a[12:15], v[160:163]
    ds_read_b64_tr_b16 a[176:177], v235 offset:0
    v_mfma_f32_16x16x32_bf16 v[160:163], a[164:167], a[28:31], v[160:163]
    ds_write_b64 v253, v[224:225] offset:6656
    v_mfma_f32_16x16x32_bf16 v[156:159], a[164:167], a[24:27], v[156:159]
    ds_read_b64_tr_b16 a[178:179], v235 offset:2048
    v_mfma_f32_16x16x32_bf16 v[156:159], a[160:163], a[8:11], v[156:159]
    buffer_load_dwordx4 a[120:123], v2, s[32:35], s60 offen offset:2048 sc1
    v_mfma_f32_16x16x32_bf16 v[152:155], a[160:163], a[4:7], v[152:155]
    ds_read_b64_tr_b16 a[180:181], v235 offset:8192
    v_mfma_f32_16x16x32_bf16 v[152:155], a[164:167], a[20:23], v[152:155]
    ds_write_b64 v253, v[226:227] offset:7680
    v_mfma_f32_16x16x32_bf16 v[148:151], a[164:167], a[16:19], v[148:151]
    ds_read_b64_tr_b16 a[182:183], v235 offset:10240
    ds_read_b64_tr_b16 a[236:237], v254 offset:6144
    v_mfma_f32_16x16x32_bf16 v[148:151], a[160:163], a[0:3], v[148:151]
    buffer_load_dwordx4 a[124:127], v2, s[32:35], s60 offen offset:3072 sc1
    s_add_u32 s60, s60, 0x1000
    s_waitcnt lgkmcnt(7)
    v_mfma_f32_16x16x32_bf16 v[164:167], a[168:171], a[0:3], v[164:167]
    ds_read_b64_tr_b16 a[160:161], v228 offset:16384
    ds_read_b64_tr_b16 a[238:239], v255 offset:6144
    v_mfma_f32_16x16x32_bf16 v[164:167], a[172:175], a[16:19], v[164:167]
    ds_read_b64_tr_b16 a[252:253], v254 offset:7168
    ds_read_b64_tr_b16 a[254:255], v255 offset:7168
    v_mfma_f32_16x16x32_bf16 v[168:171], a[172:175], a[20:23], v[168:171]
    ds_read_b64_tr_b16 a[162:163], v228 offset:18432
    v_lshrrev_b32 v12, 3, v0
    v_mfma_f32_16x16x32_bf16 v[168:171], a[168:171], a[4:7], v[168:171]
    buffer_load_dwordx4 a[32:35], v2, s[32:35], s60 offen sc1
    v_lshrrev_b32 v13, 1, v12
    v_mfma_f32_16x16x32_bf16 v[172:175], a[168:171], a[8:11], v[172:175]
    ds_read_b64_tr_b16 a[164:165], v228 offset:24576
    v_xor_b32 v13, v13, v1
    v_mfma_f32_16x16x32_bf16 v[172:175], a[172:175], a[24:27], v[172:175]
    buffer_load_dwordx4 a[36:39], v2, s[32:35], s60 offen offset:1024 sc1
    v_and_b32 v13, 7, v13
    v_mfma_f32_16x16x32_bf16 v[176:179], a[172:175], a[28:31], v[176:179]
    ds_read_b64_tr_b16 a[166:167], v228 offset:26624
    v_lshlrev_b32 v13, 4, v13
    v_mfma_f32_16x16x32_bf16 v[176:179], a[168:171], a[12:15], v[176:179]
    v_lshl_add_u32 v13, v12, 11, v13
    s_lshl_b32 s66, s56, 18
    s_waitcnt lgkmcnt(8)
    v_mfma_f32_16x16x32_bf16 v[192:195], a[176:179], a[12:15], v[192:195]
    ds_read_b64_tr_b16 a[168:169], v229 offset:16384
    v_add_u32 v4, s66, v13
    v_mfma_f32_16x16x32_bf16 v[192:195], a[180:183], a[28:31], v[192:195]
    s_mov_b32 s44, s12
    s_mov_b32 s45, s13
    s_mov_b32 s36, s14
    v_mfma_f32_16x16x32_bf16 v[188:191], a[180:183], a[24:27], v[188:191]
    ds_read_b64_tr_b16 a[170:171], v229 offset:18432
    s_mov_b32 s37, s15
    v_mfma_f32_16x16x32_bf16 v[188:191], a[176:179], a[8:11], v[188:191]
    buffer_load_dwordx4 a[40:43], v2, s[32:35], s60 offen offset:2048 sc1
    s_mov_b32 s38, 2097152
    v_mfma_f32_16x16x32_bf16 v[184:187], a[176:179], a[4:7], v[184:187]
    ds_read_b64_tr_b16 a[172:173], v229 offset:24576
    v_mfma_f32_16x16x32_bf16 v[184:187], a[180:183], a[20:23], v[184:187]
    s_waitcnt lgkmcnt(8)
    buffer_store_dwordx4 a[236:239], v2, s[32:35], s7 offen offset:3072 sc0 sc1
    v_mfma_f32_16x16x32_bf16 v[180:183], a[180:183], a[16:19], v[180:183]
    ds_read_b64_tr_b16 a[174:175], v229 offset:26624
    v_lshrrev_b32 v16, 4, v1
    v_mfma_f32_16x16x32_bf16 v[180:183], a[176:179], a[0:3], v[180:183]
    v_and_b32 v14, 15, v1
    s_waitcnt vmcnt(28) lgkmcnt(4)
    v_mfma_f32_16x16x32_bf16 v[68:71], a[160:163], a[128:131], v[68:71]
    ds_read_b64_tr_b16 a[176:177], v230 offset:16384
    v_lshrrev_b32 v15, 1, v14
    v_mfma_f32_16x16x32_bf16 v[68:71], a[164:167], a[144:147], v[68:71]
    v_xor_b32 v15, v15, v16
    v_lshlrev_b32 v15, 4, v15
    v_mfma_f32_16x16x32_bf16 v[72:75], a[164:167], a[148:151], v[72:75]
    ds_read_b64_tr_b16 a[178:179], v230 offset:18432
    v_lshl_add_u32 v8, v14, 7, v15
    v_mfma_f32_16x16x32_bf16 v[72:75], a[160:163], a[132:135], v[72:75]
    s_and_b32 s66, s56, 1
    s_lshl_b32 s66, s66, 6
    v_xor_b32 v8, s66, v8
    v_mfma_f32_16x16x32_bf16 v[76:79], a[160:163], a[136:139], v[76:79]
    ds_read_b64_tr_b16 a[180:181], v230 offset:24576
    v_xor_b32 v9, 64, v8
    v_mfma_f32_16x16x32_bf16 v[76:79], a[164:167], a[152:155], v[76:79]
    buffer_load_dwordx4 a[44:47], v2, s[32:35], s60 offen offset:3072 sc1
    v_add_u32 v10, 0x10000, v8
    v_mfma_f32_16x16x32_bf16 v[80:83], a[164:167], a[156:159], v[80:83]
    ds_read_b64_tr_b16 a[182:183], v230 offset:26624
    v_add_u32 v11, 0x10000, v9
    v_mfma_f32_16x16x32_bf16 v[80:83], a[160:163], a[140:143], v[80:83]
    s_add_u32 s60, s60, 0x1000
    v_mov_b32 v54, 0
    s_waitcnt lgkmcnt(4)
    v_mfma_f32_16x16x32_bf16 v[96:99], a[168:171], a[140:143], v[96:99]
    ds_read_b64_tr_b16 a[160:161], v231 offset:16384
    v_mfma_f32_16x16x32_bf16 v[96:99], a[172:175], a[156:159], v[96:99]
    s_waitcnt lgkmcnt(12)
    buffer_store_dwordx4 a[252:255], v2, s[32:35], s27 offen offset:3072 sc0 sc1
    v_mfma_f32_16x16x32_bf16 v[92:95], a[172:175], a[152:155], v[92:95]
    ds_read_b64_tr_b16 a[162:163], v231 offset:18432
    v_and_b32 v17, 15, v1
    v_mfma_f32_16x16x32_bf16 v[92:95], a[168:171], a[136:139], v[92:95]
    buffer_load_dwordx4 a[48:51], v2, s[32:35], s60 offen sc1
    v_lshrrev_b32 v18, 4, v1
    v_mfma_f32_16x16x32_bf16 v[88:91], a[168:171], a[132:135], v[88:91]
    ds_read_b64_tr_b16 a[164:165], v231 offset:24576
    v_xor_b32 v18, v18, v17
    v_mfma_f32_16x16x32_bf16 v[88:91], a[172:175], a[148:151], v[88:91]
    v_and_b32 v18, 7, v18
    v_lshlrev_b32 v18, 4, v18
    v_mfma_f32_16x16x32_bf16 v[84:87], a[172:175], a[144:147], v[84:87]
    ds_read_b64_tr_b16 a[166:167], v231 offset:26624
    v_lshl_add_u32 v18, v17, 7, v18
    v_mfma_f32_16x16x32_bf16 v[84:87], a[168:171], a[128:131], v[84:87]
    v_add_u32 v56, s63, v18
    s_waitcnt lgkmcnt(4)
    v_mfma_f32_16x16x32_bf16 v[100:103], a[176:179], a[128:131], v[100:103]
    ds_read_b64_tr_b16 a[168:169], v232 offset:16384
    v_xor_b32 v57, 64, v56
    v_mfma_f32_16x16x32_bf16 v[100:103], a[180:183], a[144:147], v[100:103]
    v_lshrrev_b32 v17, 3, v1
    v_xor_b32 v18, v17, v1
    v_mfma_f32_16x16x32_bf16 v[104:107], a[180:183], a[148:151], v[104:107]
    ds_read_b64_tr_b16 a[170:171], v232 offset:18432
    v_and_b32 v18, 7, v18
    v_mfma_f32_16x16x32_bf16 v[104:107], a[176:179], a[132:135], v[104:107]
    v_lshlrev_b32 v18, 4, v18
    v_lshl_add_u32 v18, v17, 7, v18
    v_mfma_f32_16x16x32_bf16 v[108:111], a[176:179], a[136:139], v[108:111]
    ds_read_b64_tr_b16 a[172:173], v232 offset:24576
    v_add_u32 v58, s63, v18
    v_mfma_f32_16x16x32_bf16 v[108:111], a[180:183], a[152:155], v[108:111]
    buffer_load_dwordx4 a[52:55], v2, s[32:35], s60 offen offset:1024 sc1
    v_mfma_f32_16x16x32_bf16 v[112:115], a[180:183], a[156:159], v[112:115]
    ds_read_b64_tr_b16 a[174:175], v232 offset:26624
    v_mfma_f32_16x16x32_bf16 v[112:115], a[176:179], a[140:143], v[112:115]
    s_waitcnt lgkmcnt(4)
    v_mfma_f32_16x16x32_bf16 v[128:131], a[160:163], a[140:143], v[128:131]
    ds_read_b64_tr_b16 a[176:177], v233 offset:16384
    v_mfma_f32_16x16x32_bf16 v[128:131], a[164:167], a[156:159], v[128:131]
    v_mfma_f32_16x16x32_bf16 v[124:127], a[164:167], a[152:155], v[124:127]
    ds_read_b64_tr_b16 a[178:179], v233 offset:18432
    v_mfma_f32_16x16x32_bf16 v[124:127], a[160:163], a[136:139], v[124:127]
    buffer_load_dwordx4 a[56:59], v2, s[32:35], s60 offen offset:2048 sc1
    v_mfma_f32_16x16x32_bf16 v[120:123], a[160:163], a[132:135], v[120:123]
    ds_read_b64_tr_b16 a[180:181], v233 offset:24576
    v_mfma_f32_16x16x32_bf16 v[120:123], a[164:167], a[148:151], v[120:123]
    buffer_load_dwordx4 a[60:63], v2, s[32:35], s60 offen offset:3072 sc1
    v_mfma_f32_16x16x32_bf16 v[116:119], a[164:167], a[144:147], v[116:119]
    ds_read_b64_tr_b16 a[182:183], v233 offset:26624
    v_mfma_f32_16x16x32_bf16 v[116:119], a[160:163], a[128:131], v[116:119]
    s_add_u32 s60, s60, 0x1000
    s_waitcnt lgkmcnt(4)
    v_mfma_f32_16x16x32_bf16 v[132:135], a[168:171], a[128:131], v[132:135]
    ds_read_b64_tr_b16 a[160:161], v234 offset:16384
    v_mfma_f32_16x16x32_bf16 v[132:135], a[172:175], a[144:147], v[132:135]
    v_mfma_f32_16x16x32_bf16 v[136:139], a[172:175], a[148:151], v[136:139]
    ds_read_b64_tr_b16 a[162:163], v234 offset:18432
    v_mfma_f32_16x16x32_bf16 v[136:139], a[168:171], a[132:135], v[136:139]
    buffer_load_dwordx4 a[184:187], v2, s[32:35], s60 offen sc1
    v_mfma_f32_16x16x32_bf16 v[140:143], a[168:171], a[136:139], v[140:143]
    ds_read_b64_tr_b16 a[164:165], v234 offset:24576
    v_mfma_f32_16x16x32_bf16 v[140:143], a[172:175], a[152:155], v[140:143]
    v_mfma_f32_16x16x32_bf16 v[144:147], a[172:175], a[156:159], v[144:147]
    ds_read_b64_tr_b16 a[166:167], v234 offset:26624
    v_mfma_f32_16x16x32_bf16 v[144:147], a[168:171], a[140:143], v[144:147]
    s_waitcnt lgkmcnt(4)
    v_mfma_f32_16x16x32_bf16 v[160:163], a[176:179], a[140:143], v[160:163]
    ds_read_b64_tr_b16 a[168:169], v235 offset:16384
    v_mfma_f32_16x16x32_bf16 v[160:163], a[180:183], a[156:159], v[160:163]
    v_mfma_f32_16x16x32_bf16 v[156:159], a[180:183], a[152:155], v[156:159]
    ds_read_b64_tr_b16 a[170:171], v235 offset:18432
    v_mfma_f32_16x16x32_bf16 v[156:159], a[176:179], a[136:139], v[156:159]
    buffer_load_dwordx4 a[188:191], v2, s[32:35], s60 offen offset:1024 sc1
    v_mfma_f32_16x16x32_bf16 v[152:155], a[176:179], a[132:135], v[152:155]
    ds_read_b64_tr_b16 a[172:173], v235 offset:24576
    v_mfma_f32_16x16x32_bf16 v[152:155], a[180:183], a[148:151], v[152:155]
    buffer_load_dwordx4 a[192:195], v2, s[32:35], s60 offen offset:2048 sc1
    v_mfma_f32_16x16x32_bf16 v[148:151], a[180:183], a[144:147], v[148:151]
    ds_read_b64_tr_b16 a[174:175], v235 offset:26624
    v_mfma_f32_16x16x32_bf16 v[148:151], a[176:179], a[128:131], v[148:151]
    s_waitcnt vmcnt(23) lgkmcnt(4)
    s_barrier
    v_mfma_f32_16x16x32_bf16 v[164:167], a[160:163], a[128:131], v[164:167]
    ds_read_b64_tr_b16 a[176:177], v228 offset:32768
    v_mfma_f32_16x16x32_bf16 v[164:167], a[164:167], a[144:147], v[164:167]
    v_mfma_f32_16x16x32_bf16 v[168:171], a[164:167], a[148:151], v[168:171]
    ds_read_b64_tr_b16 a[178:179], v228 offset:34816
    v_mfma_f32_16x16x32_bf16 v[168:171], a[160:163], a[132:135], v[168:171]
    buffer_load_dwordx4 a[196:199], v2, s[32:35], s60 offen offset:3072 sc1
    s_add_u32 s60, s60, 0x1000
    v_mfma_f32_16x16x32_bf16 v[172:175], a[160:163], a[136:139], v[172:175]
    ds_read_b64_tr_b16 a[180:181], v228 offset:40960
    v_mfma_f32_16x16x32_bf16 v[172:175], a[164:167], a[152:155], v[172:175]
    s_waitcnt vmcnt(8)
    v_or_b32_e64 v250, s3, 5
    s_mov_b64 exec, 1
    buffer_store_dword v250, v3, s[52:55], s20 offen sc0 sc1
    s_mov_b64 exec, -1
    v_mfma_f32_16x16x32_bf16 v[176:179], a[164:167], a[156:159], v[176:179]
    ds_read_b64_tr_b16 a[182:183], v228 offset:43008
    v_accvgpr_read_b32 v14, a221
    v_mfma_f32_16x16x32_bf16 v[176:179], a[160:163], a[140:143], v[176:179]
    buffer_load_dwordx4 a[64:67], v2, s[32:35], s60 offen sc1
    s_waitcnt lgkmcnt(4)
    v_mfma_f32_16x16x32_bf16 v[192:195], a[168:171], a[140:143], v[192:195]
    ds_read_b64_tr_b16 a[160:161], v229 offset:32768
    v_lshrrev_b32 v12, 1, v2
    v_mfma_f32_16x16x32_bf16 v[192:195], a[172:175], a[156:159], v[192:195]
    v_add_u32 v12, s63, v12
    v_mfma_f32_16x16x32_bf16 v[188:191], a[172:175], a[152:155], v[188:191]
    ds_read_b64_tr_b16 a[162:163], v229 offset:34816
    v_mfma_f32_16x16x32_bf16 v[188:191], a[168:171], a[136:139], v[188:191]
    ds_write_b64 v12, a[218:219]
    v_mfma_f32_16x16x32_bf16 v[184:187], a[168:171], a[132:135], v[184:187]
    ds_read_b64_tr_b16 a[164:165], v229 offset:40960
    v_bfe_u32 v12, v14, 11, 6
    v_mfma_f32_16x16x32_bf16 v[184:187], a[172:175], a[148:151], v[184:187]
    buffer_load_dwordx4 a[68:71], v2, s[32:35], s60 offen offset:1024 sc1
    v_lshl_add_u32 v12, v12, 3, s63
    v_mfma_f32_16x16x32_bf16 v[180:183], a[172:175], a[144:147], v[180:183]
    ds_read_b64_tr_b16 a[166:167], v229 offset:43008
    ds_read_b64 v[36:37], v12 offset:0
    v_mfma_f32_16x16x32_bf16 v[180:183], a[168:171], a[128:131], v[180:183]
    ds_read_b64 v[38:39], v12 offset:256
    s_waitcnt vmcnt(17) lgkmcnt(7)
    v_mfma_f32_16x16x32_bf16 v[68:71], a[176:179], a[96:99], v[68:71]
    ds_read_b64_tr_b16 a[168:169], v230 offset:32768
    ds_read_b64 v[40:41], v12 offset:16
    v_mfma_f32_16x16x32_bf16 v[68:71], a[180:183], a[112:115], v[68:71]
    ds_read_b64 v[42:43], v12 offset:272
    ds_read_b64 v[44:45], v12 offset:32
    v_mfma_f32_16x16x32_bf16 v[72:75], a[180:183], a[116:119], v[72:75]
    ds_read_b64_tr_b16 a[170:171], v230 offset:34816
    ds_read_b64 v[46:47], v12 offset:288
    v_mfma_f32_16x16x32_bf16 v[72:75], a[176:179], a[100:103], v[72:75]
    buffer_load_dwordx4 a[72:75], v2, s[32:35], s60 offen offset:2048 sc1
    ds_read_b64 v[48:49], v12 offset:48
    v_mfma_f32_16x16x32_bf16 v[76:79], a[176:179], a[104:107], v[76:79]
    ds_read_b64_tr_b16 a[172:173], v230 offset:40960
    ds_read_b64 v[50:51], v12 offset:304
    v_mfma_f32_16x16x32_bf16 v[76:79], a[180:183], a[120:123], v[76:79]
    buffer_load_dwordx4 a[76:79], v2, s[32:35], s60 offen offset:3072 sc1
    v_accvgpr_read_b32 v20, a200
    v_mfma_f32_16x16x32_bf16 v[80:83], a[180:183], a[124:127], v[80:83]
    ds_read_b64_tr_b16 a[174:175], v230 offset:43008
    v_accvgpr_read_b32 v21, a201
    v_mfma_f32_16x16x32_bf16 v[80:83], a[176:179], a[108:111], v[80:83]
    s_add_u32 s60, s60, 0x1000
    v_accvgpr_read_b32 v22, a202
    s_waitcnt lgkmcnt(12)
    v_mfma_f32_16x16x32_bf16 v[96:99], a[160:163], a[108:111], v[96:99]
    ds_read_b64_tr_b16 a[176:177], v231 offset:32768
    v_accvgpr_read_b32 v23, a203
    v_mfma_f32_16x16x32_bf16 v[96:99], a[164:167], a[124:127], v[96:99]
    s_add_u32 s61, s5, 917504
    s_add_u32 m0, s64, 81920
    v_accvgpr_read_b32 v24, a204
    v_mfma_f32_16x16x32_bf16 v[92:95], a[164:167], a[120:123], v[92:95]
    ds_read_b64_tr_b16 a[178:179], v231 offset:34816
    v_accvgpr_read_b32 v25, a205
    v_mfma_f32_16x16x32_bf16 v[92:95], a[160:163], a[104:107], v[92:95]
    buffer_load_dwordx4 v242, s[48:51], s61 offen lds
    v_accvgpr_read_b32 v26, a206
    v_mfma_f32_16x16x32_bf16 v[88:91], a[160:163], a[100:103], v[88:91]
    ds_read_b64_tr_b16 a[180:181], v231 offset:40960
    v_accvgpr_read_b32 v27, a207
    v_mfma_f32_16x16x32_bf16 v[88:91], a[164:167], a[116:119], v[88:91]
    buffer_load_dwordx4 v243, s[48:51], s61 offen offset:1024 lds
    v_accvgpr_read_b32 v28, a208
    v_mfma_f32_16x16x32_bf16 v[84:87], a[164:167], a[112:115], v[84:87]
    ds_read_b64_tr_b16 a[182:183], v231 offset:43008
    v_accvgpr_read_b32 v29, a209
    v_mfma_f32_16x16x32_bf16 v[84:87], a[160:163], a[96:99], v[84:87]
    v_accvgpr_read_b32 v30, a210
    s_waitcnt lgkmcnt(4)
    v_mfma_f32_16x16x32_bf16 v[100:103], a[168:171], a[96:99], v[100:103]
    ds_read_b64_tr_b16 a[160:161], v232 offset:32768
    v_accvgpr_read_b32 v31, a211
    v_mfma_f32_16x16x32_bf16 v[100:103], a[172:175], a[112:115], v[100:103]
    v_accvgpr_read_b32 v32, a212
    v_accvgpr_read_b32 v33, a213
    v_mfma_f32_16x16x32_bf16 v[104:107], a[172:175], a[116:119], v[104:107]
    ds_read_b64_tr_b16 a[162:163], v232 offset:34816
    v_accvgpr_read_b32 v34, a214
    v_mfma_f32_16x16x32_bf16 v[104:107], a[168:171], a[100:103], v[104:107]
    v_accvgpr_read_b32 v35, a215
    v_accvgpr_read_b32 v52, a216
    v_mfma_f32_16x16x32_bf16 v[108:111], a[168:171], a[104:107], v[108:111]
    ds_read_b64_tr_b16 a[164:165], v232 offset:40960
    v_accvgpr_read_b32 v53, a217
    v_mfma_f32_16x16x32_bf16 v[108:111], a[172:175], a[120:123], v[108:111]
    buffer_load_dwordx4 v244, s[48:51], s61 offen offset:2048 lds
    v_mfma_f32_16x16x32_bf16 v[112:115], a[172:175], a[124:127], v[112:115]
    ds_read_b64_tr_b16 a[166:167], v232 offset:43008
    v_mfma_f32_16x16x32_bf16 v[112:115], a[168:171], a[108:111], v[112:115]
    s_waitcnt lgkmcnt(4)
    v_mfma_f32_16x16x32_bf16 v[128:131], a[176:179], a[108:111], v[128:131]
    ds_read_b64_tr_b16 a[168:169], v233 offset:32768
    v_mfma_f32_16x16x32_bf16 v[128:131], a[180:183], a[124:127], v[128:131]
    s_and_b32 s66, s59, 127
    v_mov_b32 v62, s66
    s_getpc_b64 s[72:73]
L_pc3:
    s_add_u32 s72, s72, fa_late-L_pc3
    s_addc_u32 s73, s73, (fa_late-L_pc3)>>32
    v_lshlrev_b32 v63, 7, v62
    v_min_u32 v63, fa_last-fa_late-4, v63
    v_mov_b32 v61, s73
    v_add_co_u32 v60, vcc, s72, v63
    s_nop 1
    v_addc_co_u32 v61, vcc, 0, v61, vcc
    v_mfma_f32_16x16x32_bf16 v[124:127], a[180:183], a[120:123], v[124:127]
    ds_read_b64_tr_b16 a[170:171], v233 offset:34816
    v_mfma_f32_16x16x32_bf16 v[124:127], a[176:179], a[104:107], v[124:127]
    buffer_load_dwordx4 v245, s[48:51], s61 offen offset:3072 lds
    global_load_dword v62, v[60:61], off
    v_mfma_f32_16x16x32_bf16 v[120:123], a[176:179], a[100:103], v[120:123]
    ds_read_b64_tr_b16 a[172:173], v233 offset:40960
    v_mfma_f32_16x16x32_bf16 v[120:123], a[180:183], a[116:119], v[120:123]
    s_xor_b32 s61, s8, 0
    s_add_u32 m0, s68, 98304
    v_mfma_f32_16x16x32_bf16 v[116:119], a[180:183], a[112:115], v[116:119]
    ds_read_b64_tr_b16 a[174:175], v233 offset:43008
    v_mfma_f32_16x16x32_bf16 v[116:119], a[176:179], a[96:99], v[116:119]
    buffer_load_dwordx4 v4, s[44:47], s61 offen lds
    s_waitcnt lgkmcnt(4)
    v_mfma_f32_16x16x32_bf16 v[132:135], a[160:163], a[96:99], v[132:135]
    ds_read_b64_tr_b16 a[176:177], v234 offset:32768
    v_mfma_f32_16x16x32_bf16 v[132:135], a[164:167], a[112:115], v[132:135]
    v_mfma_f32_16x16x32_bf16 v[136:139], a[164:167], a[116:119], v[136:139]
    ds_read_b64_tr_b16 a[178:179], v234 offset:34816
    v_mfma_f32_16x16x32_bf16 v[136:139], a[160:163], a[100:103], v[136:139]
    v_mfma_f32_16x16x32_bf16 v[140:143], a[160:163], a[104:107], v[140:143]
    ds_read_b64_tr_b16 a[180:181], v234 offset:40960
    v_mfma_f32_16x16x32_bf16 v[140:143], a[164:167], a[120:123], v[140:143]
    s_xor_b32 s61, s9, 0
    s_add_u32 m0, s68, 102400
    v_mfma_f32_16x16x32_bf16 v[144:147], a[164:167], a[124:127], v[144:147]
    ds_read_b64_tr_b16 a[182:183], v234 offset:43008
    v_mfma_f32_16x16x32_bf16 v[144:147], a[160:163], a[108:111], v[144:147]
    buffer_load_dwordx4 v4, s[44:47], s61 offen lds
    s_waitcnt lgkmcnt(4)
    v_mfma_f32_16x16x32_bf16 v[160:163], a[168:171], a[108:111], v[160:163]
    ds_read_b64_tr_b16 a[160:161], v235 offset:32768
    v_mfma_f32_16x16x32_bf16 v[160:163], a[172:175], a[124:127], v[160:163]
    v_mfma_f32_16x16x32_bf16 v[156:159], a[172:175], a[120:123], v[156:159]
    ds_read_b64_tr_b16 a[162:163], v235 offset:34816
    v_mfma_f32_16x16x32_bf16 v[156:159], a[168:171], a[104:107], v[156:159]
    buffer_load_dwordx4 a[80:83], v2, s[32:35], s60 offen sc1
    v_mfma_f32_16x16x32_bf16 v[152:155], a[168:171], a[100:103], v[152:155]
    ds_read_b64_tr_b16 a[164:165], v235 offset:40960
    v_mfma_f32_16x16x32_bf16 v[152:155], a[172:175], a[116:119], v[152:155]
    buffer_load_dwordx4 a[84:87], v2, s[32:35], s60 offen offset:1024 sc1
    v_mfma_f32_16x16x32_bf16 v[148:151], a[172:175], a[112:115], v[148:151]
    ds_read_b64_tr_b16 a[166:167], v235 offset:43008
    v_mfma_f32_16x16x32_bf16 v[148:151], a[168:171], a[96:99], v[148:151]
    s_waitcnt lgkmcnt(4)
    v_mfma_f32_16x16x32_bf16 v[164:167], a[176:179], a[96:99], v[164:167]
    ds_read_b64_tr_b16 a[168:169], v228 offset:49152
    v_mfma_f32_16x16x32_bf16 v[164:167], a[180:183], a[112:115], v[164:167]
    v_mfma_f32_16x16x32_bf16 v[168:171], a[180:183], a[116:119], v[168:171]
    ds_read_b64_tr_b16 a[170:171], v228 offset:51200
    v_mfma_f32_16x16x32_bf16 v[168:171], a[176:179], a[100:103], v[168:171]
    buffer_load_dwordx4 a[88:91], v2, s[32:35], s60 offen offset:2048 sc1
    v_mfma_f32_16x16x32_bf16 v[172:175], a[176:179], a[104:107], v[172:175]
    ds_read_b64_tr_b16 a[172:173], v228 offset:57344
    v_mfma_f32_16x16x32_bf16 v[172:175], a[180:183], a[120:123], v[172:175]
    buffer_load_dwordx4 a[92:95], v2, s[32:35], s60 offen offset:3072 sc1
    v_mfma_f32_16x16x32_bf16 v[176:179], a[180:183], a[124:127], v[176:179]
    ds_read_b64_tr_b16 a[174:175], v228 offset:59392
    v_xor_b32 v228, 0x10000, v228
    v_mfma_f32_16x16x32_bf16 v[176:179], a[176:179], a[108:111], v[176:179]
    s_add_u32 s60, s60, 0x1000
    s_waitcnt lgkmcnt(4)
    v_mfma_f32_16x16x32_bf16 v[192:195], a[160:163], a[108:111], v[192:195]
    ds_read_b64_tr_b16 a[176:177], v229 offset:49152
    v_mfma_f32_16x16x32_bf16 v[192:195], a[164:167], a[124:127], v[192:195]
    buffer_load_dword v252, v249, s[52:55], 0 offen sc0 sc1
    v_mfma_f32_16x16x32_bf16 v[188:191], a[164:167], a[120:123], v[188:191]
    ds_read_b64_tr_b16 a[178:179], v229 offset:51200
    v_mfma_f32_16x16x32_bf16 v[188:191], a[160:163], a[104:107], v[188:191]
    v_mfma_f32_16x16x32_bf16 v[184:187], a[160:163], a[100:103], v[184:187]
    ds_read_b64_tr_b16 a[180:181], v229 offset:57344
    v_mfma_f32_16x16x32_bf16 v[184:187], a[164:167], a[116:119], v[184:187]
    buffer_load_dwordx4 a[0:3], v2, s[32:35], s60 offen sc1
    v_mfma_f32_16x16x32_bf16 v[180:183], a[164:167], a[112:115], v[180:183]
    ds_read_b64_tr_b16 a[182:183], v229 offset:59392
    v_xor_b32 v229, 0x10000, v229
    v_mfma_f32_16x16x32_bf16 v[180:183], a[160:163], a[96:99], v[180:183]
    s_waitcnt vmcnt(22) lgkmcnt(4)
    v_mfma_f32_16x16x32_bf16 v[68:71], a[168:171], a[32:35], v[68:71]
    ds_read_b64_tr_b16 a[160:161], v230 offset:49152
    v_mfma_f32_16x16x32_bf16 v[68:71], a[172:175], a[48:51], v[68:71]
    v_mfma_f32_16x16x32_bf16 v[72:75], a[172:175], a[52:55], v[72:75]
    ds_read_b64_tr_b16 a[162:163], v230 offset:51200
    v_mfma_f32_16x16x32_bf16 v[72:75], a[168:171], a[36:39], v[72:75]
    buffer_load_dwordx4 a[4:7], v2, s[32:35], s60 offen offset:1024 sc1
    v_mfma_f32_16x16x32_bf16 v[76:79], a[168:171], a[40:43], v[76:79]
    ds_read_b64_tr_b16 a[164:165], v230 offset:57344
    v_mfma_f32_16x16x32_bf16 v[76:79], a[172:175], a[56:59], v[76:79]
    buffer_load_dwordx4 a[8:11], v2, s[32:35], s60 offen offset:2048 sc1
    v_mfma_f32_16x16x32_bf16 v[80:83], a[172:175], a[60:63], v[80:83]
    ds_read_b64_tr_b16 a[166:167], v230 offset:59392
    v_xor_b32 v230, 0x10000, v230
    v_mfma_f32_16x16x32_bf16 v[80:83], a[168:171], a[44:47], v[80:83]
    s_waitcnt lgkmcnt(4)
    v_mfma_f32_16x16x32_bf16 v[96:99], a[176:179], a[44:47], v[96:99]
    ds_read_b64_tr_b16 a[168:169], v231 offset:49152
    v_mfma_f32_16x16x32_bf16 v[96:99], a[180:183], a[60:63], v[96:99]
    v_mfma_f32_16x16x32_bf16 v[92:95], a[180:183], a[56:59], v[92:95]
    ds_read_b64_tr_b16 a[170:171], v231 offset:51200
    v_mfma_f32_16x16x32_bf16 v[92:95], a[176:179], a[40:43], v[92:95]
    buffer_load_dwordx4 a[12:15], v2, s[32:35], s60 offen offset:3072 sc1
    s_add_u32 s60, s60, 0x1000
    v_mfma_f32_16x16x32_bf16 v[88:91], a[176:179], a[36:39], v[88:91]
    ds_read_b64_tr_b16 a[172:173], v231 offset:57344
    v_mfma_f32_16x16x32_bf16 v[88:91], a[180:183], a[52:55], v[88:91]
    v_mfma_f32_16x16x32_bf16 v[84:87], a[180:183], a[48:51], v[84:87]
    ds_read_b64_tr_b16 a[174:175], v231 offset:59392
    v_xor_b32 v231, 0x10000, v231
    v_mfma_f32_16x16x32_bf16 v[84:87], a[176:179], a[32:35], v[84:87]
    s_waitcnt lgkmcnt(4)
    v_mfma_f32_16x16x32_bf16 v[100:103], a[160:163], a[32:35], v[100:103]
    ds_read_b64_tr_b16 a[176:177], v232 offset:49152
    v_mfma_f32_16x16x32_bf16 v[100:103], a[164:167], a[48:51], v[100:103]
    s_xor_b32 s61, s10, 0
    s_add_u32 m0, s68, 106496
    v_mfma_f32_16x16x32_bf16 v[104:107], a[164:167], a[52:55], v[104:107]
    ds_read_b64_tr_b16 a[178:179], v232 offset:51200
    v_mfma_f32_16x16x32_bf16 v[104:107], a[160:163], a[36:39], v[104:107]
    buffer_load_dwordx4 v4, s[44:47], s61 offen lds
    v_mfma_f32_16x16x32_bf16 v[108:111], a[160:163], a[40:43], v[108:111]
    ds_read_b64_tr_b16 a[180:181], v232 offset:57344
    v_mfma_f32_16x16x32_bf16 v[108:111], a[164:167], a[56:59], v[108:111]
    s_xor_b32 s61, s11, 0
    s_add_u32 m0, s68, 110592
    v_mfma_f32_16x16x32_bf16 v[112:115], a[164:167], a[60:63], v[112:115]
    ds_read_b64_tr_b16 a[182:183], v232 offset:59392
    v_xor_b32 v232, 0x10000, v232
    v_mfma_f32_16x16x32_bf16 v[112:115], a[160:163], a[44:47], v[112:115]
    buffer_load_dwordx4 v4, s[44:47], s61 offen lds
    s_waitcnt lgkmcnt(4)
    v_mfma_f32_16x16x32_bf16 v[128:131], a[168:171], a[44:47], v[128:131]
    ds_read_b64_tr_b16 a[160:161], v233 offset:49152
    v_mfma_f32_16x16x32_bf16 v[128:131], a[172:175], a[60:63], v[128:131]
    s_xor_b32 s61, s8, 128
    s_add_u32 m0, s68, 114688
    v_mfma_f32_16x16x32_bf16 v[124:127], a[172:175], a[56:59], v[124:127]
    ds_read_b64_tr_b16 a[162:163], v233 offset:51200
    v_mfma_f32_16x16x32_bf16 v[124:127], a[168:171], a[40:43], v[124:127]
    buffer_load_dwordx4 v4, s[44:47], s61 offen lds
    v_mfma_f32_16x16x32_bf16 v[120:123], a[168:171], a[36:39], v[120:123]
    ds_read_b64_tr_b16 a[164:165], v233 offset:57344
    v_mfma_f32_16x16x32_bf16 v[120:123], a[172:175], a[52:55], v[120:123]
    s_xor_b32 s61, s9, 128
    s_add_u32 m0, s68, 118784
    v_mfma_f32_16x16x32_bf16 v[116:119], a[172:175], a[48:51], v[116:119]
    ds_read_b64_tr_b16 a[166:167], v233 offset:59392
    v_xor_b32 v233, 0x10000, v233
    v_mfma_f32_16x16x32_bf16 v[116:119], a[168:171], a[32:35], v[116:119]
    buffer_load_dwordx4 v4, s[44:47], s61 offen lds
fa_late:
    s_waitcnt lgkmcnt(4)
    v_mfma_f32_16x16x32_bf16 v[132:135], a[176:179], a[32:35], v[132:135]
    ds_read_b64_tr_b16 a[168:169], v234 offset:49152
    v_mfma_f32_16x16x32_bf16 v[132:135], a[180:183], a[48:51], v[132:135]
    s_add_u32 s21, s3, 5
    s_waitcnt vmcnt(8)
    v_subrev_u32 v252, s21, v252
    v_cmp_lt_u32 vcc, 10, v252
    s_cbranch_vccnz fa_f4_slow
fa_f4_ok:
    v_mfma_f32_16x16x32_bf16 v[136:139], a[180:183], a[52:55], v[136:139]
    ds_read_b64_tr_b16 a[170:171], v234 offset:51200
    s_add_u32 s40, s22, 0x2000000
    s_addc_u32 s41, s23, 0
    v_mfma_f32_16x16x32_bf16 v[136:139], a[176:179], a[36:39], v[136:139]
    s_mov_b32 s42, 16777216
    s_lshl_b32 s67, s20, 2
    v_and_b32 v249, 3, v1
    v_mfma_f32_16x16x32_bf16 v[140:143], a[176:179], a[40:43], v[140:143]
    ds_read_b64_tr_b16 a[172:173], v234 offset:57344
    v_lshlrev_b32 v249, 16, v249
    v_mfma_f32_16x16x32_bf16 v[140:143], a[180:183], a[56:59], v[140:143]
    s_xor_b32 s62, s28, 4096
    s_add_u32 s62, s62, s60
    v_xor_b32 v249, s20, v249
    v_mfma_f32_16x16x32_bf16 v[144:147], a[180:183], a[60:63], v[144:147]
    ds_read_b64_tr_b16 a[174:175], v234 offset:59392
    v_xor_b32 v234, 0x10000, v234
    v_mfma_f32_16x16x32_bf16 v[144:147], a[176:179], a[44:47], v[144:147]
    buffer_load_dwordx4 a[16:19], v2, s[32:35], s62 offen sc1
    s_waitcnt lgkmcnt(4)
    v_mfma_f32_16x16x32_bf16 v[160:163], a[160:163], a[44:47], v[160:163]
    ds_read_b64_tr_b16 a[176:177], v235 offset:49152
    v_mfma_f32_16x16x32_bf16 v[160:163], a[164:167], a[60:63], v[160:163]
    buffer_load_dword v252, v249, s[52:55], 0 offen sc0 sc1
    v_mfma_f32_16x16x32_bf16 v[156:159], a[164:167], a[56:59], v[156:159]
    ds_read_b64_tr_b16 a[178:179], v235 offset:51200
    v_mfma_f32_16x16x32_bf16 v[156:159], a[160:163], a[40:43], v[156:159]
    buffer_load_dwordx4 a[20:23], v2, s[32:35], s62 offen offset:1024 sc1
    v_mfma_f32_16x16x32_bf16 v[152:155], a[160:163], a[36:39], v[152:155]
    ds_read_b64_tr_b16 a[180:181], v235 offset:57344
    v_mfma_f32_16x16x32_bf16 v[152:155], a[164:167], a[52:55], v[152:155]
    buffer_load_dwordx4 a[24:27], v2, s[32:35], s62 offen offset:2048 sc1
    v_mfma_f32_16x16x32_bf16 v[148:151], a[164:167], a[48:51], v[148:151]
    ds_read_b64_tr_b16 a[182:183], v235 offset:59392
    v_xor_b32 v235, 0x10000, v235
    v_mfma_f32_16x16x32_bf16 v[148:151], a[160:163], a[32:35], v[148:151]
    s_waitcnt lgkmcnt(4)
    v_mfma_f32_16x16x32_bf16 v[164:167], a[168:171], a[32:35], v[164:167]
    ds_read_b64_tr_b16 a[160:161], v228 offset:0
    v_mfma_f32_16x16x32_bf16 v[164:167], a[172:175], a[48:51], v[164:167]
    v_mfma_f32_16x16x32_bf16 v[168:171], a[172:175], a[52:55], v[168:171]
    ds_read_b64_tr_b16 a[162:163], v228 offset:2048
    v_mfma_f32_16x16x32_bf16 v[168:171], a[168:171], a[36:39], v[168:171]
    buffer_load_dwordx4 a[28:31], v2, s[32:35], s62 offen offset:3072 sc1
    v_mfma_f32_16x16x32_bf16 v[172:175], a[168:171], a[40:43], v[172:175]
    ds_read_b64_tr_b16 a[164:165], v228 offset:8192
    v_mfma_f32_16x16x32_bf16 v[172:175], a[172:175], a[56:59], v[172:175]
    v_mfma_f32_16x16x32_bf16 v[176:179], a[172:175], a[60:63], v[176:179]
    ds_read_b64_tr_b16 a[166:167], v228 offset:10240
    v_mfma_f32_16x16x32_bf16 v[176:179], a[168:171], a[44:47], v[176:179]
    s_waitcnt lgkmcnt(4)
    v_mfma_f32_16x16x32_bf16 v[192:195], a[176:179], a[44:47], v[192:195]
    ds_read_b64_tr_b16 a[168:169], v229 offset:0
    v_mfma_f32_16x16x32_bf16 v[192:195], a[180:183], a[60:63], v[192:195]
    s_xor_b32 s61, s10, 128
    s_add_u32 m0, s68, 122880
    v_mfma_f32_16x16x32_bf16 v[188:191], a[180:183], a[56:59], v[188:191]
    ds_read_b64_tr_b16 a[170:171], v229 offset:2048
    v_mfma_f32_16x16x32_bf16 v[188:191], a[176:179], a[40:43], v[188:191]
    buffer_load_dwordx4 v4, s[44:47], s61 offen lds
    v_mfma_f32_16x16x32_bf16 v[184:187], a[176:179], a[36:39], v[184:187]
    ds_read_b64_tr_b16 a[172:173], v229 offset:8192
    v_mfma_f32_16x16x32_bf16 v[184:187], a[180:183], a[52:55], v[184:187]
    s_xor_b32 s61, s11, 128
    s_add_u32 m0, s68, 126976
    v_mfma_f32_16x16x32_bf16 v[180:183], a[180:183], a[48:51], v[180:183]
    ds_read_b64_tr_b16 a[174:175], v229 offset:10240
    v_mfma_f32_16x16x32_bf16 v[180:183], a[176:179], a[32:35], v[180:183]
    buffer_load_dwordx4 v4, s[44:47], s61 offen lds
    s_waitcnt vmcnt(27) lgkmcnt(4)
    v_mfma_f32_16x16x32_bf16 v[68:71], a[160:163], a[184:187], v[68:71]
    ds_read_b64_tr_b16 a[176:177], v230 offset:0
    v_mfma_f32_16x16x32_bf16 v[68:71], a[164:167], a[64:67], v[68:71]
    s_xor_b32 s62, s28, 8192
    s_add_u32 s62, s62, s60
    v_mfma_f32_16x16x32_bf16 v[72:75], a[164:167], a[68:71], v[72:75]
    ds_read_b64_tr_b16 a[178:179], v230 offset:2048
    v_mfma_f32_16x16x32_bf16 v[72:75], a[160:163], a[188:191], v[72:75]
    buffer_load_dwordx4 a[128:131], v2, s[32:35], s62 offen sc1
    v_mfma_f32_16x16x32_bf16 v[76:79], a[160:163], a[192:195], v[76:79]
    ds_read_b64_tr_b16 a[180:181], v230 offset:8192
    v_mfma_f32_16x16x32_bf16 v[76:79], a[164:167], a[72:75], v[76:79]
    buffer_load_dwordx4 a[132:135], v2, s[32:35], s62 offen offset:1024 sc1
    v_mfma_f32_16x16x32_bf16 v[80:83], a[164:167], a[76:79], v[80:83]
    ds_read_b64_tr_b16 a[182:183], v230 offset:10240
    v_mfma_f32_16x16x32_bf16 v[80:83], a[160:163], a[196:199], v[80:83]
    s_waitcnt lgkmcnt(4)
    v_mfma_f32_16x16x32_bf16 v[96:99], a[168:171], a[196:199], v[96:99]
    ds_read_b64_tr_b16 a[160:161], v231 offset:0
    v_mfma_f32_16x16x32_bf16 v[96:99], a[172:175], a[76:79], v[96:99]
    v_mfma_f32_16x16x32_bf16 v[92:95], a[172:175], a[72:75], v[92:95]
    ds_read_b64_tr_b16 a[162:163], v231 offset:2048
    v_mfma_f32_16x16x32_bf16 v[92:95], a[168:171], a[192:195], v[92:95]
    v_mfma_f32_16x16x32_bf16 v[88:91], a[168:171], a[188:191], v[88:91]
    ds_read_b64_tr_b16 a[164:165], v231 offset:8192
    v_mfma_f32_16x16x32_bf16 v[88:91], a[172:175], a[68:71], v[88:91]
    buffer_load_dwordx4 a[136:139], v2, s[32:35], s62 offen offset:2048 sc1
    v_mfma_f32_16x16x32_bf16 v[84:87], a[172:175], a[64:67], v[84:87]
    ds_read_b64_tr_b16 a[166:167], v231 offset:10240
    v_mfma_f32_16x16x32_bf16 v[84:87], a[168:171], a[184:187], v[84:87]
    s_waitcnt lgkmcnt(4)
    v_mfma_f32_16x16x32_bf16 v[100:103], a[176:179], a[184:187], v[100:103]
    ds_read_b64_tr_b16 a[168:169], v232 offset:0
    v_mfma_f32_16x16x32_bf16 v[100:103], a[180:183], a[64:67], v[100:103]
    v_mfma_f32_16x16x32_bf16 v[104:107], a[180:183], a[68:71], v[104:107]
    ds_read_b64_tr_b16 a[170:171], v232 offset:2048
    v_mfma_f32_16x16x32_bf16 v[104:107], a[176:179], a[188:191], v[104:107]
    buffer_load_dwordx4 a[140:143], v2, s[32:35], s62 offen offset:3072 sc1
    v_mfma_f32_16x16x32_bf16 v[108:111], a[176:179], a[192:195], v[108:111]
    ds_read_b64_tr_b16 a[172:173], v232 offset:8192
    v_mfma_f32_16x16x32_bf16 v[108:111], a[180:183], a[72:75], v[108:111]
    s_xor_b32 s62, s28, 12288
    s_add_u32 s62, s62, s60
    v_mfma_f32_16x16x32_bf16 v[112:115], a[180:183], a[76:79], v[112:115]
    ds_read_b64_tr_b16 a[174:175], v232 offset:10240
    v_mfma_f32_16x16x32_bf16 v[112:115], a[176:179], a[196:199], v[112:115]
    buffer_load_dwordx4 a[144:147], v2, s[32:35], s62 offen sc1
    s_waitcnt lgkmcnt(4)
    v_mfma_f32_16x16x32_bf16 v[128:131], a[160:163], a[196:199], v[128:131]
    ds_read_b64_tr_b16 a[176:177], v233 offset:0
    v_mfma_f32_16x16x32_bf16 v[128:131], a[164:167], a[76:79], v[128:131]
    s_add_u32 s21, s3, 2
    s_waitcnt vmcnt(10)
    v_subrev_u32 v252, s21, v252
    v_cmp_lt_u32 vcc, 13, v252
    s_cbranch_vccnz fa_fz_slow
fa_fz_ok:
    v_mfma_f32_16x16x32_bf16 v[124:127], a[164:167], a[72:75], v[124:127]
    ds_read_b64_tr_b16 a[178:179], v233 offset:2048
    s_mov_b32 s70, 0xffff0000
    v_mfma_f32_16x16x32_bf16 v[124:127], a[160:163], a[192:195], v[124:127]
    buffer_load_dwordx4 a[148:151], v2, s[32:35], s62 offen offset:1024 sc1
    v_lshlrev_b32 v16, 16, v52
    v_mfma_f32_16x16x32_bf16 v[120:123], a[160:163], a[188:191], v[120:123]
    ds_read_b64_tr_b16 a[180:181], v233 offset:8192
    v_and_b32 v17, s70, v52
    v_mfma_f32_16x16x32_bf16 v[120:123], a[164:167], a[68:71], v[120:123]
    v_lshlrev_b32 v18, 16, v53
    v_and_b32 v19, s70, v53
    v_mfma_f32_16x16x32_bf16 v[116:119], a[164:167], a[64:67], v[116:119]
    ds_read_b64_tr_b16 a[182:183], v233 offset:10240
    v_lshlrev_b32 v14, 1, v14
    v_mfma_f32_16x16x32_bf16 v[116:119], a[160:163], a[184:187], v[116:119]
    v_lshlrev_b32 v196, 16, v20
    s_waitcnt lgkmcnt(4)
    v_mfma_f32_16x16x32_bf16 v[132:135], a[168:171], a[184:187], v[132:135]
    ds_read_b64_tr_b16 a[160:161], v234 offset:0
    v_sub_f32 v12, v196, v36
    v_mfma_f32_16x16x32_bf16 v[132:135], a[172:175], a[64:67], v[132:135]
    v_mul_f32 v12, v12, v37
    v_fmac_f32 v196, v12, v16
    v_mfma_f32_16x16x32_bf16 v[136:139], a[172:175], a[68:71], v[136:139]
    ds_read_b64_tr_b16 a[162:163], v234 offset:2048
    v_and_b32 v197, s70, v20
    v_mfma_f32_16x16x32_bf16 v[136:139], a[168:171], a[188:191], v[136:139]
    buffer_load_dwordx4 a[152:155], v2, s[32:35], s62 offen offset:2048 sc1
    v_sub_f32 v13, v197, v36
    v_mfma_f32_16x16x32_bf16 v[140:143], a[168:171], a[192:195], v[140:143]
    ds_read_b64_tr_b16 a[164:165], v234 offset:8192
    v_mul_f32 v13, v13, v37
    v_mfma_f32_16x16x32_bf16 v[140:143], a[172:175], a[72:75], v[140:143]
    buffer_load_dwordx4 a[156:159], v2, s[32:35], s62 offen offset:3072 sc1
    v_fmac_f32 v197, v13, v17
    v_mfma_f32_16x16x32_bf16 v[144:147], a[172:175], a[76:79], v[144:147]
    ds_read_b64_tr_b16 a[166:167], v234 offset:10240
    v_lshlrev_b32 v198, 16, v21
    v_mfma_f32_16x16x32_bf16 v[144:147], a[168:171], a[196:199], v[144:147]
    v_sub_f32 v12, v198, v36
    s_waitcnt lgkmcnt(4)
    v_mfma_f32_16x16x32_bf16 v[160:163], a[176:179], a[196:199], v[160:163]
    ds_read_b64_tr_b16 a[168:169], v235 offset:0
    v_mul_f32 v12, v12, v37
    v_mfma_f32_16x16x32_bf16 v[160:163], a[180:183], a[76:79], v[160:163]
    s_xor_b32 s61, s9, 256
    s_add_u32 m0, s68, 4096
    v_fmac_f32 v198, v12, v18
    v_mfma_f32_16x16x32_bf16 v[156:159], a[180:183], a[72:75], v[156:159]
    ds_read_b64_tr_b16 a[170:171], v235 offset:2048
    v_and_b32 v199, s70, v21
    v_mfma_f32_16x16x32_bf16 v[156:159], a[176:179], a[192:195], v[156:159]
    buffer_load_dwordx4 v4, s[44:47], s61 offen lds
    v_sub_f32 v13, v199, v36
    v_mfma_f32_16x16x32_bf16 v[152:155], a[176:179], a[188:191], v[152:155]
    ds_read_b64_tr_b16 a[172:173], v235 offset:8192
    v_mul_f32 v13, v13, v37
    v_mfma_f32_16x16x32_bf16 v[152:155], a[180:183], a[68:71], v[152:155]
    s_xor_b32 s62, s28, 16384
    s_add_u32 s62, s62, s60
    v_fmac_f32 v199, v13, v19
    v_mfma_f32_16x16x32_bf16 v[148:151], a[180:183], a[64:67], v[148:151]
    ds_read_b64_tr_b16 a[174:175], v235 offset:10240
    v_lshlrev_b32 v200, 16, v22
    v_mfma_f32_16x16x32_bf16 v[148:151], a[176:179], a[184:187], v[148:151]
    buffer_load_dwordx4 a[200:203], v2, s[32:35], s62 offen sc1
    s_waitcnt vmcnt(30) lgkmcnt(4)
    s_barrier
    v_mfma_f32_16x16x32_bf16 v[164:167], a[160:163], a[184:187], v[164:167]
    ds_read_b64_tr_b16 a[176:177], v228 offset:16384
    v_sub_f32 v12, v200, v38
    v_mfma_f32_16x16x32_bf16 v[164:167], a[164:167], a[64:67], v[164:167]
    v_mul_f32 v12, v12, v39
    v_fmac_f32 v200, v12, v16
    v_mfma_f32_16x16x32_bf16 v[168:171], a[164:167], a[68:71], v[168:171]
    ds_read_b64_tr_b16 a[178:179], v228 offset:18432
    v_and_b32 v201, s70, v22
    v_mfma_f32_16x16x32_bf16 v[168:171], a[160:163], a[188:191], v[168:171]
    buffer_load_dwordx4 a[204:207], v2, s[32:35], s62 offen offset:1024 sc1
    v_sub_f32 v13, v201, v38
    v_mfma_f32_16x16x32_bf16 v[172:175], a[160:163], a[192:195], v[172:175]
    ds_read_b64_tr_b16 a[180:181], v228 offset:24576
    v_mul_f32 v13, v13, v39
    v_mfma_f32_16x16x32_bf16 v[172:175], a[164:167], a[72:75], v[172:175]
    v_fmac_f32 v201, v13, v17
    v_lshlrev_b32 v202, 16, v23
    v_mfma_f32_16x16x32_bf16 v[176:179], a[164:167], a[76:79], v[176:179]
    ds_read_b64_tr_b16 a[182:183], v228 offset:26624
    v_sub_f32 v12, v202, v38
    v_mfma_f32_16x16x32_bf16 v[176:179], a[160:163], a[196:199], v[176:179]
    v_mul_f32 v12, v12, v39
    s_waitcnt lgkmcnt(4)
    v_mfma_f32_16x16x32_bf16 v[192:195], a[168:171], a[196:199], v[192:195]
    ds_read_b64_tr_b16 a[160:161], v229 offset:16384
    v_fmac_f32 v202, v12, v18
    v_mfma_f32_16x16x32_bf16 v[192:195], a[172:175], a[76:79], v[192:195]
    s_xor_b32 s61, s9, 384
    s_add_u32 m0, s68, 20480
    v_and_b32 v203, s70, v23
    v_mfma_f32_16x16x32_bf16 v[188:191], a[172:175], a[72:75], v[188:191]
    ds_read_b64_tr_b16 a[162:163], v229 offset:18432
    v_sub_f32 v13, v203, v38
    v_mfma_f32_16x16x32_bf16 v[188:191], a[168:171], a[192:195], v[188:191]
    buffer_load_dwordx4 v4, s[44:47], s61 offen lds
    v_mul_f32 v13, v13, v39
    v_mfma_f32_16x16x32_bf16 v[184:187], a[168:171], a[188:191], v[184:187]
    ds_read_b64_tr_b16 a[164:165], v229 offset:24576
    v_fmac_f32 v203, v13, v19
    v_mfma_f32_16x16x32_bf16 v[184:187], a[172:175], a[68:71], v[184:187]
    s_xor_b32 s61, s9, 0
    s_add_u32 m0, s68, 36864
    v_lshlrev_b32 v204, 16, v24
    v_mfma_f32_16x16x32_bf16 v[180:183], a[172:175], a[64:67], v[180:183]
    ds_read_b64_tr_b16 a[166:167], v229 offset:26624
    v_sub_f32 v12, v204, v40
    v_mfma_f32_16x16x32_bf16 v[180:183], a[168:171], a[184:187], v[180:183]
    buffer_load_dwordx4 v4, s[36:39], s61 offen lds
    s_waitcnt vmcnt(24) lgkmcnt(4)
    v_mfma_f32_16x16x32_bf16 v[68:71], a[176:179], a[80:83], v[68:71]
    ds_read_b64_tr_b16 a[168:169], v230 offset:16384
    v_mul_f32 v12, v12, v41
    v_mfma_f32_16x16x32_bf16 v[68:71], a[180:183], a[0:3], v[68:71]
    s_xor_b32 s61, s9, 128
    s_add_u32 m0, s68, 53248
    v_fmac_f32 v204, v12, v16
    v_mfma_f32_16x16x32_bf16 v[72:75], a[180:183], a[4:7], v[72:75]
    ds_read_b64_tr_b16 a[170:171], v230 offset:18432
    v_and_b32 v205, s70, v24
    v_mfma_f32_16x16x32_bf16 v[72:75], a[176:179], a[84:87], v[72:75]
    buffer_load_dwordx4 v4, s[36:39], s61 offen lds
    v_sub_f32 v13, v205, v40
    v_mfma_f32_16x16x32_bf16 v[76:79], a[176:179], a[88:91], v[76:79]
    ds_read_b64_tr_b16 a[172:173], v230 offset:24576
    v_mul_f32 v13, v13, v41
    v_mfma_f32_16x16x32_bf16 v[76:79], a[180:183], a[8:11], v[76:79]
    s_xor_b32 s62, s28, 20480
    s_add_u32 s62, s62, s60
    v_fmac_f32 v205, v13, v17
    v_mfma_f32_16x16x32_bf16 v[80:83], a[180:183], a[12:15], v[80:83]
    ds_read_b64_tr_b16 a[174:175], v230 offset:26624
    v_lshlrev_b32 v206, 16, v25
    v_mfma_f32_16x16x32_bf16 v[80:83], a[176:179], a[92:95], v[80:83]
    buffer_load_dwordx4 a[96:99], v2, s[32:35], s62 offen sc1
    s_waitcnt lgkmcnt(4)
    v_mfma_f32_16x16x32_bf16 v[96:99], a[160:163], a[92:95], v[96:99]
    ds_read_b64_tr_b16 a[176:177], v231 offset:16384
    v_sub_f32 v12, v206, v40
    v_mfma_f32_16x16x32_bf16 v[96:99], a[164:167], a[12:15], v[96:99]
    v_mul_f32 v12, v12, v41
    v_fmac_f32 v206, v12, v18
    v_mfma_f32_16x16x32_bf16 v[92:95], a[164:167], a[8:11], v[92:95]
    ds_read_b64_tr_b16 a[178:179], v231 offset:18432
    v_and_b32 v207, s70, v25
    v_mfma_f32_16x16x32_bf16 v[92:95], a[160:163], a[88:91], v[92:95]
    v_sub_f32 v13, v207, v40
    v_mul_f32 v13, v13, v41
    v_mfma_f32_16x16x32_bf16 v[88:91], a[160:163], a[84:87], v[88:91]
    ds_read_b64_tr_b16 a[180:181], v231 offset:24576
    v_fmac_f32 v207, v13, v19
    v_mfma_f32_16x16x32_bf16 v[88:91], a[164:167], a[4:7], v[88:91]
    buffer_load_dwordx4 a[100:103], v2, s[32:35], s62 offen offset:1024 sc1
    v_lshlrev_b32 v208, 16, v26
    v_mfma_f32_16x16x32_bf16 v[84:87], a[164:167], a[0:3], v[84:87]
    ds_read_b64_tr_b16 a[182:183], v231 offset:26624
    v_sub_f32 v12, v208, v42
    v_mfma_f32_16x16x32_bf16 v[84:87], a[160:163], a[80:83], v[84:87]
    v_mul_f32 v12, v12, v43
    s_waitcnt lgkmcnt(4)
    v_mfma_f32_16x16x32_bf16 v[100:103], a[168:171], a[80:83], v[100:103]
    ds_read_b64_tr_b16 a[160:161], v232 offset:16384
    v_fmac_f32 v208, v12, v16
    v_mfma_f32_16x16x32_bf16 v[100:103], a[172:175], a[0:3], v[100:103]
    s_xor_b32 s62, s28, 24576
    s_add_u32 s62, s62, s60
    v_and_b32 v209, s70, v26
    v_mfma_f32_16x16x32_bf16 v[104:107], a[172:175], a[4:7], v[104:107]
    ds_read_b64_tr_b16 a[162:163], v232 offset:18432
    v_sub_f32 v13, v209, v42
    v_mfma_f32_16x16x32_bf16 v[104:107], a[168:171], a[84:87], v[104:107]
    buffer_load_dwordx4 a[112:115], v2, s[32:35], s62 offen sc1
    v_mul_f32 v13, v13, v43
    v_mfma_f32_16x16x32_bf16 v[108:111], a[168:171], a[88:91], v[108:111]
    ds_read_b64_tr_b16 a[164:165], v232 offset:24576
    v_fmac_f32 v209, v13, v17
    v_mfma_f32_16x16x32_bf16 v[108:111], a[172:175], a[8:11], v[108:111]
    buffer_load_dwordx4 a[116:119], v2, s[32:35], s62 offen offset:1024 sc1
    v_lshlrev_b32 v210, 16, v27
    v_mfma_f32_16x16x32_bf16 v[112:115], a[172:175], a[12:15], v[112:115]
    ds_read_b64_tr_b16 a[166:167], v232 offset:26624
    v_sub_f32 v12, v210, v42
    v_mfma_f32_16x16x32_bf16 v[112:115], a[168:171], a[92:95], v[112:115]
    v_mul_f32 v12, v12, v43
    s_waitcnt lgkmcnt(4)
    v_mfma_f32_16x16x32_bf16 v[128:131], a[176:179], a[92:95], v[128:131]
    ds_read_b64_tr_b16 a[168:169], v233 offset:16384
    v_fmac_f32 v210, v12, v18
    v_mfma_f32_16x16x32_bf16 v[128:131], a[180:183], a[12:15], v[128:131]
    s_xor_b32 s62, s28, 28672
    s_add_u32 s62, s62, s60
    v_and_b32 v211, s70, v27
    v_mfma_f32_16x16x32_bf16 v[124:127], a[180:183], a[8:11], v[124:127]
    ds_read_b64_tr_b16 a[170:171], v233 offset:18432
    v_sub_f32 v13, v211, v42
    v_mfma_f32_16x16x32_bf16 v[124:127], a[176:179], a[88:91], v[124:127]
    buffer_load_dwordx4 a[32:35], v2, s[32:35], s62 offen sc1
    v_mul_f32 v13, v13, v43
    v_mfma_f32_16x16x32_bf16 v[120:123], a[176:179], a[84:87], v[120:123]
    ds_read_b64_tr_b16 a[172:173], v233 offset:24576
    v_fmac_f32 v211, v13, v19
    v_mfma_f32_16x16x32_bf16 v[120:123], a[180:183], a[4:7], v[120:123]
    v_lshlrev_b32 v212, 16, v28
    v_sub_f32 v12, v212, v44
    v_mfma_f32_16x16x32_bf16 v[116:119], a[180:183], a[0:3], v[116:119]
    ds_read_b64_tr_b16 a[174:175], v233 offset:26624
    v_mul_f32 v12, v12, v45
    v_mfma_f32_16x16x32_bf16 v[116:119], a[176:179], a[80:83], v[116:119]
    v_fmac_f32 v212, v12, v16
    s_waitcnt lgkmcnt(4)
    v_mfma_f32_16x16x32_bf16 v[132:135], a[160:163], a[80:83], v[132:135]
    ds_read_b64_tr_b16 a[176:177], v234 offset:16384
    v_and_b32 v213, s70, v28
    v_mfma_f32_16x16x32_bf16 v[132:135], a[164:167], a[0:3], v[132:135]
    v_sub_f32 v13, v213, v44
    v_mul_f32 v13, v13, v45
    v_mfma_f32_16x16x32_bf16 v[136:139], a[164:167], a[4:7], v[136:139]
    ds_read_b64_tr_b16 a[178:179], v234 offset:18432
    v_fmac_f32 v213, v13, v17
    v_mfma_f32_16x16x32_bf16 v[136:139], a[160:163], a[84:87], v[136:139]
    buffer_load_dwordx4 a[36:39], v2, s[32:35], s62 offen offset:1024 sc1
    v_lshlrev_b32 v214, 16, v29
    v_mfma_f32_16x16x32_bf16 v[140:143], a[160:163], a[88:91], v[140:143]
    ds_read_b64_tr_b16 a[180:181], v234 offset:24576
    v_sub_f32 v12, v214, v44
    v_mfma_f32_16x16x32_bf16 v[140:143], a[164:167], a[8:11], v[140:143]
    s_xor_b32 s62, s28, 36864
    s_add_u32 s62, s62, s60
    v_mul_f32 v12, v12, v45
    v_mfma_f32_16x16x32_bf16 v[144:147], a[164:167], a[12:15], v[144:147]
    ds_read_b64_tr_b16 a[182:183], v234 offset:26624
    v_fmac_f32 v214, v12, v18
    v_mfma_f32_16x16x32_bf16 v[144:147], a[160:163], a[92:95], v[144:147]
    buffer_load_dwordx4 a[48:51], v2, s[32:35], s62 offen sc1
    s_waitcnt lgkmcnt(4)
    v_mfma_f32_16x16x32_bf16 v[160:163], a[168:171], a[92:95], v[160:163]
    ds_read_b64_tr_b16 a[160:161], v235 offset:16384
    v_and_b32 v215, s70, v29
    v_mfma_f32_16x16x32_bf16 v[160:163], a[172:175], a[12:15], v[160:163]
    v_sub_f32 v13, v215, v44
    v_mul_f32 v13, v13, v45
    v_mfma_f32_16x16x32_bf16 v[156:159], a[172:175], a[8:11], v[156:159]
    ds_read_b64_tr_b16 a[162:163], v235 offset:18432
    v_fmac_f32 v215, v13, v19
    v_mfma_f32_16x16x32_bf16 v[156:159], a[168:171], a[88:91], v[156:159]
    buffer_load_dwordx4 a[52:55], v2, s[32:35], s62 offen offset:1024 sc1
    v_lshlrev_b32 v216, 16, v30
    v_mfma_f32_16x16x32_bf16 v[152:155], a[168:171], a[84:87], v[152:155]
    ds_read_b64_tr_b16 a[164:165], v235 offset:24576
    v_sub_f32 v12, v216, v46
    v_mfma_f32_16x16x32_bf16 v[152:155], a[172:175], a[4:7], v[152:155]
    s_xor_b32 s62, s28, 40960
    s_add_u32 s62, s62, s60
    v_mul_f32 v12, v12, v47
    v_mfma_f32_16x16x32_bf16 v[148:151], a[172:175], a[0:3], v[148:151]
    ds_read_b64_tr_b16 a[166:167], v235 offset:26624
    v_fmac_f32 v216, v12, v16
    v_mfma_f32_16x16x32_bf16 v[148:151], a[168:171], a[80:83], v[148:151]
    buffer_load_dwordx4 a[184:187], v2, s[32:35], s62 offen sc1
    s_waitcnt lgkmcnt(4)
    v_mfma_f32_16x16x32_bf16 v[164:167], a[176:179], a[80:83], v[164:167]
    ds_read_b128 a[168:171], v10 offset:32768
    v_and_b32 v217, s70, v30
    v_mfma_f32_16x16x32_bf16 v[164:167], a[180:183], a[0:3], v[164:167]
    v_sub_f32 v13, v217, v46
    v_mul_f32 v13, v13, v47
    v_mfma_f32_16x16x32_bf16 v[168:171], a[180:183], a[4:7], v[168:171]
    v_fmac_f32 v217, v13, v17
    v_lshlrev_b32 v218, 16, v31
    v_mfma_f32_16x16x32_bf16 v[168:171], a[176:179], a[84:87], v[168:171]
    buffer_load_dwordx4 a[188:191], v2, s[32:35], s62 offen offset:1024 sc1
    v_sub_f32 v12, v218, v46
    v_mfma_f32_16x16x32_bf16 v[172:175], a[176:179], a[88:91], v[172:175]
    ds_read_b128 a[172:175], v11 offset:32768
    v_mul_f32 v12, v12, v47
    v_mfma_f32_16x16x32_bf16 v[172:175], a[180:183], a[8:11], v[172:175]
    v_fmac_f32 v218, v12, v18
    v_and_b32 v219, s70, v31
    v_mfma_f32_16x16x32_bf16 v[176:179], a[180:183], a[12:15], v[176:179]
    v_sub_f32 v13, v219, v46
    v_mul_f32 v13, v13, v47
    v_mfma_f32_16x16x32_bf16 v[176:179], a[176:179], a[92:95], v[176:179]
    v_fmac_f32 v219, v13, v19
    s_waitcnt lgkmcnt(2)
    v_mfma_f32_16x16x32_bf16 v[192:195], a[160:163], a[92:95], v[192:195]
    ds_read_b128 a[176:179], v10 offset:34816
    v_lshlrev_b32 v220, 16, v32
    v_mfma_f32_16x16x32_bf16 v[192:195], a[164:167], a[12:15], v[192:195]
    s_xor_b32 s62, s28, 45056
    s_add_u32 s62, s62, s60
    v_sub_f32 v12, v220, v48
    v_mfma_f32_16x16x32_bf16 v[188:191], a[164:167], a[8:11], v[188:191]
    v_mul_f32 v12, v12, v49
    v_fmac_f32 v220, v12, v16
    v_mfma_f32_16x16x32_bf16 v[188:191], a[160:163], a[88:91], v[188:191]
    buffer_load_dwordx4 a[64:67], v2, s[32:35], s62 offen sc1
    v_and_b32 v221, s70, v32
    v_mfma_f32_16x16x32_bf16 v[184:187], a[160:163], a[84:87], v[184:187]
    ds_read_b128 a[180:183], v11 offset:34816
    v_sub_f32 v13, v221, v48
    v_mfma_f32_16x16x32_bf16 v[184:187], a[164:167], a[4:7], v[184:187]
    buffer_load_dwordx4 a[68:71], v2, s[32:35], s62 offen offset:1024 sc1
    v_mul_f32 v13, v13, v49
    v_mfma_f32_16x16x32_bf16 v[180:183], a[164:167], a[0:3], v[180:183]
    v_fmac_f32 v221, v13, v17
    v_lshlrev_b32 v222, 16, v33
    v_mfma_f32_16x16x32_bf16 v[180:183], a[160:163], a[80:83], v[180:183]
    v_sub_f32 v12, v222, v48
    s_waitcnt vmcnt(28) lgkmcnt(2)
    v_mfma_f32_16x16x32_bf16 v[68:71], a[168:171], a[224:227], v[68:71]
    ds_read_b128 a[160:163], v10 offset:36864
    v_mul_f32 v12, v12, v49
    v_mfma_f32_16x16x32_bf16 v[68:71], a[172:175], a[16:19], v[68:71]
    s_xor_b32 s62, s28, 49152
    s_add_u32 s62, s62, s60
    v_fmac_f32 v222, v12, v18
    v_mfma_f32_16x16x32_bf16 v[72:75], a[172:175], a[20:23], v[72:75]
    v_and_b32 v223, s70, v33
    v_sub_f32 v13, v223, v48
    v_mfma_f32_16x16x32_bf16 v[72:75], a[168:171], a[228:231], v[72:75]
    buffer_load_dwordx4 a[80:83], v2, s[32:35], s62 offen sc1
    v_mul_f32 v13, v13, v49
    v_mfma_f32_16x16x32_bf16 v[76:79], a[168:171], a[232:235], v[76:79]
    ds_read_b128 a[164:167], v11 offset:36864
    v_fmac_f32 v223, v13, v19
    v_mfma_f32_16x16x32_bf16 v[76:79], a[172:175], a[24:27], v[76:79]
    buffer_load_dwordx4 a[84:87], v2, s[32:35], s62 offen offset:1024 sc1
    v_lshlrev_b32 v224, 16, v34
    v_mfma_f32_16x16x32_bf16 v[80:83], a[172:175], a[28:31], v[80:83]
    v_sub_f32 v12, v224, v50
    v_mul_f32 v12, v12, v51
    v_mfma_f32_16x16x32_bf16 v[80:83], a[168:171], a[236:239], v[80:83]
    v_fmac_f32 v224, v12, v16
    s_waitcnt vmcnt(28) lgkmcnt(2)
    s_barrier
    v_mfma_f32_16x16x32_bf16 v[96:99], a[176:179], a[236:239], v[96:99]
    ds_read_b128 a[168:171], v10 offset:38912
    v_and_b32 v225, s70, v34
    v_mfma_f32_16x16x32_bf16 v[96:99], a[180:183], a[28:31], v[96:99]
    v_sub_f32 v13, v225, v50
    v_mul_f32 v13, v13, v51
    v_mfma_f32_16x16x32_bf16 v[92:95], a[180:183], a[24:27], v[92:95]
    v_fmac_f32 v225, v13, v17
    v_lshlrev_b32 v226, 16, v35
    v_mfma_f32_16x16x32_bf16 v[92:95], a[176:179], a[232:235], v[92:95]
    v_sub_f32 v12, v226, v50
    v_mul_f32 v12, v12, v51
    v_mfma_f32_16x16x32_bf16 v[88:91], a[176:179], a[228:231], v[88:91]
    ds_read_b128 a[172:175], v11 offset:38912
    v_fmac_f32 v226, v12, v18
    v_mfma_f32_16x16x32_bf16 v[88:91], a[180:183], a[20:23], v[88:91]
    s_xor_b32 s61, s9, 256
    s_add_u32 m0, s68, 69632
    v_and_b32 v227, s70, v35
    v_mfma_f32_16x16x32_bf16 v[84:87], a[180:183], a[16:19], v[84:87]
    v_sub_f32 v13, v227, v50
    v_mul_f32 v13, v13, v51
    v_mfma_f32_16x16x32_bf16 v[84:87], a[176:179], a[224:227], v[84:87]
    buffer_load_dwordx4 v4, s[36:39], s61 offen lds
    s_waitcnt lgkmcnt(2)
    v_mfma_f32_16x16x32_bf16 v[100:103], a[160:163], a[224:227], v[100:103]
    ds_read_b128 a[176:179], v10 offset:40960
    v_fmac_f32 v227, v13, v19
    v_mfma_f32_16x16x32_bf16 v[100:103], a[164:167], a[16:19], v[100:103]
    s_xor_b32 s61, s9, 384
    s_add_u32 m0, s68, 86016
    v_mfma_f32_16x16x32_bf16 v[104:107], a[164:167], a[20:23], v[104:107]
    v_mfma_f32_16x16x32_bf16 v[104:107], a[160:163], a[228:231], v[104:107]
    buffer_load_dwordx4 v4, s[36:39], s61 offen lds
    v_mfma_f32_16x16x32_bf16 v[108:111], a[160:163], a[232:235], v[108:111]
    ds_read_b128 a[180:183], v11 offset:40960
    v_mfma_f32_16x16x32_bf16 v[108:111], a[164:167], a[24:27], v[108:111]
    s_xor_b32 s61, s10, 256
    s_add_u32 m0, s68, 8192
    v_mfma_f32_16x16x32_bf16 v[112:115], a[164:167], a[28:31], v[112:115]
    v_mfma_f32_16x16x32_bf16 v[112:115], a[160:163], a[236:239], v[112:115]
    buffer_load_dwordx4 v4, s[44:47], s61 offen lds
    s_waitcnt lgkmcnt(2)
    v_mfma_f32_16x16x32_bf16 v[128:131], a[168:171], a[236:239], v[128:131]
    ds_read_b128 a[160:163], v10 offset:43008
    v_mfma_f32_16x16x32_bf16 v[128:131], a[172:175], a[28:31], v[128:131]
    s_xor_b32 s61, s11, 256
    s_add_u32 m0, s68, 12288
    v_mfma_f32_16x16x32_bf16 v[124:127], a[172:175], a[24:27], v[124:127]
    v_mfma_f32_16x16x32_bf16 v[124:127], a[168:171], a[232:235], v[124:127]
    buffer_load_dwordx4 v4, s[44:47], s61 offen lds
    v_mfma_f32_16x16x32_bf16 v[120:123], a[168:171], a[228:231], v[120:123]
    ds_read_b128 a[164:167], v11 offset:43008
    v_mfma_f32_16x16x32_bf16 v[120:123], a[172:175], a[20:23], v[120:123]
    v_mfma_f32_16x16x32_bf16 v[116:119], a[172:175], a[16:19], v[116:119]
    v_mfma_f32_16x16x32_bf16 v[116:119], a[168:171], a[224:227], v[116:119]
    s_waitcnt lgkmcnt(2)
    v_mfma_f32_16x16x32_bf16 v[132:135], a[176:179], a[224:227], v[132:135]
    ds_read_b128 a[168:171], v10 offset:45056
    v_mfma_f32_16x16x32_bf16 v[132:135], a[180:183], a[16:19], v[132:135]
    s_xor_b32 s61, s10, 384
    s_add_u32 m0, s68, 24576
    v_mfma_f32_16x16x32_bf16 v[136:139], a[180:183], a[20:23], v[136:139]
    v_mfma_f32_16x16x32_bf16 v[136:139], a[176:179], a[228:231], v[136:139]
    buffer_load_dwordx4 v4, s[44:47], s61 offen lds
    v_mfma_f32_16x16x32_bf16 v[140:143], a[176:179], a[232:235], v[140:143]
    ds_read_b128 a[172:175], v11 offset:45056
    v_mfma_f32_16x16x32_bf16 v[140:143], a[180:183], a[24:27], v[140:143]
    s_xor_b32 s61, s11, 384
    s_add_u32 m0, s68, 28672
    v_mfma_f32_16x16x32_bf16 v[144:147], a[180:183], a[28:31], v[144:147]
    v_mfma_f32_16x16x32_bf16 v[144:147], a[176:179], a[236:239], v[144:147]
    buffer_load_dwordx4 v4, s[44:47], s61 offen lds
    s_waitcnt lgkmcnt(2)
    v_mfma_f32_16x16x32_bf16 v[160:163], a[160:163], a[236:239], v[160:163]
    ds_read_b128 a[176:179], v10 offset:47104
    v_mfma_f32_16x16x32_bf16 v[160:163], a[164:167], a[28:31], v[160:163]
    s_xor_b32 s61, s10, 0
    s_add_u32 m0, s68, 40960
    v_mfma_f32_16x16x32_bf16 v[156:159], a[164:167], a[24:27], v[156:159]
    v_mfma_f32_16x16x32_bf16 v[156:159], a[160:163], a[232:235], v[156:159]
    buffer_load_dwordx4 v4, s[36:39], s61 offen lds
    v_mfma_f32_16x16x32_bf16 v[152:155], a[160:163], a[228:231], v[152:155]
    ds_read_b128 a[180:183], v11 offset:47104
    v_mfma_f32_16x16x32_bf16 v[152:155], a[164:167], a[20:23], v[152:155]
    s_xor_b32 s61, s11, 0
    s_add_u32 m0, s68, 45056
    v_mfma_f32_16x16x32_bf16 v[148:151], a[164:167], a[16:19], v[148:151]
    v_mfma_f32_16x16x32_bf16 v[148:151], a[160:163], a[224:227], v[148:151]
    buffer_load_dwordx4 v4, s[36:39], s61 offen lds
    s_waitcnt lgkmcnt(2)
    v_mfma_f32_16x16x32_bf16 v[164:167], a[168:171], a[224:227], v[164:167]
    ds_read_b128 a[160:163], v10 offset:49152
    v_mfma_f32_16x16x32_bf16 v[164:167], a[172:175], a[16:19], v[164:167]
    s_xor_b32 s61, s10, 128
    s_add_u32 m0, s68, 57344
    v_mfma_f32_16x16x32_bf16 v[168:171], a[172:175], a[20:23], v[168:171]
    v_mfma_f32_16x16x32_bf16 v[168:171], a[168:171], a[228:231], v[168:171]
    buffer_load_dwordx4 v4, s[36:39], s61 offen lds
    v_mfma_f32_16x16x32_bf16 v[172:175], a[168:171], a[232:235], v[172:175]
    ds_read_b128 a[164:167], v11 offset:49152
    v_mfma_f32_16x16x32_bf16 v[172:175], a[172:175], a[24:27], v[172:175]
    v_mfma_f32_16x16x32_bf16 v[176:179], a[172:175], a[28:31], v[176:179]
    v_mfma_f32_16x16x32_bf16 v[176:179], a[168:171], a[236:239], v[176:179]
    s_waitcnt lgkmcnt(2)
    v_mfma_f32_16x16x32_bf16 v[192:195], a[176:179], a[236:239], v[192:195]
    ds_read_b128 a[168:171], v10 offset:51200
    v_mfma_f32_16x16x32_bf16 v[192:195], a[180:183], a[28:31], v[192:195]
    s_xor_b32 s61, s11, 128
    s_add_u32 m0, s68, 61440
    v_mfma_f32_16x16x32_bf16 v[188:191], a[180:183], a[24:27], v[188:191]
    v_mfma_f32_16x16x32_bf16 v[188:191], a[176:179], a[232:235], v[188:191]
    buffer_load_dwordx4 v4, s[36:39], s61 offen lds
    v_mfma_f32_16x16x32_bf16 v[184:187], a[176:179], a[228:231], v[184:187]
    ds_read_b128 a[172:175], v11 offset:51200
    v_mfma_f32_16x16x32_bf16 v[184:187], a[180:183], a[20:23], v[184:187]
    s_xor_b32 s61, s10, 256
    s_add_u32 m0, s68, 73728
    v_mfma_f32_16x16x32_bf16 v[180:183], a[180:183], a[16:19], v[180:183]
    v_mfma_f32_16x16x32_bf16 v[180:183], a[176:179], a[224:227], v[180:183]
    buffer_load_dwordx4 v4, s[36:39], s61 offen lds
    s_waitcnt vmcnt(31) lgkmcnt(2)
    v_mfma_f32_16x16x32_bf16 v[68:71], a[160:163], a[128:131], v[68:71]
    ds_read_b128 a[176:179], v10 offset:53248
    v_mfma_f32_16x16x32_bf16 v[68:71], a[164:167], a[144:147], v[68:71]
    s_xor_b32 s61, s11, 256
    s_add_u32 m0, s68, 77824
    v_mfma_f32_16x16x32_bf16 v[72:75], a[164:167], a[148:151], v[72:75]
    v_mfma_f32_16x16x32_bf16 v[72:75], a[160:163], a[132:135], v[72:75]
    buffer_load_dwordx4 v4, s[36:39], s61 offen lds
    v_mfma_f32_16x16x32_bf16 v[76:79], a[160:163], a[136:139], v[76:79]
    ds_read_b128 a[180:183], v11 offset:53248
    v_mfma_f32_16x16x32_bf16 v[76:79], a[164:167], a[152:155], v[76:79]
    s_xor_b32 s61, s10, 384
    s_add_u32 m0, s68, 90112
    v_mfma_f32_16x16x32_bf16 v[80:83], a[164:167], a[156:159], v[80:83]
    v_mfma_f32_16x16x32_bf16 v[80:83], a[160:163], a[140:143], v[80:83]
    buffer_load_dwordx4 v4, s[36:39], s61 offen lds
    s_waitcnt lgkmcnt(2)
    v_mfma_f32_16x16x32_bf16 v[96:99], a[168:171], a[140:143], v[96:99]
    ds_read_b128 a[160:163], v10 offset:55296
    v_mfma_f32_16x16x32_bf16 v[96:99], a[172:175], a[156:159], v[96:99]
    v_mfma_f32_16x16x32_bf16 v[92:95], a[172:175], a[152:155], v[92:95]
    v_mfma_f32_16x16x32_bf16 v[92:95], a[168:171], a[136:139], v[92:95]
    v_mfma_f32_16x16x32_bf16 v[88:91], a[168:171], a[132:135], v[88:91]
    ds_read_b128 a[164:167], v11 offset:55296
    v_mfma_f32_16x16x32_bf16 v[88:91], a[172:175], a[148:151], v[88:91]
    s_xor_b32 s61, s11, 384
    s_add_u32 m0, s68, 94208
    v_mfma_f32_16x16x32_bf16 v[84:87], a[172:175], a[144:147], v[84:87]
    v_mfma_f32_16x16x32_bf16 v[84:87], a[168:171], a[128:131], v[84:87]
    buffer_load_dwordx4 v4, s[36:39], s61 offen lds
    s_waitcnt lgkmcnt(2)
    v_mfma_f32_16x16x32_bf16 v[100:103], a[176:179], a[128:131], v[100:103]
    ds_read_b128 a[168:171], v10 offset:57344
    v_mfma_f32_16x16x32_bf16 v[100:103], a[180:183], a[144:147], v[100:103]
    s_xor_b32 s62, s28, 53248
    s_add_u32 s62, s62, s60
    v_mfma_f32_16x16x32_bf16 v[104:107], a[180:183], a[148:151], v[104:107]
    v_mfma_f32_16x16x32_bf16 v[104:107], a[176:179], a[132:135], v[104:107]
    buffer_load_dwordx4 a[0:3], v2, s[32:35], s62 offen sc1
    v_mfma_f32_16x16x32_bf16 v[108:111], a[176:179], a[136:139], v[108:111]
    ds_read_b128 a[172:175], v11 offset:57344
    v_mfma_f32_16x16x32_bf16 v[108:111], a[180:183], a[152:155], v[108:111]
    buffer_load_dwordx4 a[4:7], v2, s[32:35], s62 offen offset:1024 sc1
    v_mfma_f32_16x16x32_bf16 v[112:115], a[180:183], a[156:159], v[112:115]
    v_mfma_f32_16x16x32_bf16 v[112:115], a[176:179], a[140:143], v[112:115]
    s_waitcnt lgkmcnt(2)
    v_mfma_f32_16x16x32_bf16 v[128:131], a[160:163], a[140:143], v[128:131]
    ds_read_b128 a[176:179], v10 offset:59392
    v_mfma_f32_16x16x32_bf16 v[128:131], a[164:167], a[156:159], v[128:131]
    s_xor_b32 s62, s28, 57344
    s_add_u32 s62, s62, s60
    v_mfma_f32_16x16x32_bf16 v[124:127], a[164:167], a[152:155], v[124:127]
    v_mfma_f32_16x16x32_bf16 v[124:127], a[160:163], a[136:139], v[124:127]
    buffer_load_dwordx4 v[20:23], v2, s[32:35], s62 offen sc1
    v_mfma_f32_16x16x32_bf16 v[120:123], a[160:163], a[132:135], v[120:123]
    ds_read_b128 a[180:183], v11 offset:59392
    v_mfma_f32_16x16x32_bf16 v[120:123], a[164:167], a[148:151], v[120:123]
    v_mfma_f32_16x16x32_bf16 v[116:119], a[164:167], a[144:147], v[116:119]
    v_mfma_f32_16x16x32_bf16 v[116:119], a[160:163], a[128:131], v[116:119]
    s_waitcnt lgkmcnt(2)
    v_mfma_f32_16x16x32_bf16 v[132:135], a[168:171], a[128:131], v[132:135]
    ds_read_b128 a[160:163], v10 offset:61440
    v_mfma_f32_16x16x32_bf16 v[132:135], a[172:175], a[144:147], v[132:135]
    v_mfma_f32_16x16x32_bf16 v[136:139], a[172:175], a[148:151], v[136:139]
    v_mfma_f32_16x16x32_bf16 v[136:139], a[168:171], a[132:135], v[136:139]
    buffer_load_dwordx4 v[24:27], v2, s[32:35], s62 offen offset:1024 sc1
    v_mfma_f32_16x16x32_bf16 v[140:143], a[168:171], a[136:139], v[140:143]
    ds_read_b128 a[164:167], v11 offset:61440
    v_mfma_f32_16x16x32_bf16 v[140:143], a[172:175], a[152:155], v[140:143]
    s_xor_b32 s62, s28, 61440
    s_add_u32 s62, s62, s60
    v_mfma_f32_16x16x32_bf16 v[144:147], a[172:175], a[156:159], v[144:147]
    v_mfma_f32_16x16x32_bf16 v[144:147], a[168:171], a[140:143], v[144:147]
    buffer_load_dwordx4 v[36:39], v2, s[32:35], s62 offen sc1
    s_waitcnt lgkmcnt(2)
    v_mfma_f32_16x16x32_bf16 v[160:163], a[176:179], a[140:143], v[160:163]
    ds_read_b128 a[168:171], v10 offset:63488
    v_mfma_f32_16x16x32_bf16 v[160:163], a[180:183], a[156:159], v[160:163]
    v_mfma_f32_16x16x32_bf16 v[156:159], a[180:183], a[152:155], v[156:159]
    v_mfma_f32_16x16x32_bf16 v[156:159], a[176:179], a[136:139], v[156:159]
    buffer_load_dwordx4 v[40:43], v2, s[32:35], s62 offen offset:1024 sc1
    v_mfma_f32_16x16x32_bf16 v[152:155], a[176:179], a[132:135], v[152:155]
    ds_read_b128 a[172:175], v11 offset:63488
    v_mfma_f32_16x16x32_bf16 v[152:155], a[180:183], a[148:151], v[152:155]
    s_xor_b32 s62, s28, 16384
    s_add_u32 s62, s62, s60
    v_mfma_f32_16x16x32_bf16 v[148:151], a[180:183], a[144:147], v[148:151]
    v_mfma_f32_16x16x32_bf16 v[148:151], a[176:179], a[128:131], v[148:151]
    buffer_load_dwordx4 a[208:211], v2, s[32:35], s62 offen offset:2048 sc1
    s_waitcnt vmcnt(19) lgkmcnt(2)
    s_barrier
    v_mfma_f32_16x16x32_bf16 v[164:167], a[160:163], a[128:131], v[164:167]
    ds_read_b128 v[228:231], v8 offset:4096
    v_mfma_f32_16x16x32_bf16 v[164:167], a[164:167], a[144:147], v[164:167]
    v_mfma_f32_16x16x32_bf16 v[168:171], a[164:167], a[148:151], v[168:171]
    ds_read_b128 v[232:235], v9 offset:4096
    v_mfma_f32_16x16x32_bf16 v[168:171], a[160:163], a[132:135], v[168:171]
    buffer_load_dwordx4 a[212:215], v2, s[32:35], s62 offen offset:3072 sc1
    v_mfma_f32_16x16x32_bf16 v[172:175], a[160:163], a[136:139], v[172:175]
    ds_read_b128 v[242:245], v8 offset:6144
    v_mfma_f32_16x16x32_bf16 v[172:175], a[164:167], a[152:155], v[172:175]
    v_mfma_f32_16x16x32_bf16 v[176:179], a[164:167], a[156:159], v[176:179]
    ds_read_b128 v[64:67], v9 offset:6144
    v_mfma_f32_16x16x32_bf16 v[176:179], a[160:163], a[140:143], v[176:179]
    s_waitcnt lgkmcnt(4)
    v_mfma_f32_16x16x32_bf16 v[192:195], a[168:171], a[140:143], v[192:195]
    ds_read_b128 a[176:179], v8 offset:20480
    v_mfma_f32_16x16x32_bf16 v[192:195], a[172:175], a[156:159], v[192:195]
    s_xor_b32 s62, s28, 20480
    s_add_u32 s62, s62, s60
    v_mfma_f32_16x16x32_bf16 v[188:191], a[172:175], a[152:155], v[188:191]
    ds_read_b128 a[180:183], v9 offset:20480
    v_mfma_f32_16x16x32_bf16 v[188:191], a[168:171], a[136:139], v[188:191]
    buffer_load_dwordx4 a[104:107], v2, s[32:35], s62 offen offset:2048 sc1
    v_mfma_f32_16x16x32_bf16 v[184:187], a[168:171], a[132:135], v[184:187]
    ds_read_b128 a[160:163], v8 offset:22528
    v_mfma_f32_16x16x32_bf16 v[184:187], a[172:175], a[148:151], v[184:187]
    buffer_load_dwordx4 a[108:111], v2, s[32:35], s62 offen offset:3072 sc1
    v_mfma_f32_16x16x32_bf16 v[180:183], a[172:175], a[144:147], v[180:183]
    ds_read_b128 a[164:167], v9 offset:22528
    v_mfma_f32_16x16x32_bf16 v[180:183], a[168:171], a[128:131], v[180:183]
    s_waitcnt vmcnt(36) lgkmcnt(6)
    v_mfma_f32_16x16x32_bf16 v[100:103], v[228:231], a[200:203], v[100:103]
    ds_read_b128 a[168:171], v8 offset:36864
    ds_read_b128 a[172:175], v9 offset:36864
    v_mfma_f32_16x16x32_bf16 v[100:103], v[232:235], a[96:99], v[100:103]
    v_mfma_f32_16x16x32_bf16 v[104:107], v[232:235], a[100:103], v[104:107]
    s_xor_b32 s62, s28, 24576
    s_add_u32 s62, s62, s60
    v_mfma_f32_16x16x32_bf16 v[104:107], v[228:231], a[204:207], v[104:107]
    buffer_load_dwordx4 a[120:123], v2, s[32:35], s62 offen offset:2048 sc1
    s_waitcnt lgkmcnt(6)
    v_mfma_f32_16x16x32_bf16 v[120:123], v[242:245], a[204:207], v[120:123]
    ds_read_b128 v[228:231], v8 offset:38912
    ds_read_b128 v[232:235], v9 offset:38912
    v_mfma_f32_16x16x32_bf16 v[120:123], v[64:67], a[100:103], v[120:123]
    v_mfma_f32_16x16x32_bf16 v[116:119], v[64:67], a[96:99], v[116:119]
    v_mfma_f32_16x16x32_bf16 v[116:119], v[242:245], a[200:203], v[116:119]
    buffer_load_dwordx4 a[124:127], v2, s[32:35], s62 offen offset:3072 sc1
    s_waitcnt vmcnt(34) lgkmcnt(6)
    v_mfma_f32_16x16x32_bf16 v[100:103], a[176:179], a[112:115], v[100:103]
    ds_read_b128 v[242:245], v8 offset:53248
    ds_read_b128 v[64:67], v9 offset:53248
    v_mfma_f32_16x16x32_bf16 v[100:103], a[180:183], a[32:35], v[100:103]
    v_mfma_f32_16x16x32_bf16 v[104:107], a[180:183], a[36:39], v[104:107]
    v_mfma_f32_16x16x32_bf16 v[104:107], a[176:179], a[116:119], v[104:107]
    s_waitcnt lgkmcnt(6)
    v_mfma_f32_16x16x32_bf16 v[120:123], a[160:163], a[116:119], v[120:123]
    ds_read_b128 a[176:179], v8 offset:55296
    ds_read_b128 a[180:183], v9 offset:55296
    v_mfma_f32_16x16x32_bf16 v[120:123], a[164:167], a[36:39], v[120:123]
    v_mfma_f32_16x16x32_bf16 v[116:119], a[164:167], a[32:35], v[116:119]
    s_xor_b32 s62, s28, 28672
    s_add_u32 s62, s62, s60
    v_mfma_f32_16x16x32_bf16 v[116:119], a[160:163], a[112:115], v[116:119]
    buffer_load_dwordx4 a[40:43], v2, s[32:35], s62 offen offset:2048 sc1
    s_waitcnt vmcnt(33) lgkmcnt(6)
    v_mfma_f32_16x16x32_bf16 v[100:103], a[168:171], a[240:243], v[100:103]
    ds_read_b128 a[160:163], v10 offset:4096
    ds_read_b128 a[164:167], v11 offset:4096
    v_mfma_f32_16x16x32_bf16 v[100:103], a[172:175], a[48:51], v[100:103]
    v_mfma_f32_16x16x32_bf16 v[104:107], a[172:175], a[52:55], v[104:107]
    v_mfma_f32_16x16x32_bf16 v[104:107], a[168:171], a[244:247], v[104:107]
    buffer_load_dwordx4 a[44:47], v2, s[32:35], s62 offen offset:3072 sc1
    s_waitcnt lgkmcnt(6)
    v_mfma_f32_16x16x32_bf16 v[120:123], v[228:231], a[244:247], v[120:123]
    ds_read_b128 a[168:171], v10 offset:6144
    ds_read_b128 a[172:175], v11 offset:6144
    v_mfma_f32_16x16x32_bf16 v[120:123], v[232:235], a[52:55], v[120:123]
    v_mfma_f32_16x16x32_bf16 v[116:119], v[232:235], a[48:51], v[116:119]
    s_xor_b32 s62, s28, 36864
    s_add_u32 s62, s62, s60
    v_mfma_f32_16x16x32_bf16 v[116:119], v[228:231], a[240:243], v[116:119]
    buffer_load_dwordx4 a[56:59], v2, s[32:35], s62 offen offset:2048 sc1
    s_waitcnt vmcnt(31) lgkmcnt(6)
    v_mfma_f32_16x16x32_bf16 v[100:103], v[242:245], a[184:187], v[100:103]
    ds_read_b128 v[228:231], v10 offset:20480
    ds_read_b128 v[232:235], v11 offset:20480
    v_mfma_f32_16x16x32_bf16 v[100:103], v[64:67], a[64:67], v[100:103]
    v_mfma_f32_16x16x32_bf16 v[104:107], v[64:67], a[68:71], v[104:107]
    v_mfma_f32_16x16x32_bf16 v[104:107], v[242:245], a[188:191], v[104:107]
    buffer_load_dwordx4 a[60:63], v2, s[32:35], s62 offen offset:3072 sc1
    s_waitcnt lgkmcnt(6)
    v_mfma_f32_16x16x32_bf16 v[120:123], a[176:179], a[188:191], v[120:123]
    ds_read_b128 v[242:245], v10 offset:22528
    ds_read_b128 v[64:67], v11 offset:22528
    v_mfma_f32_16x16x32_bf16 v[120:123], a[180:183], a[68:71], v[120:123]
    v_mfma_f32_16x16x32_bf16 v[116:119], a[180:183], a[64:67], v[116:119]
    v_mfma_f32_16x16x32_bf16 v[116:119], a[176:179], a[184:187], v[116:119]
    s_waitcnt vmcnt(14) lgkmcnt(6)
    s_waitcnt vmcnt(16)
    s_barrier
    v_mfma_f32_16x16x32_bf16 v[100:103], a[160:163], a[80:83], v[100:103]
    ds_read_b128 a[176:179], v8 offset:8192
    ds_read_b128 a[180:183], v9 offset:8192
    v_mfma_f32_16x16x32_bf16 v[100:103], a[164:167], a[0:3], v[100:103]
    v_mfma_f32_16x16x32_bf16 v[104:107], a[164:167], a[4:7], v[104:107]
    s_xor_b32 s62, s28, 40960
    s_add_u32 s62, s62, s60
    v_mfma_f32_16x16x32_bf16 v[104:107], a[160:163], a[84:87], v[104:107]
    buffer_load_dwordx4 a[192:195], v2, s[32:35], s62 offen offset:2048 sc1
    s_waitcnt lgkmcnt(6)
    v_mfma_f32_16x16x32_bf16 v[120:123], a[168:171], a[84:87], v[120:123]
    ds_read_b128 a[160:163], v8 offset:10240
    ds_read_b128 a[164:167], v9 offset:10240
    v_mfma_f32_16x16x32_bf16 v[120:123], a[172:175], a[4:7], v[120:123]
    v_mfma_f32_16x16x32_bf16 v[116:119], a[172:175], a[0:3], v[116:119]
    v_mfma_f32_16x16x32_bf16 v[116:119], a[168:171], a[80:83], v[116:119]
    buffer_load_dwordx4 a[196:199], v2, s[32:35], s62 offen offset:3072 sc1
    s_waitcnt vmcnt(12) lgkmcnt(6)
    v_mfma_f32_16x16x32_bf16 v[100:103], v[228:231], v[20:23], v[100:103]
    ds_read_b128 a[168:171], v8 offset:24576
    ds_read_b128 a[172:175], v9 offset:24576
    v_mfma_f32_16x16x32_bf16 v[100:103], v[232:235], v[36:39], v[100:103]
    v_mfma_f32_16x16x32_bf16 v[104:107], v[232:235], v[40:43], v[104:107]
    s_xor_b32 s62, s28, 45056
    s_add_u32 s62, s62, s60
    v_mfma_f32_16x16x32_bf16 v[104:107], v[228:231], v[24:27], v[104:107]
    buffer_load_dwordx4 a[72:75], v2, s[32:35], s62 offen offset:2048 sc1
    s_waitcnt lgkmcnt(6)
    v_mfma_f32_16x16x32_bf16 v[120:123], v[242:245], v[24:27], v[120:123]
    ds_read_b128 v[228:231], v8 offset:26624
    ds_read_b128 v[232:235], v9 offset:26624
    v_mfma_f32_16x16x32_bf16 v[120:123], v[64:67], v[40:43], v[120:123]
    v_mfma_f32_16x16x32_bf16 v[116:119], v[64:67], v[36:39], v[116:119]
    v_mfma_f32_16x16x32_bf16 v[116:119], v[242:245], v[20:23], v[116:119]
    buffer_load_dwordx4 a[76:79], v2, s[32:35], s62 offen offset:3072 sc1
    s_waitcnt lgkmcnt(6)
    v_mfma_f32_16x16x32_bf16 v[132:135], a[176:179], a[200:203], v[132:135]
    ds_read_b128 v[242:245], v8 offset:40960
    ds_read_b128 v[64:67], v9 offset:40960
    v_mfma_f32_16x16x32_bf16 v[132:135], a[180:183], a[96:99], v[132:135]
    v_mfma_f32_16x16x32_bf16 v[136:139], a[180:183], a[100:103], v[136:139]
    s_xor_b32 s62, s28, 49152
    s_add_u32 s62, s62, s60
    v_mfma_f32_16x16x32_bf16 v[136:139], a[176:179], a[204:207], v[136:139]
    buffer_load_dwordx4 a[88:91], v2, s[32:35], s62 offen offset:2048 sc1
    s_waitcnt lgkmcnt(6)
    v_mfma_f32_16x16x32_bf16 v[152:155], a[160:163], a[204:207], v[152:155]
    ds_read_b128 a[176:179], v8 offset:43008
    ds_read_b128 a[180:183], v9 offset:43008
    v_mfma_f32_16x16x32_bf16 v[152:155], a[164:167], a[100:103], v[152:155]
    v_mfma_f32_16x16x32_bf16 v[148:151], a[164:167], a[96:99], v[148:151]
    v_cvt_pk_bf16_f32 v100, v100, v101
    v_cvt_pk_bf16_f32 v101, v102, v103
    v_mfma_f32_16x16x32_bf16 v[148:151], a[160:163], a[200:203], v[148:151]
    v_cvt_pk_bf16_f32 v102, v116, v117
    s_waitcnt lgkmcnt(6)
    v_mfma_f32_16x16x32_bf16 v[132:135], a[168:171], a[112:115], v[132:135]
    ds_read_b128 a[160:163], v8 offset:57344
    ds_read_b128 a[164:167], v9 offset:57344
    v_mfma_f32_16x16x32_bf16 v[132:135], a[172:175], a[32:35], v[132:135]
    v_cvt_pk_bf16_f32 v103, v118, v119
    v_mfma_f32_16x16x32_bf16 v[136:139], a[172:175], a[36:39], v[136:139]
    s_add_u32 s7, s67, 0xa00000
    buffer_store_dwordx4 v[100:103], v2, s[40:43], s7 offen sc0 sc1
    v_mfma_f32_16x16x32_bf16 v[136:139], a[168:171], a[116:119], v[136:139]
    buffer_load_dwordx4 a[92:95], v2, s[32:35], s62 offen offset:3072 sc1
    s_waitcnt lgkmcnt(6)
    v_mfma_f32_16x16x32_bf16 v[152:155], v[228:231], a[116:119], v[152:155]
    ds_read_b128 a[168:171], v8 offset:59392
    ds_read_b128 a[172:175], v9 offset:59392
    v_mfma_f32_16x16x32_bf16 v[152:155], v[232:235], a[36:39], v[152:155]
    v_cvt_pk_bf16_f32 v104, v104, v105
    v_cvt_pk_bf16_f32 v105, v106, v107
    v_mfma_f32_16x16x32_bf16 v[148:151], v[232:235], a[32:35], v[148:151]
    v_cvt_pk_bf16_f32 v106, v120, v121
    v_cvt_pk_bf16_f32 v107, v122, v123
    v_mfma_f32_16x16x32_bf16 v[148:151], v[228:231], a[112:115], v[148:151]
    s_waitcnt lgkmcnt(6)
    v_mfma_f32_16x16x32_bf16 v[132:135], v[242:245], a[240:243], v[132:135]
    ds_read_b128 v[228:231], v10 offset:8192
    ds_read_b128 v[232:235], v11 offset:8192
    v_mfma_f32_16x16x32_bf16 v[132:135], v[64:67], a[48:51], v[132:135]
    s_add_u32 s7, s67, 0xb00000
    buffer_store_dwordx4 v[104:107], v2, s[40:43], s7 offen sc0 sc1
    v_mfma_f32_16x16x32_bf16 v[136:139], v[64:67], a[52:55], v[136:139]
    v_mfma_f32_16x16x32_bf16 v[136:139], v[242:245], a[244:247], v[136:139]
    s_waitcnt lgkmcnt(6)
    v_mfma_f32_16x16x32_bf16 v[152:155], a[176:179], a[244:247], v[152:155]
    ds_read_b128 v[242:245], v10 offset:10240
    ds_read_b128 v[64:67], v11 offset:10240
    v_mfma_f32_16x16x32_bf16 v[152:155], a[180:183], a[52:55], v[152:155]
    v_mfma_f32_16x16x32_bf16 v[148:151], a[180:183], a[48:51], v[148:151]
    s_xor_b32 s62, s28, 53248
    s_add_u32 s62, s62, s60
    v_mfma_f32_16x16x32_bf16 v[148:151], a[176:179], a[240:243], v[148:151]
    buffer_load_dwordx4 a[8:11], v2, s[32:35], s62 offen offset:2048 sc1
    s_waitcnt lgkmcnt(6)
    v_mfma_f32_16x16x32_bf16 v[132:135], a[160:163], a[184:187], v[132:135]
    ds_read_b128 a[176:179], v10 offset:24576
    ds_read_b128 a[180:183], v11 offset:24576
    v_mfma_f32_16x16x32_bf16 v[132:135], a[164:167], a[64:67], v[132:135]
    v_mfma_f32_16x16x32_bf16 v[136:139], a[164:167], a[68:71], v[136:139]
    v_mfma_f32_16x16x32_bf16 v[136:139], a[160:163], a[188:191], v[136:139]
    s_waitcnt lgkmcnt(6)
    v_mfma_f32_16x16x32_bf16 v[152:155], a[168:171], a[188:191], v[152:155]
    ds_read_b128 a[160:163], v10 offset:26624
    ds_read_b128 a[164:167], v11 offset:26624
    v_mfma_f32_16x16x32_bf16 v[152:155], a[172:175], a[68:71], v[152:155]
    v_mfma_f32_16x16x32_bf16 v[148:151], a[172:175], a[64:67], v[148:151]
    v_mfma_f32_16x16x32_bf16 v[148:151], a[168:171], a[184:187], v[148:151]
    buffer_load_dwordx4 a[12:15], v2, s[32:35], s62 offen offset:3072 sc1
    s_waitcnt lgkmcnt(6)
    v_mfma_f32_16x16x32_bf16 v[132:135], v[228:231], a[80:83], v[132:135]
    ds_read_b128 a[168:171], v8 offset:12288
    ds_read_b128 a[172:175], v9 offset:12288
    v_mfma_f32_16x16x32_bf16 v[132:135], v[232:235], a[0:3], v[132:135]
    v_mfma_f32_16x16x32_bf16 v[136:139], v[232:235], a[4:7], v[136:139]
    s_xor_b32 s62, s28, 57344
    s_add_u32 s62, s62, s60
    v_mfma_f32_16x16x32_bf16 v[136:139], v[228:231], a[84:87], v[136:139]
    buffer_load_dwordx4 v[28:31], v2, s[32:35], s62 offen offset:2048 sc1
    s_waitcnt lgkmcnt(6)
    v_mfma_f32_16x16x32_bf16 v[152:155], v[242:245], a[84:87], v[152:155]
    ds_read_b128 v[228:231], v8 offset:14336
    ds_read_b128 v[232:235], v9 offset:14336
    v_mfma_f32_16x16x32_bf16 v[152:155], v[64:67], a[4:7], v[152:155]
    v_mfma_f32_16x16x32_bf16 v[148:151], v[64:67], a[0:3], v[148:151]
    v_mfma_f32_16x16x32_bf16 v[148:151], v[242:245], a[80:83], v[148:151]
    buffer_load_dwordx4 v[32:35], v2, s[32:35], s62 offen offset:3072 sc1
    s_waitcnt lgkmcnt(6)
    v_mfma_f32_16x16x32_bf16 v[132:135], a[176:179], v[20:23], v[132:135]
    ds_read_b128 v[242:245], v8 offset:28672
    ds_read_b128 v[64:67], v9 offset:28672
    v_mfma_f32_16x16x32_bf16 v[132:135], a[180:183], v[36:39], v[132:135]
    v_mfma_f32_16x16x32_bf16 v[136:139], a[180:183], v[40:43], v[136:139]
    s_xor_b32 s62, s28, 61440
    s_add_u32 s62, s62, s60
    v_mfma_f32_16x16x32_bf16 v[136:139], a[176:179], v[24:27], v[136:139]
    buffer_load_dwordx4 v[44:47], v2, s[32:35], s62 offen offset:2048 sc1
    s_waitcnt lgkmcnt(6)
    v_mfma_f32_16x16x32_bf16 v[152:155], a[160:163], v[24:27], v[152:155]
    ds_read_b128 a[176:179], v8 offset:30720
    ds_read_b128 a[180:183], v9 offset:30720
    v_mfma_f32_16x16x32_bf16 v[152:155], a[164:167], v[40:43], v[152:155]
    v_mfma_f32_16x16x32_bf16 v[148:151], a[164:167], v[36:39], v[148:151]
    v_mfma_f32_16x16x32_bf16 v[148:151], a[160:163], v[20:23], v[148:151]
    s_waitcnt lgkmcnt(6)
    v_mfma_f32_16x16x32_bf16 v[164:167], a[168:171], a[200:203], v[164:167]
    ds_read_b128 a[160:163], v8 offset:45056
    ds_read_b128 a[164:167], v9 offset:45056
    v_mfma_f32_16x16x32_bf16 v[164:167], a[172:175], a[96:99], v[164:167]
    v_mfma_f32_16x16x32_bf16 v[168:171], a[172:175], a[100:103], v[168:171]
    v_mfma_f32_16x16x32_bf16 v[168:171], a[168:171], a[204:207], v[168:171]
    buffer_load_dwordx4 v[48:51], v2, s[32:35], s62 offen offset:3072 sc1
    s_waitcnt lgkmcnt(6)
    v_mfma_f32_16x16x32_bf16 v[184:187], v[228:231], a[204:207], v[184:187]
    ds_read_b128 a[168:171], v8 offset:47104
    ds_read_b128 a[172:175], v9 offset:47104
    v_mfma_f32_16x16x32_bf16 v[184:187], v[232:235], a[100:103], v[184:187]
    v_mfma_f32_16x16x32_bf16 v[180:183], v[232:235], a[96:99], v[180:183]
    s_xor_b32 s61, s8, 256
    s_add_u32 m0, s68, 0
    v_cvt_pk_bf16_f32 v132, v132, v133
    v_mfma_f32_16x16x32_bf16 v[180:183], v[228:231], a[200:203], v[180:183]
    buffer_load_dwordx4 v4, s[44:47], s61 offen lds
    s_waitcnt lgkmcnt(6)
    v_mfma_f32_16x16x32_bf16 v[164:167], v[242:245], a[112:115], v[164:167]
    ds_read_b128 v[228:231], v8 offset:61440
    ds_read_b128 v[232:235], v9 offset:61440
    v_mfma_f32_16x16x32_bf16 v[164:167], v[64:67], a[32:35], v[164:167]
    v_cvt_pk_bf16_f32 v133, v134, v135
    v_cvt_pk_bf16_f32 v134, v148, v149
    v_mfma_f32_16x16x32_bf16 v[168:171], v[64:67], a[36:39], v[168:171]
    s_xor_b32 s61, s8, 384
    s_add_u32 m0, s68, 16384
    v_cvt_pk_bf16_f32 v135, v150, v151
    v_mfma_f32_16x16x32_bf16 v[168:171], v[242:245], a[116:119], v[168:171]
    buffer_load_dwordx4 v4, s[44:47], s61 offen lds
    s_waitcnt lgkmcnt(6)
    v_mfma_f32_16x16x32_bf16 v[184:187], a[176:179], a[116:119], v[184:187]
    ds_read_b128 v[242:245], v8 offset:63488
    ds_read_b128 v[64:67], v9 offset:63488
    v_mfma_f32_16x16x32_bf16 v[184:187], a[180:183], a[36:39], v[184:187]
    s_add_u32 s7, s67, 0x800000
    buffer_store_dwordx4 v[132:135], v2, s[40:43], s7 offen sc0 sc1
    v_mfma_f32_16x16x32_bf16 v[180:183], a[180:183], a[32:35], v[180:183]
    v_cvt_pk_bf16_f32 v136, v136, v137
    v_cvt_pk_bf16_f32 v137, v138, v139
    v_mfma_f32_16x16x32_bf16 v[180:183], a[176:179], a[112:115], v[180:183]
    v_cvt_pk_bf16_f32 v138, v152, v153
    s_waitcnt lgkmcnt(6)
    v_mfma_f32_16x16x32_bf16 v[164:167], a[160:163], a[240:243], v[164:167]
    ds_read_b128 a[176:179], v10 offset:12288
    ds_read_b128 a[180:183], v11 offset:12288
    v_mfma_f32_16x16x32_bf16 v[164:167], a[164:167], a[48:51], v[164:167]
    v_cvt_pk_bf16_f32 v139, v154, v155
    v_mfma_f32_16x16x32_bf16 v[168:171], a[164:167], a[52:55], v[168:171]
    s_xor_b32 s61, s8, 0
    s_add_u32 m0, s68, 32768
    v_mfma_f32_16x16x32_bf16 v[168:171], a[160:163], a[244:247], v[168:171]
    buffer_load_dwordx4 v4, s[36:39], s61 offen lds
    s_waitcnt lgkmcnt(6)
    v_mfma_f32_16x16x32_bf16 v[184:187], a[168:171], a[244:247], v[184:187]
    ds_read_b128 a[160:163], v10 offset:14336
    ds_read_b128 a[164:167], v11 offset:14336
    v_mfma_f32_16x16x32_bf16 v[184:187], a[172:175], a[52:55], v[184:187]
    s_add_u32 s7, s67, 0x900000
    buffer_store_dwordx4 v[136:139], v2, s[40:43], s7 offen sc0 sc1
    v_mfma_f32_16x16x32_bf16 v[180:183], a[172:175], a[48:51], v[180:183]
    v_mfma_f32_16x16x32_bf16 v[180:183], a[168:171], a[240:243], v[180:183]
    s_waitcnt lgkmcnt(6)
    v_mfma_f32_16x16x32_bf16 v[164:167], v[228:231], a[184:187], v[164:167]
    ds_read_b128 a[168:171], v10 offset:28672
    ds_read_b128 a[172:175], v11 offset:28672
    v_mfma_f32_16x16x32_bf16 v[164:167], v[232:235], a[64:67], v[164:167]
    v_mfma_f32_16x16x32_bf16 v[168:171], v[232:235], a[68:71], v[168:171]
    v_mfma_f32_16x16x32_bf16 v[168:171], v[228:231], a[188:191], v[168:171]
    s_waitcnt lgkmcnt(6)
    v_mfma_f32_16x16x32_bf16 v[184:187], v[242:245], a[188:191], v[184:187]
    ds_read_b128 v[228:231], v10 offset:30720
    ds_read_b128 v[232:235], v11 offset:30720
    v_mfma_f32_16x16x32_bf16 v[184:187], v[64:67], a[68:71], v[184:187]
    v_mfma_f32_16x16x32_bf16 v[180:183], v[64:67], a[64:67], v[180:183]
    s_xor_b32 s61, s8, 128
    s_add_u32 m0, s68, 49152
    v_mfma_f32_16x16x32_bf16 v[180:183], v[242:245], a[184:187], v[180:183]
    buffer_load_dwordx4 v4, s[36:39], s61 offen lds
    s_waitcnt lgkmcnt(6)
    v_mfma_f32_16x16x32_bf16 v[164:167], a[176:179], a[80:83], v[164:167]
    ds_read_b128 v[242:245], v8 offset:4096
    ds_read_b128 v[64:67], v9 offset:4096
    v_mfma_f32_16x16x32_bf16 v[164:167], a[180:183], a[0:3], v[164:167]
    v_mfma_f32_16x16x32_bf16 v[168:171], a[180:183], a[4:7], v[168:171]
    s_xor_b32 s61, s8, 256
    s_add_u32 m0, s68, 65536
    v_mfma_f32_16x16x32_bf16 v[168:171], a[176:179], a[84:87], v[168:171]
    buffer_load_dwordx4 v4, s[36:39], s61 offen lds
    s_waitcnt lgkmcnt(6)
    v_mfma_f32_16x16x32_bf16 v[184:187], a[160:163], a[84:87], v[184:187]
    ds_read_b128 a[176:179], v8 offset:6144
    ds_read_b128 a[180:183], v9 offset:6144
    v_mfma_f32_16x16x32_bf16 v[184:187], a[164:167], a[4:7], v[184:187]
    v_mfma_f32_16x16x32_bf16 v[180:183], a[164:167], a[0:3], v[180:183]
    s_xor_b32 s61, s8, 384
    s_add_u32 m0, s68, 81920
    v_mfma_f32_16x16x32_bf16 v[180:183], a[160:163], a[80:83], v[180:183]
    buffer_load_dwordx4 v4, s[36:39], s61 offen lds
    s_waitcnt lgkmcnt(6)
    v_mfma_f32_16x16x32_bf16 v[164:167], a[168:171], v[20:23], v[164:167]
    ds_read_b128 a[160:163], v8 offset:20480
    ds_read_b128 a[164:167], v9 offset:20480
    v_mfma_f32_16x16x32_bf16 v[164:167], a[172:175], v[36:39], v[164:167]
    v_mfma_f32_16x16x32_bf16 v[168:171], a[172:175], v[40:43], v[168:171]
    v_mfma_f32_16x16x32_bf16 v[168:171], a[168:171], v[24:27], v[168:171]
    s_waitcnt lgkmcnt(6)
    v_mfma_f32_16x16x32_bf16 v[184:187], v[228:231], v[24:27], v[184:187]
    ds_read_b128 a[168:171], v8 offset:22528
    ds_read_b128 a[172:175], v9 offset:22528
    v_mfma_f32_16x16x32_bf16 v[184:187], v[232:235], v[40:43], v[184:187]
    v_mfma_f32_16x16x32_bf16 v[180:183], v[232:235], v[36:39], v[180:183]
    v_mfma_f32_16x16x32_bf16 v[180:183], v[228:231], v[20:23], v[180:183]
    s_waitcnt vmcnt(28) lgkmcnt(6)
    v_mfma_f32_16x16x32_bf16 v[108:111], v[242:245], a[208:211], v[108:111]
    ds_read_b128 v[228:231], v8 offset:36864
    ds_read_b128 v[232:235], v9 offset:36864
    v_mfma_f32_16x16x32_bf16 v[108:111], v[64:67], a[104:107], v[108:111]
    v_mfma_f32_16x16x32_bf16 v[112:115], v[64:67], a[108:111], v[112:115]
    v_mfma_f32_16x16x32_bf16 v[112:115], v[242:245], a[212:215], v[112:115]
    s_waitcnt lgkmcnt(6)
    v_mfma_f32_16x16x32_bf16 v[128:131], a[176:179], a[212:215], v[128:131]
    ds_read_b128 v[242:245], v8 offset:38912
    ds_read_b128 v[64:67], v9 offset:38912
    v_mfma_f32_16x16x32_bf16 v[128:131], a[180:183], a[108:111], v[128:131]
    v_mfma_f32_16x16x32_bf16 v[124:127], a[180:183], a[104:107], v[124:127]
    v_cvt_pk_bf16_f32 v164, v164, v165
    v_cvt_pk_bf16_f32 v165, v166, v167
    v_mfma_f32_16x16x32_bf16 v[124:127], a[176:179], a[208:211], v[124:127]
    v_cvt_pk_bf16_f32 v166, v180, v181
    s_waitcnt vmcnt(24) lgkmcnt(6)
    v_mfma_f32_16x16x32_bf16 v[108:111], a[160:163], a[120:123], v[108:111]
    ds_read_b128 a[176:179], v8 offset:53248
    ds_read_b128 a[180:183], v9 offset:53248
    v_mfma_f32_16x16x32_bf16 v[108:111], a[164:167], a[40:43], v[108:111]
    v_cvt_pk_bf16_f32 v167, v182, v183
    v_mfma_f32_16x16x32_bf16 v[112:115], a[164:167], a[44:47], v[112:115]
    s_add_u32 s7, s67, 0x600000
    buffer_store_dwordx4 v[164:167], v2, s[40:43], s7 offen sc0 sc1
    v_mfma_f32_16x16x32_bf16 v[112:115], a[160:163], a[124:127], v[112:115]
    v_cvt_pk_bf16_f32 v168, v168, v169
    s_waitcnt lgkmcnt(6)
    v_mfma_f32_16x16x32_bf16 v[128:131], a[168:171], a[124:127], v[128:131]
    ds_read_b128 a[160:163], v8 offset:55296
    ds_read_b128 a[164:167], v9 offset:55296
    v_mfma_f32_16x16x32_bf16 v[128:131], a[172:175], a[44:47], v[128:131]
    v_cvt_pk_bf16_f32 v169, v170, v171
    v_cvt_pk_bf16_f32 v170, v184, v185
    v_mfma_f32_16x16x32_bf16 v[124:127], a[172:175], a[40:43], v[124:127]
    v_cvt_pk_bf16_f32 v171, v186, v187
    v_mfma_f32_16x16x32_bf16 v[124:127], a[168:171], a[120:123], v[124:127]
    s_waitcnt vmcnt(23) lgkmcnt(6)
    v_mfma_f32_16x16x32_bf16 v[108:111], v[228:231], a[248:251], v[108:111]
    ds_read_b128 a[168:171], v10 offset:4096
    ds_read_b128 a[172:175], v11 offset:4096
    v_mfma_f32_16x16x32_bf16 v[108:111], v[232:235], a[56:59], v[108:111]
    s_add_u32 s7, s67, 0x700000
    buffer_store_dwordx4 v[168:171], v2, s[40:43], s7 offen sc0 sc1
    v_mfma_f32_16x16x32_bf16 v[112:115], v[232:235], a[60:63], v[112:115]
    s_xor_b32 s27, s67, 0xa40000
    buffer_load_dwordx4 v[116:119], v2, s[40:43], s27 offen sc0 sc1
    v_mfma_f32_16x16x32_bf16 v[112:115], v[228:231], a[252:255], v[112:115]
    s_waitcnt lgkmcnt(6)
    v_mfma_f32_16x16x32_bf16 v[128:131], v[242:245], a[252:255], v[128:131]
    ds_read_b128 v[228:231], v10 offset:6144
    ds_read_b128 v[232:235], v11 offset:6144
    v_mfma_f32_16x16x32_bf16 v[128:131], v[64:67], a[60:63], v[128:131]
    s_xor_b32 s27, s67, 0xb40000
    buffer_load_dwordx4 v[120:123], v2, s[40:43], s27 offen sc0 sc1
    v_mfma_f32_16x16x32_bf16 v[124:127], v[64:67], a[56:59], v[124:127]
    v_mfma_f32_16x16x32_bf16 v[124:127], v[242:245], a[248:251], v[124:127]
    s_waitcnt vmcnt(22) lgkmcnt(6)
    v_mfma_f32_16x16x32_bf16 v[108:111], a[176:179], a[192:195], v[108:111]
    ds_read_b128 v[242:245], v10 offset:20480
    ds_read_b128 v[64:67], v11 offset:20480
    v_mfma_f32_16x16x32_bf16 v[108:111], a[180:183], a[72:75], v[108:111]
    v_mfma_f32_16x16x32_bf16 v[112:115], a[180:183], a[76:79], v[112:115]
    v_mfma_f32_16x16x32_bf16 v[112:115], a[176:179], a[196:199], v[112:115]
    s_waitcnt lgkmcnt(6)
    v_mfma_f32_16x16x32_bf16 v[128:131], a[160:163], a[196:199], v[128:131]
    ds_read_b128 a[176:179], v10 offset:22528
    ds_read_b128 a[180:183], v11 offset:22528
    v_mfma_f32_16x16x32_bf16 v[128:131], a[164:167], a[76:79], v[128:131]
    v_mfma_f32_16x16x32_bf16 v[124:127], a[164:167], a[72:75], v[124:127]
    v_mfma_f32_16x16x32_bf16 v[124:127], a[160:163], a[192:195], v[124:127]
    s_waitcnt vmcnt(16) lgkmcnt(6)
    v_mfma_f32_16x16x32_bf16 v[108:111], a[168:171], a[88:91], v[108:111]
    ds_read_b128 a[160:163], v8 offset:8192
    ds_read_b128 a[164:167], v9 offset:8192
    v_mfma_f32_16x16x32_bf16 v[108:111], a[172:175], a[8:11], v[108:111]
    v_mfma_f32_16x16x32_bf16 v[112:115], a[172:175], a[12:15], v[112:115]
    v_mfma_f32_16x16x32_bf16 v[112:115], a[168:171], a[92:95], v[112:115]
    s_waitcnt lgkmcnt(6)
    v_mfma_f32_16x16x32_bf16 v[128:131], v[228:231], a[92:95], v[128:131]
    ds_read_b128 a[168:171], v8 offset:10240
    ds_read_b128 a[172:175], v9 offset:10240
    v_mfma_f32_16x16x32_bf16 v[128:131], v[232:235], a[12:15], v[128:131]
    v_mfma_f32_16x16x32_bf16 v[124:127], v[232:235], a[8:11], v[124:127]
    v_mfma_f32_16x16x32_bf16 v[124:127], v[228:231], a[88:91], v[124:127]
    s_waitcnt vmcnt(12) lgkmcnt(6)
    v_mfma_f32_16x16x32_bf16 v[108:111], v[242:245], v[28:31], v[108:111]
    ds_read_b128 v[228:231], v8 offset:24576
    ds_read_b128 v[232:235], v9 offset:24576
    v_mfma_f32_16x16x32_bf16 v[108:111], v[64:67], v[44:47], v[108:111]
    v_mfma_f32_16x16x32_bf16 v[112:115], v[64:67], v[48:51], v[112:115]
    v_mfma_f32_16x16x32_bf16 v[112:115], v[242:245], v[32:35], v[112:115]
    s_waitcnt lgkmcnt(6)
    v_mfma_f32_16x16x32_bf16 v[128:131], a[176:179], v[32:35], v[128:131]
    ds_read_b128 v[242:245], v8 offset:26624
    ds_read_b128 v[64:67], v9 offset:26624
    v_mfma_f32_16x16x32_bf16 v[128:131], a[180:183], v[48:51], v[128:131]
    v_mfma_f32_16x16x32_bf16 v[124:127], a[180:183], v[44:47], v[124:127]
    v_mfma_f32_16x16x32_bf16 v[124:127], a[176:179], v[28:31], v[124:127]
    s_waitcnt lgkmcnt(6)
    v_mfma_f32_16x16x32_bf16 v[140:143], a[160:163], a[208:211], v[140:143]
    ds_read_b128 a[176:179], v8 offset:40960
    ds_read_b128 a[180:183], v9 offset:40960
    v_mfma_f32_16x16x32_bf16 v[140:143], a[164:167], a[104:107], v[140:143]
    v_mfma_f32_16x16x32_bf16 v[144:147], a[164:167], a[108:111], v[144:147]
    v_mfma_f32_16x16x32_bf16 v[144:147], a[160:163], a[212:215], v[144:147]
    s_waitcnt lgkmcnt(6)
    v_mfma_f32_16x16x32_bf16 v[160:163], a[168:171], a[212:215], v[160:163]
    ds_read_b128 a[160:163], v8 offset:43008
    ds_read_b128 a[164:167], v9 offset:43008
    v_mfma_f32_16x16x32_bf16 v[160:163], a[172:175], a[108:111], v[160:163]
    v_mfma_f32_16x16x32_bf16 v[156:159], a[172:175], a[104:107], v[156:159]
    v_cvt_pk_bf16_f32 v108, v108, v109
    v_cvt_pk_bf16_f32 v109, v110, v111
    v_mfma_f32_16x16x32_bf16 v[156:159], a[168:171], a[208:211], v[156:159]
    v_cvt_pk_bf16_f32 v110, v124, v125
    s_waitcnt lgkmcnt(6)
    v_mfma_f32_16x16x32_bf16 v[140:143], v[228:231], a[120:123], v[140:143]
    ds_read_b128 a[168:171], v8 offset:57344
    ds_read_b128 a[172:175], v9 offset:57344
    v_mfma_f32_16x16x32_bf16 v[140:143], v[232:235], a[40:43], v[140:143]
    v_cvt_pk_bf16_f32 v111, v126, v127
    v_mfma_f32_16x16x32_bf16 v[144:147], v[232:235], a[44:47], v[144:147]
    s_add_u32 s7, s67, 0x400000
    buffer_store_dwordx4 v[108:111], v2, s[40:43], s7 offen sc0 sc1
    v_mfma_f32_16x16x32_bf16 v[144:147], v[228:231], a[124:127], v[144:147]
    v_cvt_pk_bf16_f32 v112, v112, v113
    s_waitcnt lgkmcnt(6)
    v_mfma_f32_16x16x32_bf16 v[160:163], v[242:245], a[124:127], v[160:163]
    ds_read_b128 v[228:231], v8 offset:59392
    ds_read_b128 v[232:235], v9 offset:59392
    v_mfma_f32_16x16x32_bf16 v[160:163], v[64:67], a[44:47], v[160:163]
    v_cvt_pk_bf16_f32 v113, v114, v115
    v_cvt_pk_bf16_f32 v114, v128, v129
    v_mfma_f32_16x16x32_bf16 v[156:159], v[64:67], a[40:43], v[156:159]
    v_cvt_pk_bf16_f32 v115, v130, v131
    v_mfma_f32_16x16x32_bf16 v[156:159], v[242:245], a[120:123], v[156:159]
    s_waitcnt lgkmcnt(6)
    v_mfma_f32_16x16x32_bf16 v[140:143], a[176:179], a[248:251], v[140:143]
    ds_read_b128 v[242:245], v10 offset:8192
    ds_read_b128 v[64:67], v11 offset:8192
    v_mfma_f32_16x16x32_bf16 v[140:143], a[180:183], a[56:59], v[140:143]
    s_add_u32 s7, s67, 0x500000
    buffer_store_dwordx4 v[112:115], v2, s[40:43], s7 offen sc0 sc1
    v_mfma_f32_16x16x32_bf16 v[144:147], a[180:183], a[60:63], v[144:147]
    s_xor_b32 s27, s67, 0x880000
    buffer_load_dwordx4 v[148:151], v2, s[40:43], s27 offen sc0 sc1
    v_mfma_f32_16x16x32_bf16 v[144:147], a[176:179], a[252:255], v[144:147]
    s_waitcnt lgkmcnt(6)
    v_mfma_f32_16x16x32_bf16 v[160:163], a[160:163], a[252:255], v[160:163]
    ds_read_b128 a[176:179], v10 offset:10240
    ds_read_b128 a[180:183], v11 offset:10240
    v_mfma_f32_16x16x32_bf16 v[160:163], a[164:167], a[60:63], v[160:163]
    s_xor_b32 s27, s67, 0x980000
    buffer_load_dwordx4 v[152:155], v2, s[40:43], s27 offen sc0 sc1
    v_mfma_f32_16x16x32_bf16 v[156:159], a[164:167], a[56:59], v[156:159]
    v_mfma_f32_16x16x32_bf16 v[156:159], a[160:163], a[248:251], v[156:159]
    s_waitcnt lgkmcnt(6)
    v_mfma_f32_16x16x32_bf16 v[140:143], a[168:171], a[192:195], v[140:143]
    ds_read_b128 a[160:163], v10 offset:24576
    ds_read_b128 a[164:167], v11 offset:24576
    v_mfma_f32_16x16x32_bf16 v[140:143], a[172:175], a[72:75], v[140:143]
    v_mfma_f32_16x16x32_bf16 v[144:147], a[172:175], a[76:79], v[144:147]
    v_mfma_f32_16x16x32_bf16 v[144:147], a[168:171], a[196:199], v[144:147]
    s_waitcnt lgkmcnt(6)
    v_mfma_f32_16x16x32_bf16 v[160:163], v[228:231], a[196:199], v[160:163]
    ds_read_b128 a[168:171], v10 offset:26624
    ds_read_b128 a[172:175], v11 offset:26624
    v_mfma_f32_16x16x32_bf16 v[160:163], v[232:235], a[76:79], v[160:163]
    v_mfma_f32_16x16x32_bf16 v[156:159], v[232:235], a[72:75], v[156:159]
    v_mfma_f32_16x16x32_bf16 v[156:159], v[228:231], a[192:195], v[156:159]
    s_waitcnt lgkmcnt(6)
    v_mfma_f32_16x16x32_bf16 v[140:143], v[242:245], a[88:91], v[140:143]
    ds_read_b128 v[228:231], v8 offset:12288
    ds_read_b128 v[232:235], v9 offset:12288
    v_mfma_f32_16x16x32_bf16 v[140:143], v[64:67], a[8:11], v[140:143]
    v_mfma_f32_16x16x32_bf16 v[144:147], v[64:67], a[12:15], v[144:147]
    v_mfma_f32_16x16x32_bf16 v[144:147], v[242:245], a[92:95], v[144:147]
    s_waitcnt lgkmcnt(6)
    v_mfma_f32_16x16x32_bf16 v[160:163], a[176:179], a[92:95], v[160:163]
    ds_read_b128 v[242:245], v8 offset:14336
    ds_read_b128 v[64:67], v9 offset:14336
    v_mfma_f32_16x16x32_bf16 v[160:163], a[180:183], a[12:15], v[160:163]
    v_mfma_f32_16x16x32_bf16 v[156:159], a[180:183], a[8:11], v[156:159]
    v_mfma_f32_16x16x32_bf16 v[156:159], a[176:179], a[88:91], v[156:159]
    s_waitcnt lgkmcnt(6)
    v_mfma_f32_16x16x32_bf16 v[140:143], a[160:163], v[28:31], v[140:143]
    ds_read_b128 a[176:179], v8 offset:28672
    ds_read_b128 a[180:183], v9 offset:28672
    v_mfma_f32_16x16x32_bf16 v[140:143], a[164:167], v[44:47], v[140:143]
    v_mfma_f32_16x16x32_bf16 v[144:147], a[164:167], v[48:51], v[144:147]
    v_mfma_f32_16x16x32_bf16 v[144:147], a[160:163], v[32:35], v[144:147]
    s_waitcnt lgkmcnt(6)
    v_mfma_f32_16x16x32_bf16 v[160:163], a[168:171], v[32:35], v[160:163]
    ds_read_b128 a[160:163], v8 offset:30720
    ds_read_b128 a[164:167], v9 offset:30720
    v_mfma_f32_16x16x32_bf16 v[160:163], a[172:175], v[48:51], v[160:163]
    v_mfma_f32_16x16x32_bf16 v[156:159], a[172:175], v[44:47], v[156:159]
    v_mfma_f32_16x16x32_bf16 v[156:159], a[168:171], v[28:31], v[156:159]
    s_waitcnt lgkmcnt(6)
    v_mfma_f32_16x16x32_bf16 v[172:175], v[228:231], a[208:211], v[172:175]
    ds_read_b128 a[168:171], v8 offset:45056
    ds_read_b128 a[172:175], v9 offset:45056
    v_mfma_f32_16x16x32_bf16 v[172:175], v[232:235], a[104:107], v[172:175]
    v_mfma_f32_16x16x32_bf16 v[176:179], v[232:235], a[108:111], v[176:179]
    v_mfma_f32_16x16x32_bf16 v[176:179], v[228:231], a[212:215], v[176:179]
    s_waitcnt lgkmcnt(6)
    v_mfma_f32_16x16x32_bf16 v[192:195], v[242:245], a[212:215], v[192:195]
    ds_read_b128 v[228:231], v8 offset:47104
    ds_read_b128 v[232:235], v9 offset:47104
    v_mfma_f32_16x16x32_bf16 v[192:195], v[64:67], a[108:111], v[192:195]
    v_mfma_f32_16x16x32_bf16 v[188:191], v[64:67], a[104:107], v[188:191]
    v_cvt_pk_bf16_f32 v140, v140, v141
    v_cvt_pk_bf16_f32 v141, v142, v143
    v_mfma_f32_16x16x32_bf16 v[188:191], v[242:245], a[208:211], v[188:191]
    v_cvt_pk_bf16_f32 v142, v156, v157
    s_waitcnt lgkmcnt(6)
    v_mfma_f32_16x16x32_bf16 v[172:175], a[176:179], a[120:123], v[172:175]
    ds_read_b128 v[242:245], v8 offset:61440
    ds_read_b128 v[64:67], v9 offset:61440
    v_mfma_f32_16x16x32_bf16 v[172:175], a[180:183], a[40:43], v[172:175]
    v_cvt_pk_bf16_f32 v143, v158, v159
    v_mfma_f32_16x16x32_bf16 v[176:179], a[180:183], a[44:47], v[176:179]
    s_add_u32 s7, s67, 0x200000
    buffer_store_dwordx4 v[140:143], v2, s[40:43], s7 offen sc0 sc1
    v_mfma_f32_16x16x32_bf16 v[176:179], a[176:179], a[124:127], v[176:179]
    v_cvt_pk_bf16_f32 v144, v144, v145
    s_waitcnt lgkmcnt(6)
    v_mfma_f32_16x16x32_bf16 v[192:195], a[160:163], a[124:127], v[192:195]
    ds_read_b128 a[176:179], v8 offset:63488
    ds_read_b128 a[180:183], v9 offset:63488
    v_mfma_f32_16x16x32_bf16 v[192:195], a[164:167], a[44:47], v[192:195]
    v_cvt_pk_bf16_f32 v145, v146, v147
    v_cvt_pk_bf16_f32 v146, v160, v161
    v_mfma_f32_16x16x32_bf16 v[188:191], a[164:167], a[40:43], v[188:191]
    v_cvt_pk_bf16_f32 v147, v162, v163
    v_mfma_f32_16x16x32_bf16 v[188:191], a[160:163], a[120:123], v[188:191]
    s_waitcnt lgkmcnt(6)
    v_mfma_f32_16x16x32_bf16 v[172:175], a[168:171], a[248:251], v[172:175]
    ds_read_b128 a[160:163], v10 offset:12288
    ds_read_b128 a[164:167], v11 offset:12288
    v_mfma_f32_16x16x32_bf16 v[172:175], a[172:175], a[56:59], v[172:175]
    s_add_u32 s7, s67, 0x300000
    buffer_store_dwordx4 v[144:147], v2, s[40:43], s7 offen sc0 sc1
    v_mfma_f32_16x16x32_bf16 v[176:179], a[172:175], a[60:63], v[176:179]
    s_xor_b32 s27, s67, 0x6c0000
    buffer_load_dwordx4 v[180:183], v2, s[40:43], s27 offen sc0 sc1
    v_mfma_f32_16x16x32_bf16 v[176:179], a[168:171], a[252:255], v[176:179]
    s_waitcnt lgkmcnt(6)
    v_mfma_f32_16x16x32_bf16 v[192:195], v[228:231], a[252:255], v[192:195]
    ds_read_b128 a[168:171], v10 offset:14336
    ds_read_b128 a[172:175], v11 offset:14336
    v_mfma_f32_16x16x32_bf16 v[192:195], v[232:235], a[60:63], v[192:195]
    s_xor_b32 s27, s67, 0x7c0000
    buffer_load_dwordx4 v[184:187], v2, s[40:43], s27 offen sc0 sc1
    v_mfma_f32_16x16x32_bf16 v[188:191], v[232:235], a[56:59], v[188:191]
    v_mfma_f32_16x16x32_bf16 v[188:191], v[228:231], a[248:251], v[188:191]
    s_waitcnt lgkmcnt(6)
    v_mfma_f32_16x16x32_bf16 v[172:175], v[242:245], a[192:195], v[172:175]
    ds_read_b128 v[228:231], v10 offset:28672
    ds_read_b128 v[232:235], v11 offset:28672
    v_mfma_f32_16x16x32_bf16 v[172:175], v[64:67], a[72:75], v[172:175]
    v_mfma_f32_16x16x32_bf16 v[176:179], v[64:67], a[76:79], v[176:179]
    v_mfma_f32_16x16x32_bf16 v[176:179], v[242:245], a[196:199], v[176:179]
    s_waitcnt lgkmcnt(6)
    v_mfma_f32_16x16x32_bf16 v[192:195], a[176:179], a[196:199], v[192:195]
    ds_read_b128 v[242:245], v10 offset:30720
    ds_read_b128 v[64:67], v11 offset:30720
    v_mfma_f32_16x16x32_bf16 v[192:195], a[180:183], a[76:79], v[192:195]
    v_mfma_f32_16x16x32_bf16 v[188:191], a[180:183], a[72:75], v[188:191]
    v_mfma_f32_16x16x32_bf16 v[188:191], a[176:179], a[192:195], v[188:191]
    s_waitcnt vmcnt(12) lgkmcnt(6)
    s_barrier
    v_mfma_f32_16x16x32_bf16 v[172:175], a[160:163], a[88:91], v[172:175]
    ds_read_b128 a[176:179], v8 offset:0
    ds_read_b128 a[180:183], v9 offset:0
    v_mfma_f32_16x16x32_bf16 v[172:175], a[164:167], a[8:11], v[172:175]
    v_mfma_f32_16x16x32_bf16 v[176:179], a[164:167], a[12:15], v[176:179]
    v_mfma_f32_16x16x32_bf16 v[176:179], a[160:163], a[92:95], v[176:179]
    s_waitcnt lgkmcnt(6)
    v_mfma_f32_16x16x32_bf16 v[192:195], a[168:171], a[92:95], v[192:195]
    ds_read_b128 a[160:163], v8 offset:2048
    ds_read_b128 a[164:167], v9 offset:2048
    v_mfma_f32_16x16x32_bf16 v[192:195], a[172:175], a[12:15], v[192:195]
    v_mfma_f32_16x16x32_bf16 v[188:191], a[172:175], a[8:11], v[188:191]
    v_mfma_f32_16x16x32_bf16 v[188:191], a[168:171], a[88:91], v[188:191]
    s_waitcnt lgkmcnt(6)
    v_mfma_f32_16x16x32_bf16 v[172:175], v[228:231], v[28:31], v[172:175]
    ds_read_b128 a[168:171], v8 offset:16384
    ds_read_b128 a[172:175], v9 offset:16384
    v_mfma_f32_16x16x32_bf16 v[172:175], v[232:235], v[44:47], v[172:175]
    v_mfma_f32_16x16x32_bf16 v[176:179], v[232:235], v[48:51], v[176:179]
    v_mfma_f32_16x16x32_bf16 v[176:179], v[228:231], v[32:35], v[176:179]
    s_waitcnt lgkmcnt(6)
    v_mfma_f32_16x16x32_bf16 v[192:195], v[242:245], v[32:35], v[192:195]
    ds_read_b128 v[228:231], v8 offset:18432
    ds_read_b128 v[232:235], v9 offset:18432
    v_mfma_f32_16x16x32_bf16 v[192:195], v[64:67], v[48:51], v[192:195]
    v_mfma_f32_16x16x32_bf16 v[188:191], v[64:67], v[44:47], v[188:191]
    v_mfma_f32_16x16x32_bf16 v[188:191], v[242:245], v[28:31], v[188:191]
    s_waitcnt lgkmcnt(6)
    v_mfma_f32_16x16x32_bf16 v[68:71], a[176:179], a[200:203], v[68:71]
    ds_read_b128 v[242:245], v8 offset:32768
    ds_read_b128 v[64:67], v9 offset:32768
    v_mfma_f32_16x16x32_bf16 v[68:71], a[180:183], a[96:99], v[68:71]
    v_mfma_f32_16x16x32_bf16 v[72:75], a[180:183], a[100:103], v[72:75]
    v_mfma_f32_16x16x32_bf16 v[72:75], a[176:179], a[204:207], v[72:75]
    s_waitcnt lgkmcnt(6)
    v_mfma_f32_16x16x32_bf16 v[88:91], a[160:163], a[204:207], v[88:91]
    ds_read_b128 a[176:179], v8 offset:34816
    ds_read_b128 a[180:183], v9 offset:34816
    v_mfma_f32_16x16x32_bf16 v[88:91], a[164:167], a[100:103], v[88:91]
    v_mfma_f32_16x16x32_bf16 v[84:87], a[164:167], a[96:99], v[84:87]
    v_cvt_pk_bf16_f32 v172, v172, v173
    v_cvt_pk_bf16_f32 v173, v174, v175
    v_mfma_f32_16x16x32_bf16 v[84:87], a[160:163], a[200:203], v[84:87]
    v_cvt_pk_bf16_f32 v174, v188, v189
    s_waitcnt lgkmcnt(6)
    v_mfma_f32_16x16x32_bf16 v[68:71], a[168:171], a[112:115], v[68:71]
    ds_read_b128 a[160:163], v8 offset:49152
    ds_read_b128 a[164:167], v9 offset:49152
    v_mfma_f32_16x16x32_bf16 v[68:71], a[172:175], a[32:35], v[68:71]
    v_cvt_pk_bf16_f32 v175, v190, v191
    v_mfma_f32_16x16x32_bf16 v[72:75], a[172:175], a[36:39], v[72:75]
    s_add_u32 s7, s67, 0x0
    buffer_store_dwordx4 v[172:175], v2, s[40:43], s7 offen sc0 sc1
    v_mfma_f32_16x16x32_bf16 v[72:75], a[168:171], a[116:119], v[72:75]
    v_cvt_pk_bf16_f32 v176, v176, v177
    s_waitcnt lgkmcnt(6)
    v_mfma_f32_16x16x32_bf16 v[88:91], v[228:231], a[116:119], v[88:91]
    ds_read_b128 a[168:171], v8 offset:51200
    ds_read_b128 a[172:175], v9 offset:51200
    v_mfma_f32_16x16x32_bf16 v[88:91], v[232:235], a[36:39], v[88:91]
    v_cvt_pk_bf16_f32 v177, v178, v179
    v_cvt_pk_bf16_f32 v178, v192, v193
    v_mfma_f32_16x16x32_bf16 v[84:87], v[232:235], a[32:35], v[84:87]
    v_cvt_pk_bf16_f32 v179, v194, v195
    v_mfma_f32_16x16x32_bf16 v[84:87], v[228:231], a[112:115], v[84:87]
    s_waitcnt lgkmcnt(6)
    v_mfma_f32_16x16x32_bf16 v[68:71], v[242:245], a[240:243], v[68:71]
    ds_read_b128 v[228:231], v10 offset:0
    ds_read_b128 v[232:235], v11 offset:0
    v_mfma_f32_16x16x32_bf16 v[68:71], v[64:67], a[48:51], v[68:71]
    s_add_u32 s7, s67, 0x100000
    buffer_store_dwordx4 v[176:179], v2, s[40:43], s7 offen sc0 sc1
    v_mfma_f32_16x16x32_bf16 v[72:75], v[64:67], a[52:55], v[72:75]
    s_xor_b32 s27, s67, 0x440000
    buffer_load_dwordx4 v[124:127], v2, s[40:43], s27 offen sc0 sc1
    v_mfma_f32_16x16x32_bf16 v[72:75], v[242:245], a[244:247], v[72:75]
    s_waitcnt lgkmcnt(6)
    v_mfma_f32_16x16x32_bf16 v[88:91], a[176:179], a[244:247], v[88:91]
    ds_read_b128 v[242:245], v10 offset:2048
    ds_read_b128 v[64:67], v11 offset:2048
    v_mfma_f32_16x16x32_bf16 v[88:91], a[180:183], a[52:55], v[88:91]
    s_xor_b32 s27, s67, 0x540000
    buffer_load_dwordx4 v[128:131], v2, s[40:43], s27 offen sc0 sc1
    v_mfma_f32_16x16x32_bf16 v[84:87], a[180:183], a[48:51], v[84:87]
    v_mfma_f32_16x16x32_bf16 v[84:87], a[176:179], a[240:243], v[84:87]
    s_waitcnt lgkmcnt(6)
    v_mfma_f32_16x16x32_bf16 v[68:71], a[160:163], a[184:187], v[68:71]
    ds_read_b128 a[176:179], v10 offset:16384
    ds_read_b128 a[180:183], v11 offset:16384
    v_mfma_f32_16x16x32_bf16 v[68:71], a[164:167], a[64:67], v[68:71]
    v_mfma_f32_16x16x32_bf16 v[72:75], a[164:167], a[68:71], v[72:75]
    v_mfma_f32_16x16x32_bf16 v[72:75], a[160:163], a[188:191], v[72:75]
    s_waitcnt lgkmcnt(6)
    v_mfma_f32_16x16x32_bf16 v[88:91], a[168:171], a[188:191], v[88:91]
    ds_read_b128 a[160:163], v10 offset:18432
    ds_read_b128 a[164:167], v11 offset:18432
    v_mfma_f32_16x16x32_bf16 v[88:91], a[172:175], a[68:71], v[88:91]
    v_mfma_f32_16x16x32_bf16 v[84:87], a[172:175], a[64:67], v[84:87]
    v_mfma_f32_16x16x32_bf16 v[84:87], a[168:171], a[184:187], v[84:87]
    s_waitcnt lgkmcnt(6)
    v_mfma_f32_16x16x32_bf16 v[68:71], v[228:231], a[80:83], v[68:71]
    ds_read_b128 a[168:171], v8 offset:0
    ds_read_b128 a[172:175], v9 offset:0
    v_mfma_f32_16x16x32_bf16 v[68:71], v[232:235], a[0:3], v[68:71]
    v_mfma_f32_16x16x32_bf16 v[72:75], v[232:235], a[4:7], v[72:75]
    v_mfma_f32_16x16x32_bf16 v[72:75], v[228:231], a[84:87], v[72:75]
    s_waitcnt lgkmcnt(6)
    v_mfma_f32_16x16x32_bf16 v[88:91], v[242:245], a[84:87], v[88:91]
    ds_read_b128 v[228:231], v8 offset:2048
    ds_read_b128 v[232:235], v9 offset:2048
    v_mfma_f32_16x16x32_bf16 v[88:91], v[64:67], a[4:7], v[88:91]
    v_mfma_f32_16x16x32_bf16 v[84:87], v[64:67], a[0:3], v[84:87]
    v_mfma_f32_16x16x32_bf16 v[84:87], v[242:245], a[80:83], v[84:87]
    s_waitcnt lgkmcnt(6)
    v_mfma_f32_16x16x32_bf16 v[68:71], a[176:179], v[20:23], v[68:71]
    ds_read_b128 v[242:245], v8 offset:16384
    ds_read_b128 v[64:67], v9 offset:16384
    v_mfma_f32_16x16x32_bf16 v[68:71], a[180:183], v[36:39], v[68:71]
    v_mfma_f32_16x16x32_bf16 v[72:75], a[180:183], v[40:43], v[72:75]
    v_mfma_f32_16x16x32_bf16 v[72:75], a[176:179], v[24:27], v[72:75]
    s_waitcnt lgkmcnt(6)
    v_mfma_f32_16x16x32_bf16 v[88:91], a[160:163], v[24:27], v[88:91]
    ds_read_b128 a[176:179], v8 offset:18432
    ds_read_b128 a[180:183], v9 offset:18432
    v_mfma_f32_16x16x32_bf16 v[88:91], a[164:167], v[40:43], v[88:91]
    v_mfma_f32_16x16x32_bf16 v[84:87], a[164:167], v[36:39], v[84:87]
    v_mfma_f32_16x16x32_bf16 v[84:87], a[160:163], v[20:23], v[84:87]
    s_mov_b32 s48, s18
    s_mov_b32 s49, s19
    s_mov_b32 s50, 0x800000
    s_mov_b32 s51, 0x00020000
    s_waitcnt vmcnt(4)
    s_nop 0
    v_max3_u32 v240, v116, v117, v118
    v_max3_u32 v240, v240, v119, v120
    v_max3_u32 v240, v240, v121, v122
    v_max3_u32 v240, v240, v123, v148
    v_max3_u32 v240, v240, v149, v150
    v_max3_u32 v240, v240, v151, v152
    v_max3_u32 v240, v240, v153, v154
    v_max3_u32 v240, v240, v155, v180
    v_max3_u32 v240, v240, v181, v182
    v_max3_u32 v240, v240, v183, v184
    v_max3_u32 v240, v240, v185, v186
    v_max_u32 v240, v240, v187
    v_cmp_eq_u32 vcc, -1, v240
    s_cbranch_vccnz fa_r0_slow
fa_r0_ok:
    v_lshlrev_b32 v236, 16, v116
    v_and_b32_e64 v237, s70, v116
    v_pk_add_f32 v[68:69], v[68:69], v[236:237]
    v_lshlrev_b32 v238, 16, v117
    v_and_b32 v239, s70, v117
    v_pk_add_f32 v[70:71], v[70:71], v[238:239]
    v_lshlrev_b32 v236, 16, v118
    v_and_b32 v237, s70, v118
    v_pk_add_f32 v[84:85], v[84:85], v[236:237]
    v_lshlrev_b32 v238, 16, v119
    v_and_b32 v239, s70, v119
    v_pk_add_f32 v[86:87], v[86:87], v[238:239]
    v_lshlrev_b32 v236, 16, v148
    v_and_b32 v237, s70, v148
    v_pk_add_f32 v[68:69], v[68:69], v[236:237]
    v_lshlrev_b32 v238, 16, v149
    v_and_b32 v239, s70, v149
    v_pk_add_f32 v[70:71], v[70:71], v[238:239]
    v_lshlrev_b32 v236, 16, v150
    v_and_b32 v237, s70, v150
    v_pk_add_f32 v[84:85], v[84:85], v[236:237]
    v_lshlrev_b32 v238, 16, v151
    v_and_b32 v239, s70, v151
    v_pk_add_f32 v[86:87], v[86:87], v[238:239]
    v_lshlrev_b32 v236, 16, v180
    v_and_b32 v237, s70, v180
    v_pk_add_f32 v[68:69], v[68:69], v[236:237]
    v_lshlrev_b32 v238, 16, v181
    v_and_b32 v239, s70, v181
    v_pk_add_f32 v[70:71], v[70:71], v[238:239]
    v_lshlrev_b32 v236, 16, v182
    v_and_b32 v237, s70, v182
    v_pk_add_f32 v[84:85], v[84:85], v[236:237]
    v_lshlrev_b32 v238, 16, v183
    v_and_b32 v239, s70, v183
    v_pk_add_f32 v[86:87], v[86:87], v[238:239]
    ds_write_b128 v56, v[68:71] offset:0
    ds_write_b128 v57, v[84:87] offset:0
    ds_read_b128 v[100:103], v58 offset:0
    ds_read_b128 v[104:107], v58 offset:1024
    v_lshlrev_b32 v236, 16, v120
    v_and_b32 v237, s70, v120
    v_pk_add_f32 v[72:73], v[72:73], v[236:237]
    v_lshlrev_b32 v238, 16, v121
    v_and_b32 v239, s70, v121
    v_pk_add_f32 v[74:75], v[74:75], v[238:239]
    v_lshlrev_b32 v236, 16, v122
    v_and_b32 v237, s70, v122
    v_pk_add_f32 v[88:89], v[88:89], v[236:237]
    v_lshlrev_b32 v238, 16, v123
    v_and_b32 v239, s70, v123
    v_pk_add_f32 v[90:91], v[90:91], v[238:239]
    v_lshlrev_b32 v236, 16, v152
    v_and_b32 v237, s70, v152
    v_pk_add_f32 v[72:73], v[72:73], v[236:237]
    v_lshlrev_b32 v238, 16, v153
    v_and_b32 v239, s70, v153
    v_pk_add_f32 v[74:75], v[74:75], v[238:239]
    v_lshlrev_b32 v236, 16, v154
    v_and_b32 v237, s70, v154
    v_pk_add_f32 v[88:89], v[88:89], v[236:237]
    v_lshlrev_b32 v238, 16, v155
    v_and_b32 v239, s70, v155
    v_pk_add_f32 v[90:91], v[90:91], v[238:239]
    v_lshlrev_b32 v236, 16, v184
    v_and_b32 v237, s70, v184
    v_pk_add_f32 v[72:73], v[72:73], v[236:237]
    v_lshlrev_b32 v238, 16, v185
    v_and_b32 v239, s70, v185
    v_pk_add_f32 v[74:75], v[74:75], v[238:239]
    v_lshlrev_b32 v236, 16, v186
    v_and_b32 v237, s70, v186
    v_pk_add_f32 v[88:89], v[88:89], v[236:237]
    v_lshlrev_b32 v238, 16, v187
    v_and_b32 v239, s70, v187
    v_pk_add_f32 v[90:91], v[90:91], v[238:239]
    ds_write_b128 v56, v[72:75] offset:2048
    ds_write_b128 v57, v[88:91] offset:2048
    ds_read_b128 v[132:135], v58 offset:2048
    ds_read_b128 v[136:139], v58 offset:3072
    s_xor_b32 s27, s67, 0x280000
    buffer_load_dwordx4 v[156:159], v2, s[40:43], s27 offen sc0 sc1
    s_xor_b32 s27, s67, 0x380000
    buffer_load_dwordx4 v[160:163], v2, s[40:43], s27 offen sc0 sc1
    s_xor_b32 s27, s67, 0xc0000
    buffer_load_dwordx4 v[188:191], v2, s[40:43], s27 offen sc0 sc1
    s_xor_b32 s27, s67, 0x1c0000
    buffer_load_dwordx4 v[192:195], v2, s[40:43], s27 offen sc0 sc1
    s_waitcnt lgkmcnt(5)
    v_pk_add_f32 v[100:101], v[100:101], v[196:197]
    v_pk_add_f32 v[102:103], v[102:103], v[198:199]
    s_mov_b32 s66, 0
    buffer_store_dwordx4 v[100:103], v14, s[48:51], s66 offen sc0 sc1
    s_waitcnt lgkmcnt(4)
    v_pk_add_f32 v[104:105], v[104:105], v[200:201]
    v_pk_add_f32 v[106:107], v[106:107], v[202:203]
    s_mov_b32 s66, 131072
    buffer_store_dwordx4 v[104:107], v14, s[48:51], s66 offen sc0 sc1
    s_waitcnt lgkmcnt(1)
    v_pk_add_f32 v[132:133], v[132:133], v[204:205]
    v_pk_add_f32 v[134:135], v[134:135], v[206:207]
    s_mov_b32 s66, 8192
    buffer_store_dwordx4 v[132:135], v14, s[48:51], s66 offen sc0 sc1
    s_waitcnt lgkmcnt(0)
    v_pk_add_f32 v[136:137], v[136:137], v[208:209]
    v_pk_add_f32 v[138:139], v[138:139], v[210:211]
    s_mov_b32 s66, 139264
    buffer_store_dwordx4 v[136:139], v14, s[48:51], s66 offen sc0 sc1
    s_waitcnt lgkmcnt(14)
    v_mfma_f32_16x16x32_bf16 v[76:79], a[168:171], a[208:211], v[76:79]
    ds_read_b128 a[160:163], v8 offset:32768
    ds_read_b128 a[164:167], v9 offset:32768
    v_mfma_f32_16x16x32_bf16 v[76:79], a[172:175], a[104:107], v[76:79]
    v_mfma_f32_16x16x32_bf16 v[80:83], a[172:175], a[108:111], v[80:83]
    v_mfma_f32_16x16x32_bf16 v[80:83], a[168:171], a[212:215], v[80:83]
    s_waitcnt lgkmcnt(14)
    v_mfma_f32_16x16x32_bf16 v[96:99], v[228:231], a[212:215], v[96:99]
    ds_read_b128 a[168:171], v8 offset:34816
    ds_read_b128 a[172:175], v9 offset:34816
    v_mfma_f32_16x16x32_bf16 v[96:99], v[232:235], a[108:111], v[96:99]
    v_mfma_f32_16x16x32_bf16 v[92:95], v[232:235], a[104:107], v[92:95]
    v_mfma_f32_16x16x32_bf16 v[92:95], v[228:231], a[208:211], v[92:95]
    s_waitcnt lgkmcnt(14)
    v_mfma_f32_16x16x32_bf16 v[76:79], v[242:245], a[120:123], v[76:79]
    ds_read_b128 v[228:231], v8 offset:49152
    ds_read_b128 v[232:235], v9 offset:49152
    v_mfma_f32_16x16x32_bf16 v[76:79], v[64:67], a[40:43], v[76:79]
    v_mfma_f32_16x16x32_bf16 v[80:83], v[64:67], a[44:47], v[80:83]
    v_mfma_f32_16x16x32_bf16 v[80:83], v[242:245], a[124:127], v[80:83]
    s_waitcnt lgkmcnt(14)
    v_mfma_f32_16x16x32_bf16 v[96:99], a[176:179], a[124:127], v[96:99]
    ds_read_b128 v[242:245], v8 offset:51200
    ds_read_b128 v[64:67], v9 offset:51200
    v_mfma_f32_16x16x32_bf16 v[96:99], a[180:183], a[44:47], v[96:99]
    v_mfma_f32_16x16x32_bf16 v[92:95], a[180:183], a[40:43], v[92:95]
    v_mfma_f32_16x16x32_bf16 v[92:95], a[176:179], a[120:123], v[92:95]
    s_waitcnt lgkmcnt(6)
    v_mfma_f32_16x16x32_bf16 v[76:79], a[160:163], a[248:251], v[76:79]
    ds_read_b128 a[176:179], v10 offset:0
    ds_read_b128 a[180:183], v11 offset:0
    v_mfma_f32_16x16x32_bf16 v[76:79], a[164:167], a[56:59], v[76:79]
    v_mfma_f32_16x16x32_bf16 v[80:83], a[164:167], a[60:63], v[80:83]
    v_mfma_f32_16x16x32_bf16 v[80:83], a[160:163], a[252:255], v[80:83]
    s_waitcnt lgkmcnt(6)
    v_mfma_f32_16x16x32_bf16 v[96:99], a[168:171], a[252:255], v[96:99]
    ds_read_b128 a[160:163], v10 offset:2048
    ds_read_b128 a[164:167], v11 offset:2048
    v_mfma_f32_16x16x32_bf16 v[96:99], a[172:175], a[60:63], v[96:99]
    v_mfma_f32_16x16x32_bf16 v[92:95], a[172:175], a[56:59], v[92:95]
    v_mfma_f32_16x16x32_bf16 v[92:95], a[168:171], a[248:251], v[92:95]
    s_waitcnt lgkmcnt(6)
    v_mfma_f32_16x16x32_bf16 v[76:79], v[228:231], a[192:195], v[76:79]
    ds_read_b128 a[168:171], v10 offset:16384
    ds_read_b128 a[172:175], v11 offset:16384
    v_mfma_f32_16x16x32_bf16 v[76:79], v[232:235], a[72:75], v[76:79]
    v_mfma_f32_16x16x32_bf16 v[80:83], v[232:235], a[76:79], v[80:83]
    v_mfma_f32_16x16x32_bf16 v[80:83], v[228:231], a[196:199], v[80:83]
    s_waitcnt lgkmcnt(6)
    v_mfma_f32_16x16x32_bf16 v[96:99], v[242:245], a[196:199], v[96:99]
    ds_read_b128 v[228:231], v10 offset:18432
    ds_read_b128 v[232:235], v11 offset:18432
    v_mfma_f32_16x16x32_bf16 v[96:99], v[64:67], a[76:79], v[96:99]
    v_mfma_f32_16x16x32_bf16 v[92:95], v[64:67], a[72:75], v[92:95]
    v_mfma_f32_16x16x32_bf16 v[92:95], v[242:245], a[192:195], v[92:95]
    s_waitcnt lgkmcnt(6)
    v_mfma_f32_16x16x32_bf16 v[76:79], a[176:179], a[88:91], v[76:79]
    v_mfma_f32_16x16x32_bf16 v[76:79], a[180:183], a[8:11], v[76:79]
    v_mfma_f32_16x16x32_bf16 v[80:83], a[180:183], a[12:15], v[80:83]
    v_mfma_f32_16x16x32_bf16 v[80:83], a[176:179], a[92:95], v[80:83]
    s_waitcnt lgkmcnt(4)
    v_mfma_f32_16x16x32_bf16 v[96:99], a[160:163], a[92:95], v[96:99]
    v_mfma_f32_16x16x32_bf16 v[96:99], a[164:167], a[12:15], v[96:99]
    v_mfma_f32_16x16x32_bf16 v[92:95], a[164:167], a[8:11], v[92:95]
    v_mfma_f32_16x16x32_bf16 v[92:95], a[160:163], a[88:91], v[92:95]
    s_waitcnt lgkmcnt(2)
    v_mfma_f32_16x16x32_bf16 v[76:79], a[168:171], v[28:31], v[76:79]
    v_mfma_f32_16x16x32_bf16 v[76:79], a[172:175], v[44:47], v[76:79]
    v_mfma_f32_16x16x32_bf16 v[80:83], a[172:175], v[48:51], v[80:83]
    v_mfma_f32_16x16x32_bf16 v[80:83], a[168:171], v[32:35], v[80:83]
    s_waitcnt lgkmcnt(0)
    v_mfma_f32_16x16x32_bf16 v[96:99], v[228:231], v[32:35], v[96:99]
    v_mfma_f32_16x16x32_bf16 v[96:99], v[232:235], v[48:51], v[96:99]
    v_mfma_f32_16x16x32_bf16 v[92:95], v[232:235], v[44:47], v[92:95]
    v_mfma_f32_16x16x32_bf16 v[92:95], v[228:231], v[28:31], v[92:95]
    s_waitcnt vmcnt(4)
    v_max3_u32 v240, v124, v125, v126
    v_max3_u32 v240, v240, v127, v128
    v_max3_u32 v240, v240, v129, v130
    v_max3_u32 v240, v240, v131, v156
    v_max3_u32 v240, v240, v157, v158
    v_max3_u32 v240, v240, v159, v160
    v_max3_u32 v240, v240, v161, v162
    v_max3_u32 v240, v240, v163, v188
    v_max3_u32 v240, v240, v189, v190
    v_max3_u32 v240, v240, v191, v192
    v_max3_u32 v240, v240, v193, v194
    v_max_u32 v240, v240, v195
    v_cmp_eq_u32 vcc, -1, v240
    s_cbranch_vccnz fa_r1_slow
fa_r1_ok:
    v_lshlrev_b32 v236, 16, v124
    v_and_b32_e64 v237, s70, v124
    v_pk_add_f32 v[76:77], v[76:77], v[236:237]
    v_lshlrev_b32 v238, 16, v125
    v_and_b32 v239, s70, v125
    v_pk_add_f32 v[78:79], v[78:79], v[238:239]
    v_lshlrev_b32 v236, 16, v126
    v_and_b32 v237, s70, v126
    v_pk_add_f32 v[92:93], v[92:93], v[236:237]
    v_lshlrev_b32 v238, 16, v127
    v_and_b32 v239, s70, v127
    v_pk_add_f32 v[94:95], v[94:95], v[238:239]
    v_lshlrev_b32 v236, 16, v156
    v_and_b32 v237, s70, v156
    v_pk_add_f32 v[76:77], v[76:77], v[236:237]
    v_lshlrev_b32 v238, 16, v157
    v_and_b32 v239, s70, v157
    v_pk_add_f32 v[78:79], v[78:79], v[238:239]
    v_lshlrev_b32 v236, 16, v158
    v_and_b32 v237, s70, v158
    v_pk_add_f32 v[92:93], v[92:93], v[236:237]
    v_lshlrev_b32 v238, 16, v159
    v_and_b32 v239, s70, v159
    v_pk_add_f32 v[94:95], v[94:95], v[238:239]
    v_lshlrev_b32 v236, 16, v188
    v_and_b32 v237, s70, v188
    v_pk_add_f32 v[76:77], v[76:77], v[236:237]
    v_lshlrev_b32 v238, 16, v189
    v_and_b32 v239, s70, v189
    v_pk_add_f32 v[78:79], v[78:79], v[238:239]
    v_lshlrev_b32 v236, 16, v190
    v_and_b32 v237, s70, v190
    v_pk_add_f32 v[92:93], v[92:93], v[236:237]
    v_lshlrev_b32 v238, 16, v191
    v_and_b32 v239, s70, v191
    v_pk_add_f32 v[94:95], v[94:95], v[238:239]
    ds_write_b128 v56, v[76:79] offset:4096
    ds_write_b128 v57, v[92:95] offset:4096
    ds_read_b128 v[100:103], v58 offset:4096
    ds_read_b128 v[104:107], v58 offset:5120
    v_lshlrev_b32 v236, 16, v128
    v_and_b32 v237, s70, v128
    v_pk_add_f32 v[80:81], v[80:81], v[236:237]
    v_lshlrev_b32 v238, 16, v129
    v_and_b32 v239, s70, v129
    v_pk_add_f32 v[82:83], v[82:83], v[238:239]
    v_lshlrev_b32 v236, 16, v130
    v_and_b32 v237, s70, v130
    v_pk_add_f32 v[96:97], v[96:97], v[236:237]
    v_lshlrev_b32 v238, 16, v131
    v_and_b32 v239, s70, v131
    v_pk_add_f32 v[98:99], v[98:99], v[238:239]
    v_lshlrev_b32 v236, 16, v160
    v_and_b32 v237, s70, v160
    v_pk_add_f32 v[80:81], v[80:81], v[236:237]
    v_lshlrev_b32 v238, 16, v161
    v_and_b32 v239, s70, v161
    v_pk_add_f32 v[82:83], v[82:83], v[238:239]
    v_lshlrev_b32 v236, 16, v162
    v_and_b32 v237, s70, v162
    v_pk_add_f32 v[96:97], v[96:97], v[236:237]
    v_lshlrev_b32 v238, 16, v163
    v_and_b32 v239, s70, v163
    v_pk_add_f32 v[98:99], v[98:99], v[238:239]
    v_lshlrev_b32 v236, 16, v192
    v_and_b32 v237, s70, v192
    v_pk_add_f32 v[80:81], v[80:81], v[236:237]
    v_lshlrev_b32 v238, 16, v193
    v_and_b32 v239, s70, v193
    v_pk_add_f32 v[82:83], v[82:83], v[238:239]
    v_lshlrev_b32 v236, 16, v194
    v_and_b32 v237, s70, v194
    v_pk_add_f32 v[96:97], v[96:97], v[236:237]
    v_lshlrev_b32 v238, 16, v195
    v_and_b32 v239, s70, v195
    v_pk_add_f32 v[98:99], v[98:99], v[238:239]
    ds_write_b128 v56, v[80:83] offset:6144
    ds_write_b128 v57, v[96:99] offset:6144
    ds_read_b128 v[132:135], v58 offset:6144
    ds_read_b128 v[136:139], v58 offset:7168
    s_waitcnt lgkmcnt(5)
    v_pk_add_f32 v[100:101], v[100:101], v[212:213]
    v_pk_add_f32 v[102:103], v[102:103], v[214:215]
    s_mov_b32 s66, 16384
    buffer_store_dwordx4 v[100:103], v14, s[48:51], s66 offen sc0 sc1
    s_waitcnt lgkmcnt(4)
    v_pk_add_f32 v[104:105], v[104:105], v[216:217]
    v_pk_add_f32 v[106:107], v[106:107], v[218:219]
    s_mov_b32 s66, 147456
    buffer_store_dwordx4 v[104:107], v14, s[48:51], s66 offen sc0 sc1
    s_waitcnt lgkmcnt(1)
    v_pk_add_f32 v[132:133], v[132:133], v[220:221]
    v_pk_add_f32 v[134:135], v[134:135], v[222:223]
    s_mov_b32 s66, 24576
    buffer_store_dwordx4 v[132:135], v14, s[48:51], s66 offen sc0 sc1
    s_waitcnt lgkmcnt(0)
    v_pk_add_f32 v[136:137], v[136:137], v[224:225]
    v_pk_add_f32 v[138:139], v[138:139], v[226:227]
    s_mov_b32 s66, 155648
    buffer_store_dwordx4 v[136:139], v14, s[48:51], s66 offen sc0 sc1
    s_endpgm
f_n_slow:
    s_mov_b32 s3, 0
f_n_again:
    s_add_u32 s3, s3, 1
    s_cmp_gt_u32 s3, 0x40000
    s_cbranch_scc1 f_n_ok
    buffer_load_dword v105, v104, s[44:47], s71 offen sc0 sc1
    s_waitcnt vmcnt(0)
    v_cmp_eq_u32 vcc, 0, v105
    s_cbranch_vccnz f_n_again
    s_branch f_n_ok
f_fl_slow:
    s_mov_b32 s71, 0
f_fl_again:
    s_add_u32 s71, s71, 1
    s_cmp_gt_u32 s71, 0x40000
    s_cbranch_scc1 f_fl_ok
    buffer_load_dword v67, v255, s[52:55], 0 offen sc0 sc1
    s_waitcnt vmcnt(0)
    v_subrev_u32 v67, s21, v67
    v_cmp_lt_u32 vcc, 15, v67
    s_cbranch_vccnz f_fl_again
    s_branch f_fl_ok
f_fm_slow:
    s_mov_b32 s71, 0
f_fm_again:
    s_add_u32 s71, s71, 1
    s_cmp_gt_u32 s71, 0x40000
    s_cbranch_scc1 f_fm_ok
    buffer_load_dword v241, v255, s[52:55], 0 offen sc0 sc1
    s_waitcnt vmcnt(0)
    v_subrev_u32 v241, s21, v241
    v_cmp_lt_u32 vcc, 14, v241
    s_cbranch_vccnz f_fm_again
    s_branch f_fm_ok
fa_c_slow:
    s_mov_b32 s71, 0
fa_c_again:
    s_add_u32 s71, s71, 1
    s_cmp_gt_u32 s71, 0x40000
    s_cbranch_scc1 fa_c_ok
    s_sub_u32 s66, s69, 32
    s_lshl_b32 s66, s66, 8
    v_lshrrev_b32 v240, 4, v1
    v_lshl_add_u32 v240, v240, 11, v3
    v_add_u32 v240, s66, v240
    buffer_load_dwordx4 v[196:199], v240, s[40:43], 0 offen sc0 sc1
    v_add_u32 v240, 256, v240
    buffer_load_dwordx4 v[200:203], v240, s[40:43], 0 offen sc0 sc1
    v_add_u32 v240, 256, v240
    buffer_load_dwordx4 v[204:207], v240, s[40:43], 0 offen sc0 sc1
    v_add_u32 v240, 256, v240
    buffer_load_dwordx4 v[208:211], v240, s[40:43], 0 offen sc0 sc1
    v_add_u32 v240, 256, v240
    buffer_load_dwordx4 v[212:215], v240, s[40:43], 0 offen sc0 sc1
    v_add_u32 v240, 256, v240
    buffer_load_dwordx4 v[216:219], v240, s[40:43], 0 offen sc0 sc1
    v_add_u32 v240, 256, v240
    buffer_load_dwordx4 v[220:223], v240, s[40:43], 0 offen sc0 sc1
    v_add_u32 v240, 256, v240
    buffer_load_dwordx4 v[224:227], v240, s[40:43], 0 offen sc0 sc1
    v_add_u32 v240, 256, v240
    s_waitcnt vmcnt(0)
    v_max3_u32 v240, v196, v197, v198
    v_max3_u32 v240, v240, v199, v200
    v_max3_u32 v240, v240, v201, v202
    v_max3_u32 v240, v240, v203, v204
    v_max3_u32 v240, v240, v205, v206
    v_max3_u32 v240, v240, v207, v208
    v_max3_u32 v240, v240, v209, v210
    v_max3_u32 v240, v240, v211, v212
    v_max3_u32 v240, v240, v213, v214
    v_max3_u32 v240, v240, v215, v216
    v_max3_u32 v240, v240, v217, v218
    v_max3_u32 v240, v240, v219, v220
    v_max3_u32 v240, v240, v221, v222
    v_max3_u32 v240, v240, v223, v224
    v_max3_u32 v240, v240, v225, v226
    v_max_u32 v240, v240, v227
    v_cmp_eq_u32 vcc, -1, v240
    s_cbranch_vccnz fa_c_again
    s_branch fa_c_ok
fa_fx_slow:
    s_mov_b32 s71, 0
fa_fx_again:
    s_add_u32 s71, s71, 1
    s_cmp_gt_u32 s71, 0x40000
    s_cbranch_scc1 fa_fx_ok
    buffer_load_dword v252, v255, s[52:55], 0 offen sc0 sc1
    s_waitcnt vmcnt(0)
    v_subrev_u32 v252, s21, v252
    v_cmp_lt_u32 vcc, 14, v252
    s_cbranch_vccnz fa_fx_again
    s_branch fa_fx_ok
fa_f1_slow:
    s_mov_b32 s71, 0
fa_f1_again:
    s_add_u32 s71, s71, 1
    s_cmp_gt_u32 s71, 0x40000
    s_cbranch_scc1 fa_f1_ok
    buffer_load_dword v252, v249, s[52:55], 0 offen sc0 sc1
    s_waitcnt vmcnt(0)
    v_subrev_u32 v252, s21, v252
    v_cmp_lt_u32 vcc, 13, v252
    s_cbranch_vccnz fa_f1_again
    s_branch fa_f1_ok
fa_f2_slow:
    s_mov_b32 s71, 0
fa_f2_again:
    s_add_u32 s71, s71, 1
    s_cmp_gt_u32 s71, 0x40000
    s_cbranch_scc1 fa_f2_ok
    buffer_load_dword v252, v249, s[52:55], 0 offen sc0 sc1
    s_waitcnt vmcnt(0)
    v_subrev_u32 v252, s21, v252
    v_cmp_lt_u32 vcc, 12, v252
    s_cbranch_vccnz fa_f2_again
    s_branch fa_f2_ok
fa_f3_slow:
    s_mov_b32 s71, 0
fa_f3_again:
    s_add_u32 s71, s71, 1
    s_cmp_gt_u32 s71, 0x40000
    s_cbranch_scc1 fa_f3_ok
    buffer_load_dword v252, v249, s[52:55], 0 offen sc0 sc1
    s_waitcnt vmcnt(0)
    v_subrev_u32 v252, s21, v252
    v_cmp_lt_u32 vcc, 11, v252
    s_cbranch_vccnz fa_f3_again
    s_branch fa_f3_ok
fa_f4_slow:
    s_mov_b32 s71, 0
fa_f4_again:
    s_add_u32 s71, s71, 1
    s_cmp_gt_u32 s71, 0x40000
    s_cbranch_scc1 fa_f4_ok
    buffer_load_dword v252, v249, s[52:55], 0 offen sc0 sc1
    s_waitcnt vmcnt(0)
    v_subrev_u32 v252, s21, v252
    v_cmp_lt_u32 vcc, 10, v252
    s_cbranch_vccnz fa_f4_again
    s_branch fa_f4_ok
fa_fz_slow:
    s_mov_b32 s71, 0
fa_fz_again:
    s_add_u32 s71, s71, 1
    s_cmp_gt_u32 s71, 0x40000
    s_cbranch_scc1 fa_fz_ok
    buffer_load_dword v252, v249, s[52:55], 0 offen sc0 sc1
    s_waitcnt vmcnt(0)
    v_subrev_u32 v252, s21, v252
    v_cmp_lt_u32 vcc, 13, v252
    s_cbranch_vccnz fa_fz_again
    s_branch fa_fz_ok
fa_r0_slow:
    s_mov_b32 s71, 0
fa_r0_again:
    s_add_u32 s71, s71, 1
    s_cmp_gt_u32 s71, 0x40000
    s_cbranch_scc1 fa_r0_ok
    v_max3_u32 v240, v116, v117, v118
    v_max3_u32 v240, v240, v119, v120
    v_max3_u32 v240, v240, v121, v122
    v_max_u32 v240, v240, v123
    v_cmp_eq_u32 vcc, -1, v240
    s_cbranch_vccz fa_r0_has1
    s_xor_b32 s27, s67, 0xa40000
    buffer_load_dwordx4 v[116:119], v2, s[40:43], s27 offen sc0 sc1
    s_xor_b32 s27, s67, 0xb40000
    buffer_load_dwordx4 v[120:123], v2, s[40:43], s27 offen sc0 sc1
fa_r0_has1:
    v_max3_u32 v240, v148, v149, v150
    v_max3_u32 v240, v240, v151, v152
    v_max3_u32 v240, v240, v153, v154
    v_max_u32 v240, v240, v155
    v_cmp_eq_u32 vcc, -1, v240
    s_cbranch_vccz fa_r0_has2
    s_xor_b32 s27, s67, 0x880000
    buffer_load_dwordx4 v[148:151], v2, s[40:43], s27 offen sc0 sc1
    s_xor_b32 s27, s67, 0x980000
    buffer_load_dwordx4 v[152:155], v2, s[40:43], s27 offen sc0 sc1
fa_r0_has2:
    v_max3_u32 v240, v180, v181, v182
    v_max3_u32 v240, v240, v183, v184
    v_max3_u32 v240, v240, v185, v186
    v_max_u32 v240, v240, v187
    v_cmp_eq_u32 vcc, -1, v240
    s_cbranch_vccz fa_r0_has3
    s_xor_b32 s27, s67, 0x6c0000
    buffer_load_dwordx4 v[180:183], v2, s[40:43], s27 offen sc0 sc1
    s_xor_b32 s27, s67, 0x7c0000
    buffer_load_dwordx4 v[184:187], v2, s[40:43], s27 offen sc0 sc1
fa_r0_has3:
    s_waitcnt vmcnt(0)
    v_max3_u32 v240, v116, v117, v118
    v_max3_u32 v240, v240, v119, v120
    v_max3_u32 v240, v240, v121, v122
    v_max3_u32 v240, v240, v123, v148
    v_max3_u32 v240, v240, v149, v150
    v_max3_u32 v240, v240, v151, v152
    v_max3_u32 v240, v240, v153, v154
    v_max3_u32 v240, v240, v155, v180
    v_max3_u32 v240, v240, v181, v182
    v_max3_u32 v240, v240, v183, v184
    v_max3_u32 v240, v240, v185, v186
    v_max_u32 v240, v240, v187
    v_cmp_eq_u32 vcc, -1, v240
    s_cbranch_vccnz fa_r0_again
    s_branch fa_r0_ok
fa_r1_slow:
    s_mov_b32 s71, 0
fa_r1_again:
    s_add_u32 s71, s71, 1
    s_cmp_gt_u32 s71, 0x40000
    s_cbranch_scc1 fa_r1_ok
    v_max3_u32 v240, v124, v125, v126
    v_max3_u32 v240, v240, v127, v128
    v_max3_u32 v240, v240, v129, v130
    v_max_u32 v240, v240, v131
    v_cmp_eq_u32 vcc, -1, v240
    s_cbranch_vccz fa_r1_has1
    s_xor_b32 s27, s67, 0x440000
    buffer_load_dwordx4 v[124:127], v2, s[40:43], s27 offen sc0 sc1
    s_xor_b32 s27, s67, 0x540000
    buffer_load_dwordx4 v[128:131], v2, s[40:43], s27 offen sc0 sc1
fa_r1_has1:
    v_max3_u32 v240, v156, v157, v158
    v_max3_u32 v240, v240, v159, v160
    v_max3_u32 v240, v240, v161, v162
    v_max_u32 v240, v240, v163
    v_cmp_eq_u32 vcc, -1, v240
    s_cbranch_vccz fa_r1_has2
    s_xor_b32 s27, s67, 0x280000
    buffer_load_dwordx4 v[156:159], v2, s[40:43], s27 offen sc0 sc1
    s_xor_b32 s27, s67, 0x380000
    buffer_load_dwordx4 v[160:163], v2, s[40:43], s27 offen sc0 sc1
fa_r1_has2:
    v_max3_u32 v240, v188, v189, v190
    v_max3_u32 v240, v240, v191, v192
    v_max3_u32 v240, v240, v193, v194
    v_max_u32 v240, v240, v195
    v_cmp_eq_u32 vcc, -1, v240
    s_cbranch_vccz fa_r1_has3
    s_xor_b32 s27, s67, 0xc0000
    buffer_load_dwordx4 v[188:191], v2, s[40:43], s27 offen sc0 sc1
    s_xor_b32 s27, s67, 0x1c0000
    buffer_load_dwordx4 v[192:195], v2, s[40:43], s27 offen sc0 sc1
fa_r1_has3:
    s_waitcnt vmcnt(0)
    v_max3_u32 v240, v124, v125, v126
    v_max3_u32 v240, v240, v127, v128
    v_max3_u32 v240, v240, v129, v130
    v_max3_u32 v240, v240, v131, v156
    v_max3_u32 v240, v240, v157, v158
    v_max3_u32 v240, v240, v159, v160
    v_max3_u32 v240, v240, v161, v162
    v_max3_u32 v240, v240, v163, v188
    v_max3_u32 v240, v240, v189, v190
    v_max3_u32 v240, v240, v191, v192
    v_max3_u32 v240, v240, v193, v194
    v_max_u32 v240, v240, v195
    v_cmp_eq_u32 vcc, -1, v240
    s_cbranch_vccnz fa_r1_again
    s_branch fa_r1_ok
fa_last:
f_end:
    s_endpgm
code_end:

.section .rodata,"a"
.p2align 6
.amdhsa_kernel parallel_sum__ssm_conv_s5__glu_gated_geglu__prompt_kernel
  .amdhsa_next_free_vgpr 512
  .amdhsa_next_free_sgpr 102
  .amdhsa_accum_offset 256
  .amdhsa_group_segment_fixed_size 0
  .amdhsa_kernarg_size 128
  .amdhsa_user_sgpr_count 2
  .amdhsa_user_sgpr_kernarg_segment_ptr 1
  .amdhsa_system_sgpr_workgroup_id_x 1
.end_amdhsa_kernel
```
